```python
import torch

def _softmax(x, axis=-1):
    return torch.softmax(x, dim=axis)
def _gelu(x):
    return torch.nn.functional.gelu(x, approximate="tanh")
def _silu(x):
    return torch.nn.functional.silu(x)
def _sigmoid(x):
    return torch.sigmoid(x)
def _layernorm(x, axis=-1, eps=1e-5):
    m = x.mean(dim=axis, keepdim=True)
    v = x.var(dim=axis, keepdim=True, unbiased=False)
    return (x - m) / torch.sqrt(v + eps)
def _scatter_add(tgt, idx, src, axis=0):
    return tgt.clone().index_add_(axis, idx, src)
def _segment_sum(src, seg, n):
    out = torch.zeros((n,) + src.shape[1:], dtype=src.dtype)
    return out.index_add_(0, seg, src)
def _pad(x, pw):
    flat = tuple(v for pair in reversed(pw) for v in pair)
    return torch.nn.functional.pad(x, flat)

kernel_name = 'concat_heads__mha_block_cached__gqa_block_cached__near_ridge'

def setup_inputs():

    _w = (lambda a: (lambda t: t.to(torch.bfloat16) if t.is_floating_point() else t)(torch.as_tensor(a)))
    def _A_setup():
        B, Sq, D = 8, 192, 448
        H, Sk, Dh = 16, 1024, 256
        return {
            "x": _w((lambda *s: torch.randn(*s, dtype=torch.bfloat16) * 0.8)(B, Sq, D)),
            "k_cache": _w((lambda *s: torch.randn(*s, dtype=torch.bfloat16) * 0.8)(B, H, Sk, Dh)),
            "v_cache": _w((lambda *s: torch.randn(*s, dtype=torch.bfloat16) * 0.05)(B, H, Sk, Dh)),
            "wq": _w((lambda *s: torch.randn(*s, dtype=torch.bfloat16) * 0.8)(D, H * Dh) * (D ** -0.5)),
            "wo": _w((lambda *s: torch.randn(*s, dtype=torch.bfloat16) * 0.05)(H * Dh, D) * ((H * Dh) ** -0.5)),
        }
    _A_in = _A_setup()

    def _B_setup():
        B, Sq, D = 8, 192, 448
        Hq, Hkv, Sk, Dh = 16, 16, 1024, 256
        assert Hq % Hkv == 0, (Hq, Hkv)
        return {
            "x": _w((lambda *s: torch.randn(*s, dtype=torch.bfloat16) * 0.8)(B, Sq, D)),
            "k_cache": _w((lambda *s: torch.randn(*s, dtype=torch.bfloat16) * 0.8)(B, Hkv, Sk, Dh)),
            "v_cache": _w((lambda *s: torch.randn(*s, dtype=torch.bfloat16) * 0.05)(B, Hkv, Sk, Dh)),
            "wq": _w((lambda *s: torch.randn(*s, dtype=torch.bfloat16) * 0.8)(D, Hq * Dh) * (D ** -0.5)),
            "wo": _w((lambda *s: torch.randn(*s, dtype=torch.bfloat16) * 0.05)(Hq * Dh, D) * ((Hq * Dh) ** -0.5)),
        }
    _B_in = _B_setup()

    return {
        "A_x": _A_in["x"],
        "A_k_cache": _A_in["k_cache"],
        "A_v_cache": _A_in["v_cache"],
        "A_wq": _A_in["wq"],
        "A_wo": _A_in["wo"],
        "B_x": _B_in["x"],
        "B_k_cache": _B_in["k_cache"],
        "B_v_cache": _B_in["v_cache"],
        "B_wq": _B_in["wq"],
        "B_wo": _B_in["wo"],
    }

def reference(A_x, A_k_cache, A_v_cache, A_wq, A_wo, B_x, B_k_cache, B_v_cache, B_wq, B_wo):
    def _A_ref(x, k_cache, v_cache, wq, wo):
        B, Sq, D = x.shape
        H, Dh = 16, 256
        q = (lambda x, *d: x.permute(*d))((x @ wq).reshape(B, Sq, H, Dh), 0, 2, 1, 3)
        scores = torch.einsum("bhqd,bhkd->bhqk", q, k_cache) * (Dh ** -0.5)
        p = _softmax(scores, axis=-1)
        o = torch.einsum("bhqk,bhkd->bhqd", p, v_cache)
        return (lambda x, *d: x.permute(*d))(o, 0, 2, 1, 3).reshape(B, Sq, H * Dh) @ wo

    def _B_ref(x, k_cache, v_cache, wq, wo):
        B, Sq, D = x.shape
        Hq, Dh = 16, 256
        Hkv = k_cache.shape[1]
        rep = Hq // Hkv
        q = (lambda x, *d: x.permute(*d))((x @ wq).reshape(B, Sq, Hq, Dh), 0, 2, 1, 3)
        k = (lambda x, n, axis: torch.repeat_interleave(x, n, dim=axis))(k_cache, rep, axis=1)
        v = (lambda x, n, axis: torch.repeat_interleave(x, n, dim=axis))(v_cache, rep, axis=1)
        scores = torch.einsum("bhqd,bhkd->bhqk", q, k) * (Dh ** -0.5)
        p = _softmax(scores, axis=-1)
        o = torch.einsum("bhqk,bhkd->bhqd", p, v)
        return (lambda x, *d: x.permute(*d))(o, 0, 2, 1, 3).reshape(B, Sq, Hq * Dh) @ wo

    a = _A_ref(A_x, A_k_cache, A_v_cache, A_wq, A_wo)
    b = _B_ref(B_x, B_k_cache, B_v_cache, B_wq, B_wo)
    return torch.concatenate([a, b], axis=-1)
```

```asm
; @launch grid=(256,1,1) block=(256,1,1) lds=152128
.amdgcn_target "amdgcn-amd-amdhsa--gfx950"
.text
.globl concat_heads__mha_block_cached__gqa_block_cached__near_ridge_kernel
.p2align 8
.type concat_heads__mha_block_cached__gqa_block_cached__near_ridge_kernel,@function
concat_heads__mha_block_cached__gqa_block_cached__near_ridge_kernel:
  s_load_dwordx16 s[64:79], s[0:1], 0
  s_load_dwordx8 s[80:87], s[0:1], 64
  s_load_dwordx2 s[24:25], s[0:1], 96
  s_cmp_ge_u32 s2, 256
  s_cbranch_scc1 L_end
  v_lshrrev_b32 v40, 6, v0
  s_getpc_b64 s[88:89]
L_pc:
  v_readfirstlane_b32 s32, v40
  s_and_b32 s3, s2, 0xf8
  v_lshrrev_b32 v50, 5, v0
  v_add_lshl_u32 v50, v50, s3, 7
  global_load_dword v51, v50, s[88:89]
  v_min_u32 v8, L_hot_end-L_loop-128, v50
  v_add_u32 v8, L_loop-L_pc, v8
  v_and_b32 v0, 63, v0
  s_and_b32 s56, s2, 7
  s_lshr_b32 s3, s2, 3
  s_lshl_b32 s56, s56, 5
  s_add_u32 s56, s56, s3
  s_and_b32 s55, s56, 15
  s_bfe_u32 s60, s56, 0x30004
  s_mul_i32 s33, s32, 4224
  v_lshrrev_b32 v41, 3, v0
  v_lshrrev_b32 v42, 4, v0
  v_and_b32 v43, 7, v0
  v_and_b32 v44, 15, v0
  v_mad_u32_u24 v45, v40, 48, v41
  v_mul_u32_u24 v45, 896, v45
  v_xor_b32 v46, v43, v42
  v_lshl_add_u32 v22, v46, 4, v45
  v_xor_b32 v23, 64, v22
  v_add_u32 v23, 7168, v23
  v_add_u32 v24, 14336, v22
  v_add_u32 v25, 14336, v23
  v_add_u32 v26, 28672, v22
  v_add_u32 v27, 28672, v23
  v_lshrrev_b32 v45, 5, v0
  v_and_b32 v46, 1, v42
  v_lshlrev_b32 v45, 3, v45
  v_add_u32 v45, v45, v46
  v_lshl_add_u32 v45, v40, 1, v45
  v_lshlrev_b32 v45, 15, v45
  v_lshl_add_u32 v16, v44, 4, v45
  v_add_u32 v17, 0x2000, v16
  v_add_u32 v18, 0x4000, v16
  v_add_u32 v19, 0x6000, v16
  s_mul_i32 s61, s60, 172032
  s_mov_b32 s6, 172032
  s_mov_b32 s7, 0x20000
  s_lshl_b32 s3, s55, 9
  s_sub_u32 s18, 3670016, s3
  s_mov_b32 s19, 0x20000
  s_cmp_ge_u32 s56, 128
  s_waitcnt lgkmcnt(0)
  s_cselect_b64 s[4:5], s[74:75], s[64:65]
  s_cselect_b64 s[16:17], s[80:81], s[70:71]
  s_add_u32 s4, s4, s61
  s_addc_u32 s5, s5, 0
  s_add_u32 s16, s16, s3
  s_addc_u32 s17, s17, 0
  s_add_u32 m0, s33, 67584
  s_mov_b32 s52, 0
  buffer_load_dwordx4 v22, s[4:7], s52 offen lds
  s_add_u32 m0, s33, 68608
  s_nop 0
  buffer_load_dwordx4 v23, s[4:7], s52 offen lds
  s_add_u32 m0, s33, 69632
  s_nop 0
  buffer_load_dwordx4 v24, s[4:7], s52 offen lds
  s_add_u32 m0, s33, 70656
  s_nop 0
  buffer_load_dwordx4 v25, s[4:7], s52 offen lds
  s_add_u32 m0, s33, 50688
  s_mov_b32 s52, 0
  buffer_load_dwordx4 v26, s[4:7], s52 offen lds
  s_add_u32 m0, s33, 51712
  s_nop 0
  buffer_load_dwordx4 v27, s[4:7], s52 offen lds
  s_add_u32 m0, s33, 52736
  s_mov_b32 s52, 128
  buffer_load_dwordx4 v22, s[4:7], s52 offen lds
  s_add_u32 m0, s33, 53760
  s_nop 0
  buffer_load_dwordx4 v23, s[4:7], s52 offen lds
  s_add_u32 m0, s33, 84480
  s_mov_b32 s36, 0
  buffer_load_dwordx4 v16, s[16:19], s36 offen lds
  s_add_u32 m0, s33, 85536
  s_nop 0
  buffer_load_dwordx4 v17, s[16:19], s36 offen lds
  s_add_u32 m0, s33, 86592
  s_nop 0
  buffer_load_dwordx4 v18, s[16:19], s36 offen lds
  s_add_u32 m0, s33, 87648
  s_nop 0
  buffer_load_dwordx4 v19, s[16:19], s36 offen lds
  s_cmp_ge_u32 s56, 128
  s_cselect_b64 s[8:9], s[76:77], s[66:67]
  s_cselect_b64 s[12:13], s[78:79], s[68:69]
  s_cselect_b64 s[20:21], s[82:83], s[72:73]
  s_lshr_b32 s3, s56, 4
  s_lshl_b32 s61, s3, 8
  s_add_u32 s61, s61, 56623104
  s_add_u32 s44, s24, s61
  s_addc_u32 s45, s25, 0
  s_mov_b32 s46, 256
  s_mov_b32 s47, 0x20000
  s_lshl_b32 s70, s55, 4
  s_lshl_b32 s68, s32, 2
  s_add_u32 s68, s68, s70
  v_mov_b32 v46, 0
  v_mov_b32 v47, 152064
  ds_write_b32 v47, v46
  s_lshl_b32 s61, s3, 3
  s_add_u32 s48, s86, s61
  s_addc_u32 s49, s87, 0
  s_mov_b32 s50, 8
  s_mov_b32 s51, 0x20000
  s_getreg_b32 s54, hwreg(HW_REG_XCC_ID, 0, 3)
  s_lshl_b32 s59, s54, 3
  s_lshl_b64 s[62:63], 1, s59
  v_mov_b32 v46, s62
  v_mov_b32 v47, s63
  s_lshr_b32 s61, s55, 1
  s_lshl_b32 s61, s61, 9
  v_lshl_add_u32 v45, v0, 2, v40
  v_lshl_add_u32 v14, v45, 16, s61
  v_accvgpr_write_b32 a180, v46
  v_accvgpr_write_b32 a181, v47
  s_mul_i32 s61, s3, 3538944
  s_add_u32 s24, s24, s61
  s_addc_u32 s25, s25, 0
  s_mov_b64 s[40:41], s[24:25]
  s_mov_b32 s42, 3538944
  s_mov_b32 s43, 0x20000
  s_lshr_b32 s61, s68, 2
  s_mul_i32 s69, s61, 6144
  s_mul_i32 s64, s61, 24
  s_mov_b64 s[28:29], s[84:85]
  s_mov_b32 s30, 2752512
  s_mov_b32 s31, 0x20000
  s_mul_i32 s57, s60, 344064
  s_lshr_b32 s61, s3, 3
  s_mul_i32 s61, s61, 896
  s_add_u32 s57, s57, s61
  s_lshl_b32 s61, s55, 10
  s_add_u32 s24, s24, s61
  s_addc_u32 s25, s25, 0
  s_mov_b32 s26, 3523584
  s_mov_b32 s27, 0x20000
  s_and_b32 s61, s56, 127
  s_lshl_b32 s61, s61, 19
  s_add_u32 s8, s8, s61
  s_addc_u32 s9, s9, 0
  s_mov_b32 s10, 0x80000
  s_mov_b32 s11, 0x20000
  s_add_u32 s12, s12, s61
  s_addc_u32 s13, s13, 0
  s_mov_b32 s14, 0x80000
  s_mov_b32 s15, 0x20000
  s_mul_i32 s61, s55, 229376
  s_add_u32 s20, s20, s61
  s_addc_u32 s21, s21, 0
  s_mov_b32 s22, 229376
  s_mov_b32 s23, 0x20000
  s_mov_b32 s34, 0xfffff000
  s_mov_b32 s35, 0xffffb100
  s_mov_b32 s37, 0x3db8aa3b
  s_mov_b32 s38, 0x53800000
  s_mov_b32 s53, 0
  v_lshlrev_b32 v45, 4, v0
  v_lshl_add_u32 v1, v40, 10, v45
  v_lshrrev_b32 v46, 5, v0
  v_and_b32 v47, 1, v42
  v_lshl_add_u32 v46, v46, 5, v47
  v_lshl_add_u32 v46, v40, 1, v46
  v_lshlrev_b32 v47, 4, v44
  v_lshl_add_u32 v4, v46, 9, v47
  v_mul_u32_u24 v46, 98304, v40
  v_add_u32 v7, v46, v45
  v_lshl_add_u32 v45, v41, 2, v40
  v_mul_u32_u24 v45, 3584, v45
  v_lshl_add_u32 v2, v43, 4, v45
  v_mul_u32_u24 v45, 1056, v44
  v_lshl_add_u32 v3, v42, 4, v45
  v_lshrrev_b32 v45, 2, v0
  v_and_b32 v46, 3, v0
  v_mul_u32_u24 v45, 1056, v45
  v_lshl_add_u32 v5, v46, 3, v45
  v_lshl_add_u32 v20, v46, 4, v45
  v_cmp_eq_u32 vcc, 0, v46
  v_lshrrev_b32 v45, 1, v44
  v_xor_b32 v45, v45, v42
  v_lshlrev_b32 v45, 4, v45
  v_lshl_add_u32 v45, v44, 7, v45
  v_add_u32 v28, s33, v45
  v_xor_b32 v45, 64, v45
  v_add_u32 v29, s33, v45
  v_add_u32 v30, 50688, v28
  v_add_u32 v31, 50688, v29
  v_add_u32 v32, 101376, v28
  v_add_u32 v33, 101376, v29
  v_min_u32 v9, 47, v0
  v_lshlrev_b32 v9, 7, v9
  s_lshl_b32 s61, s60, 5
  v_lshl_add_u32 v47, v40, 3, v41
  v_add_u32 v47, s61, v47
  v_mul_u32_u24 v47, 896, v47
  v_min_u32 v48, 6, v43
  v_max_u32 v48, 5, v48
  v_lshl_add_u32 v13, v48, 7, v47
  v_mov_b32 v45, 0x3f803f80
  v_cndmask_b32 v45, 0, v45, vcc
  v_accvgpr_write_b32 a168, v45
  v_accvgpr_write_b32 a169, v45
  v_accvgpr_write_b32 a170, v45
  v_accvgpr_write_b32 a171, v45
  v_lshlrev_b32 v53, 2, v0
  v_lshl_add_u32 v52, v0, 8, s68
  v_add_u32 v45, s64, v44
  v_add3_u32 v46, s64, v43, 16
  v_lshrrev_b32 v47, 6, v45
  v_and_b32 v48, 63, v45
  v_lshl_add_u32 v47, v47, 4, v42
  v_lshl_add_u32 v47, v47, 6, v48
  v_lshlrev_b32 v54, 4, v47
  v_lshrrev_b32 v47, 6, v46
  v_and_b32 v48, 63, v46
  v_lshl_add_u32 v47, v47, 4, v41
  v_lshl_add_u32 v47, v47, 6, v48
  v_cmp_gt_u32 vcc, 32, v0
  v_lshlrev_b32 v55, 4, v47
  v_and_b32 v48, 40, v0
  v_cndmask_b32 v45, v46, v45, vcc
  v_cmp_eq_u32 vcc, 40, v48
  v_lshrrev_b32 v46, 7, v45
  v_and_b32 v47, 15, v45
  v_lshl_add_u32 v46, v46, 4, v47
  v_mul_u32_u24 v56, 1792, v46
  v_and_b32 v46, 64, v45
  v_add_u32 v56, v56, v46
  v_bfe_u32 v46, v45, 4, 2
  v_lshl_add_u32 v56, v46, 3, v56
  v_and_b32 v46, 1, v42
  v_lshl_add_u32 v56, v46, 5, v56
  v_mov_b32 v46, 0x10000000
  v_cndmask_b32 v56, v56, v46, vcc
  v_and_b32 v46, 1, v0
  v_lshlrev_b32 v46, 4, v46
  v_mov_b32 v47, 0x3f80
  v_lshlrev_b32 v46, v46, v47
  v_lshrrev_b32 v45, 1, v44
  v_accvgpr_write_b32 a192, v52
  v_accvgpr_write_b32 a193, v53
  v_accvgpr_write_b32 a194, v54
  v_accvgpr_write_b32 a195, v55
  v_accvgpr_write_b32 a196, v56
  v_cmp_eq_u32 s[76:77], 0, v45
  v_cmp_eq_u32 s[78:79], 1, v45
  v_cmp_eq_u32 s[80:81], 2, v45
  v_cmp_eq_u32 s[82:83], 3, v45
  v_cndmask_b32 v52, 0, v46, s[76:77]
  v_cndmask_b32 v53, 0, v46, s[78:79]
  v_cndmask_b32 v54, 0, v46, s[80:81]
  v_cndmask_b32 v55, 0, v46, s[82:83]
  v_accvgpr_write_b32 a172, v52
  v_accvgpr_write_b32 a173, v53
  v_accvgpr_write_b32 a174, v54
  v_accvgpr_write_b32 a175, v55
  v_cmp_eq_u32 s[76:77], 4, v45
  v_cmp_eq_u32 s[78:79], 5, v45
  v_cmp_eq_u32 s[80:81], 6, v45
  v_cmp_eq_u32 s[82:83], 7, v45
  v_cndmask_b32 v52, 0, v46, s[76:77]
  v_cndmask_b32 v53, 0, v46, s[78:79]
  v_cndmask_b32 v54, 0, v46, s[80:81]
  v_cndmask_b32 v55, 0, v46, s[82:83]
  v_accvgpr_write_b32 a176, v52
  v_accvgpr_write_b32 a177, v53
  v_accvgpr_write_b32 a178, v54
  v_accvgpr_write_b32 a179, v55
  s_mov_b32 s76, 16384
  s_mov_b32 s77, 32768
  s_mov_b32 s78, 49152
  s_mov_b32 s79, 65536
  s_mov_b32 s80, 81920
  s_mov_b32 s81, 4096
  s_mov_b32 s82, 8192
  s_mov_b32 s83, 12288
  s_add_u32 m0, s33, 101376
  s_mov_b32 s36, 256
  buffer_load_dwordx4 v16, s[16:19], s36 offen lds
  s_add_u32 m0, s33, 102432
  s_nop 0
  buffer_load_dwordx4 v17, s[16:19], s36 offen lds
  s_add_u32 m0, s33, 103488
  s_nop 0
  buffer_load_dwordx4 v18, s[16:19], s36 offen lds
  s_add_u32 m0, s33, 104544
  s_nop 0
  buffer_load_dwordx4 v19, s[16:19], s36 offen lds
  s_add_u32 m0, s33, 118272
  s_mov_b32 s52, 128
  buffer_load_dwordx4 v24, s[4:7], s52 offen lds
  s_add_u32 m0, s33, 119296
  s_nop 0
  buffer_load_dwordx4 v25, s[4:7], s52 offen lds
  s_add_u32 m0, s33, 120320
  s_nop 0
  buffer_load_dwordx4 v26, s[4:7], s52 offen lds
  s_add_u32 m0, s33, 121344
  s_nop 0
  buffer_load_dwordx4 v27, s[4:7], s52 offen lds
  s_cmp_eq_u32 s32, 0
  s_cbranch_scc1 L_hop0
  s_cmp_eq_u32 s32, 1
  s_cbranch_scc1 L_hop1
  s_cmp_eq_u32 s32, 2
  s_cbranch_scc1 L_hop2
  s_cmp_eq_u32 s32, 3
  s_cbranch_scc1 L_hop3
L_walked0:
  s_branch L_page0
.p2align 12
L_hop0:
  s_branch L_hop4
  s_nop 0
L_page0:
  s_waitcnt lgkmcnt(0)
  s_waitcnt vmcnt(8)
  s_barrier
  v_add_u32 v21, 84480, v20
  ds_read_b128 a[0:3], v30 offset:16896
  ds_read_b128 a[12:15], v31 offset:16896
  ds_read_b128 a[4:7], v30 offset:18944
  ds_read_b128 a[16:19], v31 offset:18944
  ds_read_b128 a[8:11], v30 offset:0
  ds_read_b128 a[20:23], v31 offset:0
  ds_read_b128 a[24:27], v30 offset:2048
  ds_read_b128 a[36:39], v31 offset:2048
  ds_read_b64_tr_b16 a[224:225], v21 offset:0
  ds_read_b64_tr_b16 a[226:227], v21 offset:256
  ds_read_b64_tr_b16 a[228:229], v21 offset:512
  ds_read_b64_tr_b16 a[230:231], v21 offset:768
  s_waitcnt lgkmcnt(4)
  ds_read_b64_tr_b16 a[232:233], v21 offset:8
  ds_read_b64_tr_b16 a[234:235], v21 offset:264
  ds_read_b64_tr_b16 a[236:237], v21 offset:520
  ds_read_b64_tr_b16 a[238:239], v21 offset:776
  ds_read_b64_tr_b16 a[240:241], v21 offset:64
  ds_read_b64_tr_b16 a[242:243], v21 offset:320
  ds_read_b64_tr_b16 a[244:245], v21 offset:576
  ds_read_b64_tr_b16 a[246:247], v21 offset:832
  s_waitcnt lgkmcnt(8)
  v_mfma_f32_16x16x32_bf16 v[64:67], a[224:227], a[0:3], 0
  ds_read_b64_tr_b16 a[248:249], v21 offset:72
  v_mfma_f32_16x16x32_bf16 v[64:67], a[228:231], a[12:15], v[64:67]
  ds_read_b64_tr_b16 a[250:251], v21 offset:328
  v_mfma_f32_16x16x32_bf16 v[72:75], a[228:231], a[16:19], 0
  s_add_u32 m0, s33, 16896
  s_mov_b32 s36, 524288
  v_mfma_f32_16x16x32_bf16 v[72:75], a[224:227], a[4:7], v[72:75]
  buffer_load_dwordx4 v16, s[16:19], s36 offen lds
  ds_read_b64_tr_b16 a[252:253], v21 offset:584
  v_mfma_f32_16x16x32_bf16 v[80:83], a[224:227], a[8:11], 0
  ds_read_b64_tr_b16 a[254:255], v21 offset:840
  v_mfma_f32_16x16x32_bf16 v[80:83], a[228:231], a[20:23], v[80:83]
  s_add_u32 m0, s33, 17952
  s_waitcnt lgkmcnt(8)
  v_mfma_f32_16x16x32_bf16 v[84:87], a[236:239], a[20:23], 0
  buffer_load_dwordx4 v17, s[16:19], s36 offen lds
  ds_read_b64_tr_b16 a[224:225], v21 offset:128
  v_mfma_f32_16x16x32_bf16 v[84:87], a[232:235], a[8:11], v[84:87]
  ds_read_b64_tr_b16 a[226:227], v21 offset:384
  v_mfma_f32_16x16x32_bf16 v[76:79], a[232:235], a[4:7], 0
  s_add_u32 m0, s33, 19008
  v_mfma_f32_16x16x32_bf16 v[76:79], a[236:239], a[16:19], v[76:79]
  buffer_load_dwordx4 v18, s[16:19], s36 offen lds
  ds_read_b64_tr_b16 a[228:229], v21 offset:640
  v_mfma_f32_16x16x32_bf16 v[68:71], a[236:239], a[12:15], 0
  ds_read_b64_tr_b16 a[230:231], v21 offset:896
  v_mfma_f32_16x16x32_bf16 v[68:71], a[232:235], a[0:3], v[68:71]
  s_add_u32 m0, s33, 20064
  s_waitcnt lgkmcnt(8)
  v_mfma_f32_16x16x32_bf16 v[88:91], a[240:243], a[0:3], 0
  buffer_load_dwordx4 v19, s[16:19], s36 offen lds
  ds_read_b64_tr_b16 a[232:233], v21 offset:136
  v_mfma_f32_16x16x32_bf16 v[88:91], a[244:247], a[12:15], v[88:91]
  ds_read_b64_tr_b16 a[234:235], v21 offset:392
  v_mfma_f32_16x16x32_bf16 v[96:99], a[244:247], a[16:19], 0
  s_add_u32 m0, s33, 135168
  s_mov_b32 s52, 256
  v_mfma_f32_16x16x32_bf16 v[96:99], a[240:243], a[4:7], v[96:99]
  buffer_load_dwordx4 v22, s[4:7], s52 offen lds
  ds_read_b64_tr_b16 a[236:237], v21 offset:648
  v_mfma_f32_16x16x32_bf16 v[104:107], a[240:243], a[8:11], 0
  ds_read_b64_tr_b16 a[238:239], v21 offset:904
  v_mfma_f32_16x16x32_bf16 v[104:107], a[244:247], a[20:23], v[104:107]
  s_add_u32 m0, s33, 136192
  s_waitcnt lgkmcnt(8)
  v_mfma_f32_16x16x32_bf16 v[108:111], a[252:255], a[20:23], 0
  buffer_load_dwordx4 v23, s[4:7], s52 offen lds
  ds_read_b64_tr_b16 a[240:241], v21 offset:192
  v_mfma_f32_16x16x32_bf16 v[108:111], a[248:251], a[8:11], v[108:111]
  ds_read_b64_tr_b16 a[242:243], v21 offset:448
  v_mfma_f32_16x16x32_bf16 v[100:103], a[248:251], a[4:7], 0
  s_add_u32 m0, s33, 137216
  v_mfma_f32_16x16x32_bf16 v[100:103], a[252:255], a[16:19], v[100:103]
  buffer_load_dwordx4 v24, s[4:7], s52 offen lds
  ds_read_b64_tr_b16 a[244:245], v21 offset:704
  v_mfma_f32_16x16x32_bf16 v[92:95], a[252:255], a[12:15], 0
  ds_read_b64_tr_b16 a[246:247], v21 offset:960
  v_mfma_f32_16x16x32_bf16 v[92:95], a[248:251], a[0:3], v[92:95]
  s_add_u32 m0, s33, 138240
  s_waitcnt lgkmcnt(8)
  v_mfma_f32_16x16x32_bf16 v[112:115], a[224:227], a[0:3], 0
  buffer_load_dwordx4 v25, s[4:7], s52 offen lds
  ds_read_b64_tr_b16 a[248:249], v21 offset:200
  v_mfma_f32_16x16x32_bf16 v[112:115], a[228:231], a[12:15], v[112:115]
  ds_read_b64_tr_b16 a[250:251], v21 offset:456
  v_mfma_f32_16x16x32_bf16 v[120:123], a[228:231], a[16:19], 0
  v_mfma_f32_16x16x32_bf16 v[120:123], a[224:227], a[4:7], v[120:123]
  ds_read_b64_tr_b16 a[252:253], v21 offset:712
  v_mfma_f32_16x16x32_bf16 v[128:131], a[224:227], a[8:11], 0
  ds_read_b64_tr_b16 a[254:255], v21 offset:968
  v_mfma_f32_16x16x32_bf16 v[128:131], a[228:231], a[20:23], v[128:131]
  s_waitcnt lgkmcnt(8)
  v_mfma_f32_16x16x32_bf16 v[132:135], a[236:239], a[20:23], 0
  s_waitcnt vmcnt(8)
  s_barrier
  v_mfma_f32_16x16x32_bf16 v[132:135], a[232:235], a[8:11], v[132:135]
  v_add_u32 v21, 101376, v20
  ds_read_b64_tr_b16 a[224:225], v21 offset:0
  v_mfma_f32_16x16x32_bf16 v[124:127], a[232:235], a[4:7], 0
  ds_read_b64_tr_b16 a[226:227], v21 offset:256
  s_add_u32 m0, s33, 33792
  s_mov_b32 s36, 524544
  v_mfma_f32_16x16x32_bf16 v[124:127], a[236:239], a[16:19], v[124:127]
  buffer_load_dwordx4 v16, s[16:19], s36 offen lds
  ds_read_b64_tr_b16 a[228:229], v21 offset:512
  v_mfma_f32_16x16x32_bf16 v[116:119], a[236:239], a[12:15], 0
  ds_read_b128 a[28:31], v32 offset:16896
  ds_read_b64_tr_b16 a[230:231], v21 offset:768
  v_mfma_f32_16x16x32_bf16 v[116:119], a[232:235], a[0:3], v[116:119]
  s_add_u32 m0, s33, 34848
  s_waitcnt lgkmcnt(9)
  v_mfma_f32_16x16x32_bf16 v[136:139], a[240:243], a[0:3], 0
  buffer_load_dwordx4 v17, s[16:19], s36 offen lds
  ds_read_b64_tr_b16 a[232:233], v21 offset:8
  v_mfma_f32_16x16x32_bf16 v[136:139], a[244:247], a[12:15], v[136:139]
  ds_read_b64_tr_b16 a[234:235], v21 offset:264
  v_mfma_f32_16x16x32_bf16 v[144:147], a[244:247], a[16:19], 0
  s_add_u32 m0, s33, 35904
  v_mfma_f32_16x16x32_bf16 v[144:147], a[240:243], a[4:7], v[144:147]
  buffer_load_dwordx4 v18, s[16:19], s36 offen lds
  ds_read_b64_tr_b16 a[236:237], v21 offset:520
  v_mfma_f32_16x16x32_bf16 v[152:155], a[240:243], a[8:11], 0
  ds_read_b128 a[40:43], v33 offset:16896
  ds_read_b64_tr_b16 a[238:239], v21 offset:776
  v_mfma_f32_16x16x32_bf16 v[152:155], a[244:247], a[20:23], v[152:155]
  s_add_u32 m0, s33, 36960
  s_waitcnt lgkmcnt(10)
  v_mfma_f32_16x16x32_bf16 v[156:159], a[252:255], a[20:23], 0
  buffer_load_dwordx4 v19, s[16:19], s36 offen lds
  ds_read_b64_tr_b16 a[240:241], v21 offset:64
  v_mfma_f32_16x16x32_bf16 v[156:159], a[248:251], a[8:11], v[156:159]
  ds_read_b64_tr_b16 a[242:243], v21 offset:320
  v_mfma_f32_16x16x32_bf16 v[148:151], a[248:251], a[4:7], 0
  s_add_u32 m0, s33, 0
  s_mov_b32 s52, 256
  v_mfma_f32_16x16x32_bf16 v[148:151], a[252:255], a[16:19], v[148:151]
  buffer_load_dwordx4 v26, s[4:7], s52 offen lds
  ds_read_b64_tr_b16 a[244:245], v21 offset:576
  v_mfma_f32_16x16x32_bf16 v[140:143], a[252:255], a[12:15], 0
  ds_read_b128 a[32:35], v32 offset:18944
  ds_read_b64_tr_b16 a[246:247], v21 offset:832
  v_mfma_f32_16x16x32_bf16 v[140:143], a[248:251], a[0:3], v[140:143]
  s_add_u32 m0, s33, 1024
  s_waitcnt lgkmcnt(10)
  v_mfma_f32_16x16x32_bf16 v[160:163], a[224:227], a[0:3], 0
  buffer_load_dwordx4 v27, s[4:7], s52 offen lds
  ds_read_b64_tr_b16 a[248:249], v21 offset:72
  v_mfma_f32_16x16x32_bf16 v[160:163], a[228:231], a[12:15], v[160:163]
  ds_read_b64_tr_b16 a[250:251], v21 offset:328
  v_mfma_f32_16x16x32_bf16 v[168:171], a[228:231], a[16:19], 0
  s_add_u32 m0, s33, 2048
  s_mov_b32 s52, 384
  v_mfma_f32_16x16x32_bf16 v[168:171], a[224:227], a[4:7], v[168:171]
  buffer_load_dwordx4 v22, s[4:7], s52 offen lds
  ds_read_b64_tr_b16 a[252:253], v21 offset:584
  v_mfma_f32_16x16x32_bf16 v[176:179], a[224:227], a[8:11], 0
  ds_read_b128 a[44:47], v33 offset:18944
  ds_read_b64_tr_b16 a[254:255], v21 offset:840
  v_mfma_f32_16x16x32_bf16 v[176:179], a[228:231], a[20:23], v[176:179]
  s_add_u32 m0, s33, 3072
  s_waitcnt lgkmcnt(10)
  v_mfma_f32_16x16x32_bf16 v[180:183], a[236:239], a[20:23], 0
  buffer_load_dwordx4 v23, s[4:7], s52 offen lds
  ds_read_b64_tr_b16 a[224:225], v21 offset:128
  v_mfma_f32_16x16x32_bf16 v[180:183], a[232:235], a[8:11], v[180:183]
  ds_read_b64_tr_b16 a[226:227], v21 offset:384
  v_mfma_f32_16x16x32_bf16 v[172:175], a[232:235], a[4:7], 0
  s_add_u32 m0, s33, 67584
  s_mov_b32 s71, 0
  v_mfma_f32_16x16x32_bf16 v[172:175], a[236:239], a[16:19], v[172:175]
  buffer_load_dwordx4 v2, s[20:23], s71 offen offset:0 lds
  ds_read_b64_tr_b16 a[228:229], v21 offset:640
  v_mfma_f32_16x16x32_bf16 v[164:167], a[236:239], a[12:15], 0
  ds_read_b64_tr_b16 a[230:231], v21 offset:896
  v_mfma_f32_16x16x32_bf16 v[164:167], a[232:235], a[0:3], v[164:167]
  s_add_u32 m0, s33, 67744
  s_waitcnt lgkmcnt(9)
  v_mfma_f32_16x16x32_bf16 v[184:187], a[240:243], a[0:3], 0
  buffer_load_dwordx4 v2, s[20:23], s71 offen offset:896 lds
  ds_read_b64_tr_b16 a[232:233], v21 offset:136
  v_mfma_f32_16x16x32_bf16 v[184:187], a[244:247], a[12:15], v[184:187]
  ds_read_b64_tr_b16 a[234:235], v21 offset:392
  v_mfma_f32_16x16x32_bf16 v[192:195], a[244:247], a[16:19], 0
  v_mfma_f32_16x16x32_bf16 v[192:195], a[240:243], a[4:7], v[192:195]
  ds_read_b64_tr_b16 a[236:237], v21 offset:648
  v_mfma_f32_16x16x32_bf16 v[200:203], a[240:243], a[8:11], 0
  ds_read_b64_tr_b16 a[238:239], v21 offset:904
  v_mfma_f32_16x16x32_bf16 v[200:203], a[244:247], a[20:23], v[200:203]
  s_waitcnt lgkmcnt(8)
  v_mfma_f32_16x16x32_bf16 v[204:207], a[252:255], a[20:23], 0
  ds_read_b64_tr_b16 a[240:241], v21 offset:192
  v_mfma_f32_16x16x32_bf16 v[204:207], a[248:251], a[8:11], v[204:207]
  ds_read_b64_tr_b16 a[242:243], v21 offset:448
  v_mfma_f32_16x16x32_bf16 v[196:199], a[248:251], a[4:7], 0
  v_mfma_f32_16x16x32_bf16 v[196:199], a[252:255], a[16:19], v[196:199]
  ds_read_b64_tr_b16 a[244:245], v21 offset:704
  v_mfma_f32_16x16x32_bf16 v[188:191], a[252:255], a[12:15], 0
  ds_read_b64_tr_b16 a[246:247], v21 offset:960
  v_mfma_f32_16x16x32_bf16 v[188:191], a[248:251], a[0:3], v[188:191]
  s_waitcnt lgkmcnt(8)
  v_mfma_f32_16x16x32_bf16 v[208:211], a[224:227], a[0:3], 0
  ds_read_b64_tr_b16 a[248:249], v21 offset:200
  v_mfma_f32_16x16x32_bf16 v[208:211], a[228:231], a[12:15], v[208:211]
  ds_read_b64_tr_b16 a[250:251], v21 offset:456
  v_mfma_f32_16x16x32_bf16 v[216:219], a[228:231], a[16:19], 0
  v_mfma_f32_16x16x32_bf16 v[216:219], a[224:227], a[4:7], v[216:219]
  ds_read_b64_tr_b16 a[252:253], v21 offset:712
  v_mfma_f32_16x16x32_bf16 v[224:227], a[224:227], a[8:11], 0
  ds_read_b64_tr_b16 a[254:255], v21 offset:968
  v_mfma_f32_16x16x32_bf16 v[224:227], a[228:231], a[20:23], v[224:227]
  s_waitcnt lgkmcnt(8)
  v_mfma_f32_16x16x32_bf16 v[228:231], a[236:239], a[20:23], 0
  s_waitcnt vmcnt(10)
  s_barrier
  v_mfma_f32_16x16x32_bf16 v[228:231], a[232:235], a[8:11], v[228:231]
  v_add_u32 v21, 16896, v20
  ds_read_b64_tr_b16 a[224:225], v21 offset:0
  v_mfma_f32_16x16x32_bf16 v[220:223], a[232:235], a[4:7], 0
  ds_read_b64_tr_b16 a[226:227], v21 offset:256
  s_add_u32 m0, s33, 50688
  s_mov_b32 s36, 1048576
  v_mfma_f32_16x16x32_bf16 v[220:223], a[236:239], a[16:19], v[220:223]
  buffer_load_dwordx4 v16, s[16:19], s36 offen lds
  ds_read_b64_tr_b16 a[228:229], v21 offset:512
  v_mfma_f32_16x16x32_bf16 v[212:215], a[236:239], a[12:15], 0
  ds_read_b128 a[48:51], v32 offset:33792
  ds_read_b64_tr_b16 a[230:231], v21 offset:768
  v_mfma_f32_16x16x32_bf16 v[212:215], a[232:235], a[0:3], v[212:215]
  s_add_u32 m0, s33, 51744
  s_waitcnt lgkmcnt(9)
  v_mfma_f32_16x16x32_bf16 v[232:235], a[240:243], a[0:3], 0
  buffer_load_dwordx4 v17, s[16:19], s36 offen lds
  ds_read_b64_tr_b16 a[232:233], v21 offset:8
  v_mfma_f32_16x16x32_bf16 v[232:235], a[244:247], a[12:15], v[232:235]
  ds_read_b64_tr_b16 a[234:235], v21 offset:264
  v_mfma_f32_16x16x32_bf16 v[240:243], a[244:247], a[16:19], 0
  s_add_u32 m0, s33, 52800
  v_mfma_f32_16x16x32_bf16 v[240:243], a[240:243], a[4:7], v[240:243]
  buffer_load_dwordx4 v18, s[16:19], s36 offen lds
  ds_read_b64_tr_b16 a[236:237], v21 offset:520
  v_mfma_f32_16x16x32_bf16 v[248:251], a[240:243], a[8:11], 0
  ds_read_b128 a[60:63], v33 offset:33792
  ds_read_b64_tr_b16 a[238:239], v21 offset:776
  v_mfma_f32_16x16x32_bf16 v[248:251], a[244:247], a[20:23], v[248:251]
  s_add_u32 m0, s33, 53856
  s_waitcnt lgkmcnt(10)
  v_mfma_f32_16x16x32_bf16 v[252:255], a[252:255], a[20:23], 0
  buffer_load_dwordx4 v19, s[16:19], s36 offen lds
  ds_read_b64_tr_b16 a[240:241], v21 offset:64
  v_mfma_f32_16x16x32_bf16 v[252:255], a[248:251], a[8:11], v[252:255]
  ds_read_b64_tr_b16 a[242:243], v21 offset:320
  v_mfma_f32_16x16x32_bf16 v[244:247], a[248:251], a[4:7], 0
  s_add_u32 m0, s33, 84480
  s_mov_b32 s52, 384
  v_mfma_f32_16x16x32_bf16 v[244:247], a[252:255], a[16:19], v[244:247]
  buffer_load_dwordx4 v24, s[4:7], s52 offen lds
  ds_read_b64_tr_b16 a[244:245], v21 offset:576
  v_mfma_f32_16x16x32_bf16 v[236:239], a[252:255], a[12:15], 0
  ds_read_b128 a[52:55], v32 offset:35840
  ds_read_b64_tr_b16 a[246:247], v21 offset:832
  v_mfma_f32_16x16x32_bf16 v[236:239], a[248:251], a[0:3], v[236:239]
  s_add_u32 m0, s33, 85504
  s_waitcnt lgkmcnt(10)
  v_mfma_f32_16x16x32_bf16 v[64:67], a[224:227], a[24:27], v[64:67]
  buffer_load_dwordx4 v25, s[4:7], s52 offen lds
  ds_read_b64_tr_b16 a[248:249], v21 offset:72
  v_mfma_f32_16x16x32_bf16 v[64:67], a[228:231], a[36:39], v[64:67]
  ds_read_b64_tr_b16 a[250:251], v21 offset:328
  v_mfma_f32_16x16x32_bf16 v[72:75], a[228:231], a[40:43], v[72:75]
  s_add_u32 m0, s33, 86528
  v_mfma_f32_16x16x32_bf16 v[72:75], a[224:227], a[28:31], v[72:75]
  buffer_load_dwordx4 v26, s[4:7], s52 offen lds
  ds_read_b64_tr_b16 a[252:253], v21 offset:584
  v_mfma_f32_16x16x32_bf16 v[80:83], a[224:227], a[32:35], v[80:83]
  ds_read_b128 a[64:67], v33 offset:35840
  ds_read_b64_tr_b16 a[254:255], v21 offset:840
  v_mfma_f32_16x16x32_bf16 v[80:83], a[228:231], a[44:47], v[80:83]
  s_add_u32 m0, s33, 87552
  s_waitcnt lgkmcnt(10)
  v_mfma_f32_16x16x32_bf16 v[84:87], a[236:239], a[44:47], v[84:87]
  buffer_load_dwordx4 v27, s[4:7], s52 offen lds
  ds_read_b64_tr_b16 a[224:225], v21 offset:128
  v_mfma_f32_16x16x32_bf16 v[84:87], a[232:235], a[32:35], v[84:87]
  ds_read_b64_tr_b16 a[226:227], v21 offset:384
  v_mfma_f32_16x16x32_bf16 v[76:79], a[232:235], a[28:31], v[76:79]
  s_add_u32 m0, s33, 67904
  v_mfma_f32_16x16x32_bf16 v[76:79], a[236:239], a[40:43], v[76:79]
  buffer_load_dwordx4 v2, s[20:23], s71 offen offset:1792 lds
  ds_read_b64_tr_b16 a[228:229], v21 offset:640
  v_mfma_f32_16x16x32_bf16 v[68:71], a[236:239], a[36:39], v[68:71]
  ds_read_b64_tr_b16 a[230:231], v21 offset:896
  v_mfma_f32_16x16x32_bf16 v[68:71], a[232:235], a[24:27], v[68:71]
  s_add_u32 m0, s33, 68064
  s_waitcnt lgkmcnt(9)
  v_mfma_f32_16x16x32_bf16 v[88:91], a[240:243], a[24:27], v[88:91]
  buffer_load_dwordx4 v2, s[20:23], s71 offen offset:2688 lds
  ds_read_b64_tr_b16 a[232:233], v21 offset:136
  v_mfma_f32_16x16x32_bf16 v[88:91], a[244:247], a[36:39], v[88:91]
  ds_read_b64_tr_b16 a[234:235], v21 offset:392
  v_mfma_f32_16x16x32_bf16 v[96:99], a[244:247], a[40:43], v[96:99]
  v_mfma_f32_16x16x32_bf16 v[96:99], a[240:243], a[28:31], v[96:99]
  ds_read_b64_tr_b16 a[236:237], v21 offset:648
  v_mfma_f32_16x16x32_bf16 v[104:107], a[240:243], a[32:35], v[104:107]
  ds_read_b64_tr_b16 a[238:239], v21 offset:904
  v_mfma_f32_16x16x32_bf16 v[104:107], a[244:247], a[44:47], v[104:107]
  s_waitcnt lgkmcnt(8)
  v_mfma_f32_16x16x32_bf16 v[108:111], a[252:255], a[44:47], v[108:111]
  ds_read_b64_tr_b16 a[240:241], v21 offset:192
  v_mfma_f32_16x16x32_bf16 v[108:111], a[248:251], a[32:35], v[108:111]
  ds_read_b64_tr_b16 a[242:243], v21 offset:448
  v_mfma_f32_16x16x32_bf16 v[100:103], a[248:251], a[28:31], v[100:103]
  v_mfma_f32_16x16x32_bf16 v[100:103], a[252:255], a[40:43], v[100:103]
  ds_read_b64_tr_b16 a[244:245], v21 offset:704
  v_mfma_f32_16x16x32_bf16 v[92:95], a[252:255], a[36:39], v[92:95]
  ds_read_b64_tr_b16 a[246:247], v21 offset:960
  v_mfma_f32_16x16x32_bf16 v[92:95], a[248:251], a[24:27], v[92:95]
  s_waitcnt lgkmcnt(8)
  v_mfma_f32_16x16x32_bf16 v[112:115], a[224:227], a[24:27], v[112:115]
  ds_read_b64_tr_b16 a[248:249], v21 offset:200
  v_mfma_f32_16x16x32_bf16 v[112:115], a[228:231], a[36:39], v[112:115]
  ds_read_b64_tr_b16 a[250:251], v21 offset:456
  v_mfma_f32_16x16x32_bf16 v[120:123], a[228:231], a[40:43], v[120:123]
  v_mfma_f32_16x16x32_bf16 v[120:123], a[224:227], a[28:31], v[120:123]
  ds_read_b64_tr_b16 a[252:253], v21 offset:712
  v_mfma_f32_16x16x32_bf16 v[128:131], a[224:227], a[32:35], v[128:131]
  ds_read_b64_tr_b16 a[254:255], v21 offset:968
  v_mfma_f32_16x16x32_bf16 v[128:131], a[228:231], a[44:47], v[128:131]
  s_waitcnt lgkmcnt(8)
  v_mfma_f32_16x16x32_bf16 v[132:135], a[236:239], a[44:47], v[132:135]
  s_waitcnt vmcnt(12)
  s_barrier
  v_mfma_f32_16x16x32_bf16 v[132:135], a[232:235], a[32:35], v[132:135]
  v_add_u32 v21, 33792, v20
  ds_read_b64_tr_b16 a[224:225], v21 offset:0
  v_mfma_f32_16x16x32_bf16 v[124:127], a[232:235], a[28:31], v[124:127]
  ds_read_b64_tr_b16 a[226:227], v21 offset:256
  s_add_u32 m0, s33, 118272
  s_mov_b32 s36, 1048832
  v_mfma_f32_16x16x32_bf16 v[124:127], a[236:239], a[40:43], v[124:127]
  buffer_load_dwordx4 v16, s[16:19], s36 offen lds
  ds_read_b64_tr_b16 a[228:229], v21 offset:512
  v_mfma_f32_16x16x32_bf16 v[116:119], a[236:239], a[36:39], v[116:119]
  ds_read_b128 a[56:59], v28 offset:0
  ds_read_b64_tr_b16 a[230:231], v21 offset:768
  v_mfma_f32_16x16x32_bf16 v[116:119], a[232:235], a[24:27], v[116:119]
  s_add_u32 m0, s33, 119328
  s_waitcnt lgkmcnt(9)
  v_mfma_f32_16x16x32_bf16 v[136:139], a[240:243], a[24:27], v[136:139]
  buffer_load_dwordx4 v17, s[16:19], s36 offen lds
  ds_read_b64_tr_b16 a[232:233], v21 offset:8
  v_mfma_f32_16x16x32_bf16 v[136:139], a[244:247], a[36:39], v[136:139]
  ds_read_b64_tr_b16 a[234:235], v21 offset:264
  v_mfma_f32_16x16x32_bf16 v[144:147], a[244:247], a[40:43], v[144:147]
  s_add_u32 m0, s33, 120384
  v_mfma_f32_16x16x32_bf16 v[144:147], a[240:243], a[28:31], v[144:147]
  buffer_load_dwordx4 v18, s[16:19], s36 offen lds
  ds_read_b64_tr_b16 a[236:237], v21 offset:520
  v_mfma_f32_16x16x32_bf16 v[152:155], a[240:243], a[32:35], v[152:155]
  ds_read_b128 a[68:71], v29 offset:0
  ds_read_b64_tr_b16 a[238:239], v21 offset:776
  v_mfma_f32_16x16x32_bf16 v[152:155], a[244:247], a[44:47], v[152:155]
  s_add_u32 m0, s33, 121440
  s_waitcnt lgkmcnt(10)
  v_mfma_f32_16x16x32_bf16 v[156:159], a[252:255], a[44:47], v[156:159]
  buffer_load_dwordx4 v19, s[16:19], s36 offen lds
  ds_read_b64_tr_b16 a[240:241], v21 offset:64
  v_mfma_f32_16x16x32_bf16 v[156:159], a[248:251], a[32:35], v[156:159]
  ds_read_b64_tr_b16 a[242:243], v21 offset:320
  v_mfma_f32_16x16x32_bf16 v[148:151], a[248:251], a[28:31], v[148:151]
  s_add_u32 m0, s33, 101376
  s_mov_b32 s52, 512
  v_mfma_f32_16x16x32_bf16 v[148:151], a[252:255], a[40:43], v[148:151]
  buffer_load_dwordx4 v22, s[4:7], s52 offen lds
  ds_read_b64_tr_b16 a[244:245], v21 offset:576
  v_mfma_f32_16x16x32_bf16 v[140:143], a[252:255], a[36:39], v[140:143]
  ds_read_b128 a[72:75], v28 offset:2048
  ds_read_b64_tr_b16 a[246:247], v21 offset:832
  v_mfma_f32_16x16x32_bf16 v[140:143], a[248:251], a[24:27], v[140:143]
  s_add_u32 m0, s33, 102400
  s_waitcnt lgkmcnt(10)
  v_mfma_f32_16x16x32_bf16 v[160:163], a[224:227], a[24:27], v[160:163]
  buffer_load_dwordx4 v23, s[4:7], s52 offen lds
  ds_read_b64_tr_b16 a[248:249], v21 offset:72
  v_mfma_f32_16x16x32_bf16 v[160:163], a[228:231], a[36:39], v[160:163]
  ds_read_b64_tr_b16 a[250:251], v21 offset:328
  v_mfma_f32_16x16x32_bf16 v[168:171], a[228:231], a[40:43], v[168:171]
  s_add_u32 m0, s33, 103424
  v_mfma_f32_16x16x32_bf16 v[168:171], a[224:227], a[28:31], v[168:171]
  buffer_load_dwordx4 v24, s[4:7], s52 offen lds
  ds_read_b64_tr_b16 a[252:253], v21 offset:584
  v_mfma_f32_16x16x32_bf16 v[176:179], a[224:227], a[32:35], v[176:179]
  ds_read_b128 a[84:87], v29 offset:2048
  ds_read_b64_tr_b16 a[254:255], v21 offset:840
  v_mfma_f32_16x16x32_bf16 v[176:179], a[228:231], a[44:47], v[176:179]
  s_add_u32 m0, s33, 104448
  s_waitcnt lgkmcnt(10)
  v_mfma_f32_16x16x32_bf16 v[180:183], a[236:239], a[44:47], v[180:183]
  buffer_load_dwordx4 v25, s[4:7], s52 offen lds
  ds_read_b64_tr_b16 a[224:225], v21 offset:128
  v_mfma_f32_16x16x32_bf16 v[180:183], a[232:235], a[32:35], v[180:183]
  ds_read_b64_tr_b16 a[226:227], v21 offset:384
  v_mfma_f32_16x16x32_bf16 v[172:175], a[232:235], a[28:31], v[172:175]
  s_add_u32 m0, s33, 135168
  s_mov_b32 s71, 114688
  v_mfma_f32_16x16x32_bf16 v[172:175], a[236:239], a[40:43], v[172:175]
  buffer_load_dwordx4 v2, s[20:23], s71 offen offset:0 lds
  ds_read_b64_tr_b16 a[228:229], v21 offset:640
  v_mfma_f32_16x16x32_bf16 v[164:167], a[236:239], a[36:39], v[164:167]
  ds_read_b64_tr_b16 a[230:231], v21 offset:896
  v_mfma_f32_16x16x32_bf16 v[164:167], a[232:235], a[24:27], v[164:167]
  s_add_u32 m0, s33, 135328
  s_waitcnt lgkmcnt(9)
  v_mfma_f32_16x16x32_bf16 v[184:187], a[240:243], a[24:27], v[184:187]
  buffer_load_dwordx4 v2, s[20:23], s71 offen offset:896 lds
  ds_read_b64_tr_b16 a[232:233], v21 offset:136
  v_mfma_f32_16x16x32_bf16 v[184:187], a[244:247], a[36:39], v[184:187]
  ds_read_b64_tr_b16 a[234:235], v21 offset:392
  v_mfma_f32_16x16x32_bf16 v[192:195], a[244:247], a[40:43], v[192:195]
  v_mfma_f32_16x16x32_bf16 v[192:195], a[240:243], a[28:31], v[192:195]
  ds_read_b64_tr_b16 a[236:237], v21 offset:648
  v_mfma_f32_16x16x32_bf16 v[200:203], a[240:243], a[32:35], v[200:203]
  ds_read_b64_tr_b16 a[238:239], v21 offset:904
  v_mfma_f32_16x16x32_bf16 v[200:203], a[244:247], a[44:47], v[200:203]
  s_waitcnt lgkmcnt(8)
  v_mfma_f32_16x16x32_bf16 v[204:207], a[252:255], a[44:47], v[204:207]
  ds_read_b64_tr_b16 a[240:241], v21 offset:192
  v_mfma_f32_16x16x32_bf16 v[204:207], a[248:251], a[32:35], v[204:207]
  ds_read_b64_tr_b16 a[242:243], v21 offset:448
  v_mfma_f32_16x16x32_bf16 v[196:199], a[248:251], a[28:31], v[196:199]
  v_mfma_f32_16x16x32_bf16 v[196:199], a[252:255], a[40:43], v[196:199]
  ds_read_b64_tr_b16 a[244:245], v21 offset:704
  v_mfma_f32_16x16x32_bf16 v[188:191], a[252:255], a[36:39], v[188:191]
  ds_read_b64_tr_b16 a[246:247], v21 offset:960
  v_mfma_f32_16x16x32_bf16 v[188:191], a[248:251], a[24:27], v[188:191]
  s_waitcnt lgkmcnt(8)
  v_mfma_f32_16x16x32_bf16 v[208:211], a[224:227], a[24:27], v[208:211]
  ds_read_b64_tr_b16 a[248:249], v21 offset:200
  v_mfma_f32_16x16x32_bf16 v[208:211], a[228:231], a[36:39], v[208:211]
  ds_read_b64_tr_b16 a[250:251], v21 offset:456
  v_mfma_f32_16x16x32_bf16 v[216:219], a[228:231], a[40:43], v[216:219]
  v_mfma_f32_16x16x32_bf16 v[216:219], a[224:227], a[28:31], v[216:219]
  ds_read_b64_tr_b16 a[252:253], v21 offset:712
  v_mfma_f32_16x16x32_bf16 v[224:227], a[224:227], a[32:35], v[224:227]
  ds_read_b64_tr_b16 a[254:255], v21 offset:968
  v_mfma_f32_16x16x32_bf16 v[224:227], a[228:231], a[44:47], v[224:227]
  s_waitcnt lgkmcnt(8)
  v_mfma_f32_16x16x32_bf16 v[228:231], a[236:239], a[44:47], v[228:231]
  s_waitcnt vmcnt(12)
  s_barrier
  v_mfma_f32_16x16x32_bf16 v[228:231], a[232:235], a[32:35], v[228:231]
  v_add_u32 v21, 50688, v20
  ds_read_b64_tr_b16 a[224:225], v21 offset:0
  v_mfma_f32_16x16x32_bf16 v[220:223], a[232:235], a[28:31], v[220:223]
  ds_read_b64_tr_b16 a[226:227], v21 offset:256
  s_add_u32 m0, s33, 16896
  s_mov_b32 s36, 1572864
  v_mfma_f32_16x16x32_bf16 v[220:223], a[236:239], a[40:43], v[220:223]
  buffer_load_dwordx4 v16, s[16:19], s36 offen lds
  ds_read_b64_tr_b16 a[228:229], v21 offset:512
  v_mfma_f32_16x16x32_bf16 v[212:215], a[236:239], a[36:39], v[212:215]
  ds_read_b128 a[76:79], v30 offset:33792
  ds_read_b64_tr_b16 a[230:231], v21 offset:768
  v_mfma_f32_16x16x32_bf16 v[212:215], a[232:235], a[24:27], v[212:215]
  s_add_u32 m0, s33, 17952
  s_waitcnt lgkmcnt(9)
  v_mfma_f32_16x16x32_bf16 v[232:235], a[240:243], a[24:27], v[232:235]
  buffer_load_dwordx4 v17, s[16:19], s36 offen lds
  ds_read_b64_tr_b16 a[232:233], v21 offset:8
  v_mfma_f32_16x16x32_bf16 v[232:235], a[244:247], a[36:39], v[232:235]
  ds_read_b64_tr_b16 a[234:235], v21 offset:264
  v_mfma_f32_16x16x32_bf16 v[240:243], a[244:247], a[40:43], v[240:243]
  s_add_u32 m0, s33, 19008
  v_mfma_f32_16x16x32_bf16 v[240:243], a[240:243], a[28:31], v[240:243]
  buffer_load_dwordx4 v18, s[16:19], s36 offen lds
  ds_read_b64_tr_b16 a[236:237], v21 offset:520
  v_mfma_f32_16x16x32_bf16 v[248:251], a[240:243], a[32:35], v[248:251]
  ds_read_b128 a[88:91], v31 offset:33792
  ds_read_b64_tr_b16 a[238:239], v21 offset:776
  v_mfma_f32_16x16x32_bf16 v[248:251], a[244:247], a[44:47], v[248:251]
  s_add_u32 m0, s33, 20064
  s_waitcnt lgkmcnt(10)
  v_mfma_f32_16x16x32_bf16 v[252:255], a[252:255], a[44:47], v[252:255]
  buffer_load_dwordx4 v19, s[16:19], s36 offen lds
  ds_read_b64_tr_b16 a[240:241], v21 offset:64
  v_mfma_f32_16x16x32_bf16 v[252:255], a[248:251], a[32:35], v[252:255]
  ds_read_b64_tr_b16 a[242:243], v21 offset:320
  v_mfma_f32_16x16x32_bf16 v[244:247], a[248:251], a[28:31], v[244:247]
  s_add_u32 m0, s33, 0
  s_mov_b32 s52, 512
  v_mfma_f32_16x16x32_bf16 v[244:247], a[252:255], a[40:43], v[244:247]
  buffer_load_dwordx4 v26, s[4:7], s52 offen lds
  ds_read_b64_tr_b16 a[244:245], v21 offset:576
  v_mfma_f32_16x16x32_bf16 v[236:239], a[252:255], a[36:39], v[236:239]
  ds_read_b128 a[80:83], v30 offset:35840
  ds_read_b64_tr_b16 a[246:247], v21 offset:832
  v_mfma_f32_16x16x32_bf16 v[236:239], a[248:251], a[24:27], v[236:239]
  s_add_u32 m0, s33, 1024
  s_waitcnt lgkmcnt(10)
  v_mfma_f32_16x16x32_bf16 v[64:67], a[224:227], a[48:51], v[64:67]
  buffer_load_dwordx4 v27, s[4:7], s52 offen lds
  ds_read_b64_tr_b16 a[248:249], v21 offset:72
  v_mfma_f32_16x16x32_bf16 v[64:67], a[228:231], a[60:63], v[64:67]
  ds_read_b64_tr_b16 a[250:251], v21 offset:328
  v_mfma_f32_16x16x32_bf16 v[72:75], a[228:231], a[64:67], v[72:75]
  s_add_u32 m0, s33, 2048
  s_mov_b32 s52, 640
  v_mfma_f32_16x16x32_bf16 v[72:75], a[224:227], a[52:55], v[72:75]
  buffer_load_dwordx4 v22, s[4:7], s52 offen lds
  ds_read_b64_tr_b16 a[252:253], v21 offset:584
  v_mfma_f32_16x16x32_bf16 v[80:83], a[224:227], a[56:59], v[80:83]
  ds_read_b128 a[92:95], v31 offset:35840
  ds_read_b64_tr_b16 a[254:255], v21 offset:840
  v_mfma_f32_16x16x32_bf16 v[80:83], a[228:231], a[68:71], v[80:83]
  s_add_u32 m0, s33, 3072
  s_waitcnt lgkmcnt(10)
  v_mfma_f32_16x16x32_bf16 v[84:87], a[236:239], a[68:71], v[84:87]
  buffer_load_dwordx4 v23, s[4:7], s52 offen lds
  ds_read_b64_tr_b16 a[224:225], v21 offset:128
  v_mfma_f32_16x16x32_bf16 v[84:87], a[232:235], a[56:59], v[84:87]
  ds_read_b64_tr_b16 a[226:227], v21 offset:384
  v_mfma_f32_16x16x32_bf16 v[76:79], a[232:235], a[52:55], v[76:79]
  s_add_u32 m0, s33, 135488
  v_mfma_f32_16x16x32_bf16 v[76:79], a[236:239], a[64:67], v[76:79]
  buffer_load_dwordx4 v2, s[20:23], s71 offen offset:1792 lds
  ds_read_b64_tr_b16 a[228:229], v21 offset:640
  v_mfma_f32_16x16x32_bf16 v[68:71], a[236:239], a[60:63], v[68:71]
  ds_read_b64_tr_b16 a[230:231], v21 offset:896
  v_mfma_f32_16x16x32_bf16 v[68:71], a[232:235], a[48:51], v[68:71]
  s_branch L_page1
.p2align 12
L_hop1:
  s_branch L_hop5
  s_nop 0
L_page1:
  s_add_u32 m0, s33, 135648
  s_waitcnt lgkmcnt(9)
  v_mfma_f32_16x16x32_bf16 v[88:91], a[240:243], a[48:51], v[88:91]
  buffer_load_dwordx4 v2, s[20:23], s71 offen offset:2688 lds
  ds_read_b64_tr_b16 a[232:233], v21 offset:136
  v_mfma_f32_16x16x32_bf16 v[88:91], a[244:247], a[60:63], v[88:91]
  ds_read_b64_tr_b16 a[234:235], v21 offset:392
  v_mfma_f32_16x16x32_bf16 v[96:99], a[244:247], a[64:67], v[96:99]
  v_mfma_f32_16x16x32_bf16 v[96:99], a[240:243], a[52:55], v[96:99]
  ds_read_b64_tr_b16 a[236:237], v21 offset:648
  v_mfma_f32_16x16x32_bf16 v[104:107], a[240:243], a[56:59], v[104:107]
  ds_read_b64_tr_b16 a[238:239], v21 offset:904
  v_mfma_f32_16x16x32_bf16 v[104:107], a[244:247], a[68:71], v[104:107]
  s_waitcnt lgkmcnt(8)
  v_mfma_f32_16x16x32_bf16 v[108:111], a[252:255], a[68:71], v[108:111]
  ds_read_b64_tr_b16 a[240:241], v21 offset:192
  v_mfma_f32_16x16x32_bf16 v[108:111], a[248:251], a[56:59], v[108:111]
  ds_read_b64_tr_b16 a[242:243], v21 offset:448
  v_mfma_f32_16x16x32_bf16 v[100:103], a[248:251], a[52:55], v[100:103]
  v_mfma_f32_16x16x32_bf16 v[100:103], a[252:255], a[64:67], v[100:103]
  ds_read_b64_tr_b16 a[244:245], v21 offset:704
  v_mfma_f32_16x16x32_bf16 v[92:95], a[252:255], a[60:63], v[92:95]
  ds_read_b64_tr_b16 a[246:247], v21 offset:960
  v_mfma_f32_16x16x32_bf16 v[92:95], a[248:251], a[48:51], v[92:95]
  s_waitcnt lgkmcnt(8)
  v_mfma_f32_16x16x32_bf16 v[112:115], a[224:227], a[48:51], v[112:115]
  ds_read_b64_tr_b16 a[248:249], v21 offset:200
  v_mfma_f32_16x16x32_bf16 v[112:115], a[228:231], a[60:63], v[112:115]
  ds_read_b64_tr_b16 a[250:251], v21 offset:456
  v_mfma_f32_16x16x32_bf16 v[120:123], a[228:231], a[64:67], v[120:123]
  v_mfma_f32_16x16x32_bf16 v[120:123], a[224:227], a[52:55], v[120:123]
  ds_read_b64_tr_b16 a[252:253], v21 offset:712
  v_mfma_f32_16x16x32_bf16 v[128:131], a[224:227], a[56:59], v[128:131]
  ds_read_b64_tr_b16 a[254:255], v21 offset:968
  v_mfma_f32_16x16x32_bf16 v[128:131], a[228:231], a[68:71], v[128:131]
  s_waitcnt lgkmcnt(8)
  v_mfma_f32_16x16x32_bf16 v[132:135], a[236:239], a[68:71], v[132:135]
  s_waitcnt vmcnt(12)
  s_barrier
  v_mfma_f32_16x16x32_bf16 v[132:135], a[232:235], a[56:59], v[132:135]
  v_add_u32 v21, 118272, v20
  ds_read_b64_tr_b16 a[224:225], v21 offset:0
  v_mfma_f32_16x16x32_bf16 v[124:127], a[232:235], a[52:55], v[124:127]
  ds_read_b64_tr_b16 a[226:227], v21 offset:256
  s_add_u32 m0, s33, 33792
  s_mov_b32 s36, 2097152
  v_mfma_f32_16x16x32_bf16 v[124:127], a[236:239], a[64:67], v[124:127]
  buffer_load_dwordx4 v16, s[16:19], s36 offen lds
  ds_read_b64_tr_b16 a[228:229], v21 offset:512
  v_mfma_f32_16x16x32_bf16 v[116:119], a[236:239], a[60:63], v[116:119]
  ds_read_b128 a[96:99], v32 offset:0
  ds_read_b64_tr_b16 a[230:231], v21 offset:768
  v_mfma_f32_16x16x32_bf16 v[116:119], a[232:235], a[48:51], v[116:119]
  s_add_u32 m0, s33, 34848
  s_waitcnt lgkmcnt(9)
  v_mfma_f32_16x16x32_bf16 v[136:139], a[240:243], a[48:51], v[136:139]
  buffer_load_dwordx4 v17, s[16:19], s36 offen lds
  ds_read_b64_tr_b16 a[232:233], v21 offset:8
  v_mfma_f32_16x16x32_bf16 v[136:139], a[244:247], a[60:63], v[136:139]
  ds_read_b64_tr_b16 a[234:235], v21 offset:264
  v_mfma_f32_16x16x32_bf16 v[144:147], a[244:247], a[64:67], v[144:147]
  s_add_u32 m0, s33, 35904
  v_mfma_f32_16x16x32_bf16 v[144:147], a[240:243], a[52:55], v[144:147]
  buffer_load_dwordx4 v18, s[16:19], s36 offen lds
  ds_read_b64_tr_b16 a[236:237], v21 offset:520
  v_mfma_f32_16x16x32_bf16 v[152:155], a[240:243], a[56:59], v[152:155]
  ds_read_b128 a[108:111], v33 offset:0
  ds_read_b64_tr_b16 a[238:239], v21 offset:776
  v_mfma_f32_16x16x32_bf16 v[152:155], a[244:247], a[68:71], v[152:155]
  s_add_u32 m0, s33, 36960
  s_waitcnt lgkmcnt(10)
  v_mfma_f32_16x16x32_bf16 v[156:159], a[252:255], a[68:71], v[156:159]
  buffer_load_dwordx4 v19, s[16:19], s36 offen lds
  ds_read_b64_tr_b16 a[240:241], v21 offset:64
  v_mfma_f32_16x16x32_bf16 v[156:159], a[248:251], a[56:59], v[156:159]
  ds_read_b64_tr_b16 a[242:243], v21 offset:320
  v_mfma_f32_16x16x32_bf16 v[148:151], a[248:251], a[52:55], v[148:151]
  s_add_u32 m0, s33, 84480
  s_mov_b32 s52, 640
  v_mfma_f32_16x16x32_bf16 v[148:151], a[252:255], a[64:67], v[148:151]
  buffer_load_dwordx4 v24, s[4:7], s52 offen lds
  ds_read_b64_tr_b16 a[244:245], v21 offset:576
  v_mfma_f32_16x16x32_bf16 v[140:143], a[252:255], a[60:63], v[140:143]
  ds_read_b128 a[100:103], v32 offset:2048
  ds_read_b64_tr_b16 a[246:247], v21 offset:832
  v_mfma_f32_16x16x32_bf16 v[140:143], a[248:251], a[48:51], v[140:143]
  s_add_u32 m0, s33, 85504
  s_waitcnt lgkmcnt(10)
  v_mfma_f32_16x16x32_bf16 v[160:163], a[224:227], a[48:51], v[160:163]
  buffer_load_dwordx4 v25, s[4:7], s52 offen lds
  ds_read_b64_tr_b16 a[248:249], v21 offset:72
  v_mfma_f32_16x16x32_bf16 v[160:163], a[228:231], a[60:63], v[160:163]
  ds_read_b64_tr_b16 a[250:251], v21 offset:328
  v_mfma_f32_16x16x32_bf16 v[168:171], a[228:231], a[64:67], v[168:171]
  s_add_u32 m0, s33, 86528
  v_mfma_f32_16x16x32_bf16 v[168:171], a[224:227], a[52:55], v[168:171]
  buffer_load_dwordx4 v26, s[4:7], s52 offen lds
  ds_read_b64_tr_b16 a[252:253], v21 offset:584
  v_mfma_f32_16x16x32_bf16 v[176:179], a[224:227], a[56:59], v[176:179]
  ds_read_b128 a[112:115], v33 offset:2048
  ds_read_b64_tr_b16 a[254:255], v21 offset:840
  v_mfma_f32_16x16x32_bf16 v[176:179], a[228:231], a[68:71], v[176:179]
  s_add_u32 m0, s33, 87552
  s_waitcnt lgkmcnt(10)
  v_mfma_f32_16x16x32_bf16 v[180:183], a[236:239], a[68:71], v[180:183]
  buffer_load_dwordx4 v27, s[4:7], s52 offen lds
  ds_read_b64_tr_b16 a[224:225], v21 offset:128
  v_mfma_f32_16x16x32_bf16 v[180:183], a[232:235], a[56:59], v[180:183]
  ds_read_b64_tr_b16 a[226:227], v21 offset:384
  v_mfma_f32_16x16x32_bf16 v[172:175], a[232:235], a[52:55], v[172:175]
  v_mfma_f32_16x16x32_bf16 v[172:175], a[236:239], a[64:67], v[172:175]
  ds_read_b64_tr_b16 a[228:229], v21 offset:640
  v_mfma_f32_16x16x32_bf16 v[164:167], a[236:239], a[60:63], v[164:167]
  ds_read_b64_tr_b16 a[230:231], v21 offset:896
  v_mfma_f32_16x16x32_bf16 v[164:167], a[232:235], a[48:51], v[164:167]
  s_waitcnt lgkmcnt(9)
  v_mfma_f32_16x16x32_bf16 v[184:187], a[240:243], a[48:51], v[184:187]
  ds_read_b64_tr_b16 a[232:233], v21 offset:136
  v_mfma_f32_16x16x32_bf16 v[184:187], a[244:247], a[60:63], v[184:187]
  ds_read_b64_tr_b16 a[234:235], v21 offset:392
  v_mfma_f32_16x16x32_bf16 v[192:195], a[244:247], a[64:67], v[192:195]
  v_mfma_f32_16x16x32_bf16 v[192:195], a[240:243], a[52:55], v[192:195]
  ds_read_b64_tr_b16 a[236:237], v21 offset:648
  v_mfma_f32_16x16x32_bf16 v[200:203], a[240:243], a[56:59], v[200:203]
  ds_read_b64_tr_b16 a[238:239], v21 offset:904
  v_mfma_f32_16x16x32_bf16 v[200:203], a[244:247], a[68:71], v[200:203]
  s_waitcnt lgkmcnt(8)
  v_mfma_f32_16x16x32_bf16 v[204:207], a[252:255], a[68:71], v[204:207]
  ds_read_b64_tr_b16 a[240:241], v21 offset:192
  v_mfma_f32_16x16x32_bf16 v[204:207], a[248:251], a[56:59], v[204:207]
  ds_read_b64_tr_b16 a[242:243], v21 offset:448
  v_mfma_f32_16x16x32_bf16 v[196:199], a[248:251], a[52:55], v[196:199]
  buffer_load_dword a182, v13, s[20:23], 0 offen
  v_mfma_f32_16x16x32_bf16 v[196:199], a[252:255], a[64:67], v[196:199]
  ds_read_b64_tr_b16 a[244:245], v21 offset:704
  v_mfma_f32_16x16x32_bf16 v[188:191], a[252:255], a[60:63], v[188:191]
  ds_read_b64_tr_b16 a[246:247], v21 offset:960
  v_mfma_f32_16x16x32_bf16 v[188:191], a[248:251], a[48:51], v[188:191]
  s_waitcnt lgkmcnt(8)
  v_mfma_f32_16x16x32_bf16 v[208:211], a[224:227], a[48:51], v[208:211]
  ds_read_b64_tr_b16 a[248:249], v21 offset:200
  v_mfma_f32_16x16x32_bf16 v[208:211], a[228:231], a[60:63], v[208:211]
  ds_read_b64_tr_b16 a[250:251], v21 offset:456
  v_mfma_f32_16x16x32_bf16 v[216:219], a[228:231], a[64:67], v[216:219]
  v_mfma_f32_16x16x32_bf16 v[216:219], a[224:227], a[52:55], v[216:219]
  ds_read_b64_tr_b16 a[252:253], v21 offset:712
  v_mfma_f32_16x16x32_bf16 v[224:227], a[224:227], a[56:59], v[224:227]
  ds_read_b64_tr_b16 a[254:255], v21 offset:968
  v_mfma_f32_16x16x32_bf16 v[224:227], a[228:231], a[68:71], v[224:227]
  s_waitcnt lgkmcnt(8)
  v_mfma_f32_16x16x32_bf16 v[228:231], a[236:239], a[68:71], v[228:231]
  s_waitcnt vmcnt(11)
  s_barrier
  v_mfma_f32_16x16x32_bf16 v[228:231], a[232:235], a[56:59], v[228:231]
  v_add_u32 v21, 16896, v20
  ds_read_b64_tr_b16 a[224:225], v21 offset:0
  v_mfma_f32_16x16x32_bf16 v[220:223], a[232:235], a[52:55], v[220:223]
  ds_read_b64_tr_b16 a[226:227], v21 offset:256
  s_add_u32 m0, s33, 50688
  s_mov_b32 s36, 2621440
  v_mfma_f32_16x16x32_bf16 v[220:223], a[236:239], a[64:67], v[220:223]
  buffer_load_dwordx4 v16, s[16:19], s36 offen lds
  ds_read_b64_tr_b16 a[228:229], v21 offset:512
  v_mfma_f32_16x16x32_bf16 v[212:215], a[236:239], a[60:63], v[212:215]
  ds_read_b128 a[104:107], v28 offset:0
  ds_read_b64_tr_b16 a[230:231], v21 offset:768
  v_mfma_f32_16x16x32_bf16 v[212:215], a[232:235], a[48:51], v[212:215]
  s_add_u32 m0, s33, 51744
  s_waitcnt lgkmcnt(9)
  v_mfma_f32_16x16x32_bf16 v[232:235], a[240:243], a[48:51], v[232:235]
  buffer_load_dwordx4 v17, s[16:19], s36 offen lds
  ds_read_b64_tr_b16 a[232:233], v21 offset:8
  v_mfma_f32_16x16x32_bf16 v[232:235], a[244:247], a[60:63], v[232:235]
  ds_read_b64_tr_b16 a[234:235], v21 offset:264
  v_mfma_f32_16x16x32_bf16 v[240:243], a[244:247], a[64:67], v[240:243]
  s_add_u32 m0, s33, 52800
  v_mfma_f32_16x16x32_bf16 v[240:243], a[240:243], a[52:55], v[240:243]
  buffer_load_dwordx4 v18, s[16:19], s36 offen lds
  ds_read_b64_tr_b16 a[236:237], v21 offset:520
  v_mfma_f32_16x16x32_bf16 v[248:251], a[240:243], a[56:59], v[248:251]
  ds_read_b128 a[116:119], v29 offset:0
  ds_read_b64_tr_b16 a[238:239], v21 offset:776
  v_mfma_f32_16x16x32_bf16 v[248:251], a[244:247], a[68:71], v[248:251]
  s_add_u32 m0, s33, 53856
  s_waitcnt lgkmcnt(10)
  v_mfma_f32_16x16x32_bf16 v[252:255], a[252:255], a[68:71], v[252:255]
  buffer_load_dwordx4 v19, s[16:19], s36 offen lds
  ds_read_b64_tr_b16 a[240:241], v21 offset:64
  v_mfma_f32_16x16x32_bf16 v[252:255], a[248:251], a[56:59], v[252:255]
  ds_read_b64_tr_b16 a[242:243], v21 offset:320
  v_mfma_f32_16x16x32_bf16 v[244:247], a[248:251], a[52:55], v[244:247]
  s_add_u32 m0, s33, 101376
  s_mov_b32 s52, 768
  v_mfma_f32_16x16x32_bf16 v[244:247], a[252:255], a[64:67], v[244:247]
  buffer_load_dwordx4 v22, s[4:7], s52 offen lds
  ds_read_b64_tr_b16 a[244:245], v21 offset:576
  v_mfma_f32_16x16x32_bf16 v[236:239], a[252:255], a[60:63], v[236:239]
  ds_read_b128 a[120:123], v28 offset:2048
  ds_read_b64_tr_b16 a[246:247], v21 offset:832
  v_mfma_f32_16x16x32_bf16 v[236:239], a[248:251], a[48:51], v[236:239]
  s_add_u32 m0, s33, 102400
  s_waitcnt lgkmcnt(10)
  v_mfma_f32_16x16x32_bf16 v[64:67], a[224:227], a[72:75], v[64:67]
  buffer_load_dwordx4 v23, s[4:7], s52 offen lds
  ds_read_b64_tr_b16 a[248:249], v21 offset:72
  v_mfma_f32_16x16x32_bf16 v[64:67], a[228:231], a[84:87], v[64:67]
  ds_read_b64_tr_b16 a[250:251], v21 offset:328
  v_mfma_f32_16x16x32_bf16 v[72:75], a[228:231], a[88:91], v[72:75]
  s_add_u32 m0, s33, 103424
  v_mfma_f32_16x16x32_bf16 v[72:75], a[224:227], a[76:79], v[72:75]
  buffer_load_dwordx4 v24, s[4:7], s52 offen lds
  ds_read_b64_tr_b16 a[252:253], v21 offset:584
  v_mfma_f32_16x16x32_bf16 v[80:83], a[224:227], a[80:83], v[80:83]
  ds_read_b128 a[132:135], v29 offset:2048
  ds_read_b64_tr_b16 a[254:255], v21 offset:840
  v_mfma_f32_16x16x32_bf16 v[80:83], a[228:231], a[92:95], v[80:83]
  s_add_u32 m0, s33, 104448
  s_waitcnt lgkmcnt(10)
  v_mfma_f32_16x16x32_bf16 v[84:87], a[236:239], a[92:95], v[84:87]
  buffer_load_dwordx4 v25, s[4:7], s52 offen lds
  ds_read_b64_tr_b16 a[224:225], v21 offset:128
  v_mfma_f32_16x16x32_bf16 v[84:87], a[232:235], a[80:83], v[84:87]
  ds_read_b64_tr_b16 a[226:227], v21 offset:384
  v_mfma_f32_16x16x32_bf16 v[76:79], a[232:235], a[76:79], v[76:79]
  v_mfma_f32_16x16x32_bf16 v[76:79], a[236:239], a[88:91], v[76:79]
  ds_read_b64_tr_b16 a[228:229], v21 offset:640
  v_mfma_f32_16x16x32_bf16 v[68:71], a[236:239], a[84:87], v[68:71]
  ds_read_b64_tr_b16 a[230:231], v21 offset:896
  v_mfma_f32_16x16x32_bf16 v[68:71], a[232:235], a[72:75], v[68:71]
  s_waitcnt lgkmcnt(9)
  v_mfma_f32_16x16x32_bf16 v[88:91], a[240:243], a[72:75], v[88:91]
  ds_read_b64_tr_b16 a[232:233], v21 offset:136
  v_mfma_f32_16x16x32_bf16 v[88:91], a[244:247], a[84:87], v[88:91]
  ds_read_b64_tr_b16 a[234:235], v21 offset:392
  v_mfma_f32_16x16x32_bf16 v[96:99], a[244:247], a[88:91], v[96:99]
  v_mfma_f32_16x16x32_bf16 v[96:99], a[240:243], a[76:79], v[96:99]
  ds_read_b64_tr_b16 a[236:237], v21 offset:648
  v_mfma_f32_16x16x32_bf16 v[104:107], a[240:243], a[80:83], v[104:107]
  ds_read_b64_tr_b16 a[238:239], v21 offset:904
  v_mfma_f32_16x16x32_bf16 v[104:107], a[244:247], a[92:95], v[104:107]
  s_waitcnt lgkmcnt(8)
  v_mfma_f32_16x16x32_bf16 v[108:111], a[252:255], a[92:95], v[108:111]
  ds_read_b64_tr_b16 a[240:241], v21 offset:192
  v_mfma_f32_16x16x32_bf16 v[108:111], a[248:251], a[80:83], v[108:111]
  ds_read_b64_tr_b16 a[242:243], v21 offset:448
  v_mfma_f32_16x16x32_bf16 v[100:103], a[248:251], a[76:79], v[100:103]
  v_mfma_f32_16x16x32_bf16 v[100:103], a[252:255], a[88:91], v[100:103]
  ds_read_b64_tr_b16 a[244:245], v21 offset:704
  v_mfma_f32_16x16x32_bf16 v[92:95], a[252:255], a[84:87], v[92:95]
  ds_read_b64_tr_b16 a[246:247], v21 offset:960
  v_mfma_f32_16x16x32_bf16 v[92:95], a[248:251], a[72:75], v[92:95]
  s_waitcnt lgkmcnt(8)
  v_mfma_f32_16x16x32_bf16 v[112:115], a[224:227], a[72:75], v[112:115]
  ds_read_b64_tr_b16 a[248:249], v21 offset:200
  v_mfma_f32_16x16x32_bf16 v[112:115], a[228:231], a[84:87], v[112:115]
  ds_read_b64_tr_b16 a[250:251], v21 offset:456
  v_mfma_f32_16x16x32_bf16 v[120:123], a[228:231], a[88:91], v[120:123]
  v_mfma_f32_16x16x32_bf16 v[120:123], a[224:227], a[76:79], v[120:123]
  ds_read_b64_tr_b16 a[252:253], v21 offset:712
  v_mfma_f32_16x16x32_bf16 v[128:131], a[224:227], a[80:83], v[128:131]
  ds_read_b64_tr_b16 a[254:255], v21 offset:968
  v_mfma_f32_16x16x32_bf16 v[128:131], a[228:231], a[92:95], v[128:131]
  s_waitcnt lgkmcnt(8)
  v_mfma_f32_16x16x32_bf16 v[132:135], a[236:239], a[92:95], v[132:135]
  s_waitcnt vmcnt(9)
  s_barrier
  v_mfma_f32_16x16x32_bf16 v[132:135], a[232:235], a[80:83], v[132:135]
  v_add_u32 v21, 33792, v20
  ds_read_b64_tr_b16 a[224:225], v21 offset:0
  v_mfma_f32_16x16x32_bf16 v[124:127], a[232:235], a[76:79], v[124:127]
  ds_read_b64_tr_b16 a[226:227], v21 offset:256
  s_add_u32 m0, s33, 118272
  s_mov_b32 s36, 1573120
  v_mfma_f32_16x16x32_bf16 v[124:127], a[236:239], a[88:91], v[124:127]
  buffer_load_dwordx4 v16, s[16:19], s36 offen lds
  ds_read_b64_tr_b16 a[228:229], v21 offset:512
  v_mfma_f32_16x16x32_bf16 v[116:119], a[236:239], a[84:87], v[116:119]
  ds_read_b128 a[124:127], v30 offset:33792
  ds_read_b64_tr_b16 a[230:231], v21 offset:768
  v_mfma_f32_16x16x32_bf16 v[116:119], a[232:235], a[72:75], v[116:119]
  s_waitcnt lgkmcnt(9)
  v_mfma_f32_16x16x32_bf16 v[136:139], a[240:243], a[72:75], v[136:139]
  ds_read_b64_tr_b16 a[232:233], v21 offset:8
  v_mfma_f32_16x16x32_bf16 v[136:139], a[244:247], a[84:87], v[136:139]
  ds_read_b64_tr_b16 a[234:235], v21 offset:264
  v_mfma_f32_16x16x32_bf16 v[144:147], a[244:247], a[88:91], v[144:147]
  s_add_u32 m0, s33, 119328
  v_mfma_f32_16x16x32_bf16 v[144:147], a[240:243], a[76:79], v[144:147]
  buffer_load_dwordx4 v17, s[16:19], s36 offen lds
  ds_read_b64_tr_b16 a[236:237], v21 offset:520
  v_mfma_f32_16x16x32_bf16 v[152:155], a[240:243], a[80:83], v[152:155]
  ds_read_b128 a[136:139], v31 offset:33792
  ds_read_b64_tr_b16 a[238:239], v21 offset:776
  v_mfma_f32_16x16x32_bf16 v[152:155], a[244:247], a[92:95], v[152:155]
  s_waitcnt lgkmcnt(10)
  v_mfma_f32_16x16x32_bf16 v[156:159], a[252:255], a[92:95], v[156:159]
  ds_read_b64_tr_b16 a[240:241], v21 offset:64
  v_mfma_f32_16x16x32_bf16 v[156:159], a[248:251], a[80:83], v[156:159]
  ds_read_b64_tr_b16 a[242:243], v21 offset:320
  v_mfma_f32_16x16x32_bf16 v[148:151], a[248:251], a[76:79], v[148:151]
  s_add_u32 m0, s33, 120384
  v_mfma_f32_16x16x32_bf16 v[148:151], a[252:255], a[88:91], v[148:151]
  buffer_load_dwordx4 v18, s[16:19], s36 offen lds
  ds_read_b64_tr_b16 a[244:245], v21 offset:576
  v_mfma_f32_16x16x32_bf16 v[140:143], a[252:255], a[84:87], v[140:143]
  ds_read_b128 a[128:131], v30 offset:35840
  ds_read_b64_tr_b16 a[246:247], v21 offset:832
  v_mfma_f32_16x16x32_bf16 v[140:143], a[248:251], a[72:75], v[140:143]
  s_waitcnt lgkmcnt(10)
  v_mfma_f32_16x16x32_bf16 v[64:67], a[224:227], a[96:99], v[64:67]
  ds_read_b64_tr_b16 a[248:249], v21 offset:72
  v_mfma_f32_16x16x32_bf16 v[64:67], a[228:231], a[108:111], v[64:67]
  ds_read_b64_tr_b16 a[250:251], v21 offset:328
  v_mfma_f32_16x16x32_bf16 v[72:75], a[228:231], a[112:115], v[72:75]
  s_add_u32 m0, s33, 121440
  v_mfma_f32_16x16x32_bf16 v[72:75], a[224:227], a[100:103], v[72:75]
  buffer_load_dwordx4 v19, s[16:19], s36 offen lds
  ds_read_b64_tr_b16 a[252:253], v21 offset:584
  v_mfma_f32_16x16x32_bf16 v[80:83], a[224:227], a[104:107], v[80:83]
  ds_read_b128 a[140:143], v31 offset:35840
  ds_read_b64_tr_b16 a[254:255], v21 offset:840
  v_mfma_f32_16x16x32_bf16 v[80:83], a[228:231], a[116:119], v[80:83]
  s_waitcnt lgkmcnt(10)
  v_mfma_f32_16x16x32_bf16 v[84:87], a[236:239], a[116:119], v[84:87]
  ds_read_b64_tr_b16 a[224:225], v21 offset:128
  v_mfma_f32_16x16x32_bf16 v[84:87], a[232:235], a[104:107], v[84:87]
  ds_read_b64_tr_b16 a[226:227], v21 offset:384
  v_mfma_f32_16x16x32_bf16 v[76:79], a[232:235], a[100:103], v[76:79]
  s_add_u32 m0, s33, 0
  s_mov_b32 s52, 768
  v_mfma_f32_16x16x32_bf16 v[76:79], a[236:239], a[112:115], v[76:79]
  buffer_load_dwordx4 v26, s[4:7], s52 offen lds
  ds_read_b64_tr_b16 a[228:229], v21 offset:640
  v_mfma_f32_16x16x32_bf16 v[68:71], a[236:239], a[108:111], v[68:71]
  ds_read_b64_tr_b16 a[230:231], v21 offset:896
  v_mfma_f32_16x16x32_bf16 v[68:71], a[232:235], a[96:99], v[68:71]
  s_waitcnt lgkmcnt(9)
  v_mfma_f32_16x16x32_bf16 v[88:91], a[240:243], a[96:99], v[88:91]
  ds_read_b64_tr_b16 a[232:233], v21 offset:136
  v_mfma_f32_16x16x32_bf16 v[88:91], a[244:247], a[108:111], v[88:91]
  ds_read_b64_tr_b16 a[234:235], v21 offset:392
  v_mfma_f32_16x16x32_bf16 v[96:99], a[244:247], a[112:115], v[96:99]
  s_add_u32 m0, s33, 1024
  v_mfma_f32_16x16x32_bf16 v[96:99], a[240:243], a[100:103], v[96:99]
  buffer_load_dwordx4 v27, s[4:7], s52 offen lds
  ds_read_b64_tr_b16 a[236:237], v21 offset:648
  v_mfma_f32_16x16x32_bf16 v[104:107], a[240:243], a[104:107], v[104:107]
  ds_read_b64_tr_b16 a[238:239], v21 offset:904
  v_mfma_f32_16x16x32_bf16 v[104:107], a[244:247], a[116:119], v[104:107]
  s_waitcnt lgkmcnt(8)
  v_mfma_f32_16x16x32_bf16 v[108:111], a[252:255], a[116:119], v[108:111]
  ds_read_b64_tr_b16 a[240:241], v21 offset:192
  v_mfma_f32_16x16x32_bf16 v[108:111], a[248:251], a[104:107], v[108:111]
  ds_read_b64_tr_b16 a[242:243], v21 offset:448
  v_mfma_f32_16x16x32_bf16 v[100:103], a[248:251], a[100:103], v[100:103]
  v_mfma_f32_16x16x32_bf16 v[100:103], a[252:255], a[112:115], v[100:103]
  ds_read_b64_tr_b16 a[244:245], v21 offset:704
  v_mfma_f32_16x16x32_bf16 v[92:95], a[252:255], a[108:111], v[92:95]
  ds_read_b64_tr_b16 a[246:247], v21 offset:960
  v_mfma_f32_16x16x32_bf16 v[92:95], a[248:251], a[96:99], v[92:95]
  s_waitcnt lgkmcnt(8)
  v_mfma_f32_16x16x32_bf16 v[112:115], a[224:227], a[96:99], v[112:115]
  ds_read_b64_tr_b16 a[248:249], v21 offset:200
  v_mfma_f32_16x16x32_bf16 v[112:115], a[228:231], a[108:111], v[112:115]
  ds_read_b64_tr_b16 a[250:251], v21 offset:456
  v_mfma_f32_16x16x32_bf16 v[120:123], a[228:231], a[112:115], v[120:123]
  v_mfma_f32_16x16x32_bf16 v[120:123], a[224:227], a[100:103], v[120:123]
  ds_read_b64_tr_b16 a[252:253], v21 offset:712
  v_mfma_f32_16x16x32_bf16 v[128:131], a[224:227], a[104:107], v[128:131]
  ds_read_b64_tr_b16 a[254:255], v21 offset:968
  v_mfma_f32_16x16x32_bf16 v[128:131], a[228:231], a[116:119], v[128:131]
  s_waitcnt lgkmcnt(8)
  v_mfma_f32_16x16x32_bf16 v[132:135], a[236:239], a[116:119], v[132:135]
  s_waitcnt vmcnt(6)
  s_barrier
  v_mfma_f32_16x16x32_bf16 v[132:135], a[232:235], a[104:107], v[132:135]
  v_add_u32 v21, 50688, v20
  ds_read_b64_tr_b16 a[224:225], v21 offset:0
  v_mfma_f32_16x16x32_bf16 v[124:127], a[232:235], a[100:103], v[124:127]
  ds_read_b64_tr_b16 a[226:227], v21 offset:256
  s_add_u32 m0, s33, 16896
  s_mov_b32 s36, 3145728
  v_mfma_f32_16x16x32_bf16 v[124:127], a[236:239], a[112:115], v[124:127]
  buffer_load_dwordx4 v16, s[16:19], s36 offen lds
  ds_read_b64_tr_b16 a[228:229], v21 offset:512
  v_mfma_f32_16x16x32_bf16 v[116:119], a[236:239], a[108:111], v[116:119]
  ds_read_b128 a[144:147], v32 offset:0
  ds_read_b64_tr_b16 a[230:231], v21 offset:768
  v_mfma_f32_16x16x32_bf16 v[116:119], a[232:235], a[96:99], v[116:119]
  s_waitcnt lgkmcnt(9)
  v_mfma_f32_16x16x32_bf16 v[136:139], a[240:243], a[96:99], v[136:139]
  ds_read_b64_tr_b16 a[232:233], v21 offset:8
  v_mfma_f32_16x16x32_bf16 v[136:139], a[244:247], a[108:111], v[136:139]
  ds_read_b64_tr_b16 a[234:235], v21 offset:264
  v_mfma_f32_16x16x32_bf16 v[144:147], a[244:247], a[112:115], v[144:147]
  s_add_u32 m0, s33, 17952
  v_mfma_f32_16x16x32_bf16 v[144:147], a[240:243], a[100:103], v[144:147]
  buffer_load_dwordx4 v17, s[16:19], s36 offen lds
  ds_read_b64_tr_b16 a[236:237], v21 offset:520
  v_mfma_f32_16x16x32_bf16 v[152:155], a[240:243], a[104:107], v[152:155]
  ds_read_b128 a[156:159], v33 offset:0
  ds_read_b64_tr_b16 a[238:239], v21 offset:776
  v_mfma_f32_16x16x32_bf16 v[152:155], a[244:247], a[116:119], v[152:155]
  s_waitcnt lgkmcnt(10)
  v_mfma_f32_16x16x32_bf16 v[156:159], a[252:255], a[116:119], v[156:159]
  ds_read_b64_tr_b16 a[240:241], v21 offset:64
  v_mfma_f32_16x16x32_bf16 v[156:159], a[248:251], a[104:107], v[156:159]
  ds_read_b64_tr_b16 a[242:243], v21 offset:320
  v_mfma_f32_16x16x32_bf16 v[148:151], a[248:251], a[100:103], v[148:151]
  s_add_u32 m0, s33, 19008
  v_mfma_f32_16x16x32_bf16 v[148:151], a[252:255], a[112:115], v[148:151]
  buffer_load_dwordx4 v18, s[16:19], s36 offen lds
  ds_read_b64_tr_b16 a[244:245], v21 offset:576
  v_mfma_f32_16x16x32_bf16 v[140:143], a[252:255], a[108:111], v[140:143]
  ds_read_b128 a[148:151], v32 offset:2048
  ds_read_b64_tr_b16 a[246:247], v21 offset:832
  v_mfma_f32_16x16x32_bf16 v[140:143], a[248:251], a[96:99], v[140:143]
  s_waitcnt lgkmcnt(10)
  v_mfma_f32_16x16x32_bf16 v[64:67], a[224:227], a[120:123], v[64:67]
  ds_read_b64_tr_b16 a[248:249], v21 offset:72
  v_mfma_f32_16x16x32_bf16 v[64:67], a[228:231], a[132:135], v[64:67]
  ds_read_b64_tr_b16 a[250:251], v21 offset:328
  v_mfma_f32_16x16x32_bf16 v[72:75], a[228:231], a[136:139], v[72:75]
  s_add_u32 m0, s33, 20064
  v_mfma_f32_16x16x32_bf16 v[72:75], a[224:227], a[124:127], v[72:75]
  buffer_load_dwordx4 v19, s[16:19], s36 offen lds
  ds_read_b64_tr_b16 a[252:253], v21 offset:584
  v_mfma_f32_16x16x32_bf16 v[80:83], a[224:227], a[128:131], v[80:83]
  ds_read_b128 a[160:163], v33 offset:2048
  ds_read_b64_tr_b16 a[254:255], v21 offset:840
  v_mfma_f32_16x16x32_bf16 v[80:83], a[228:231], a[140:143], v[80:83]
  s_waitcnt lgkmcnt(10)
  v_mfma_f32_16x16x32_bf16 v[84:87], a[236:239], a[140:143], v[84:87]
  ds_read_b64_tr_b16 a[224:225], v21 offset:128
  v_mfma_f32_16x16x32_bf16 v[84:87], a[232:235], a[128:131], v[84:87]
  ds_read_b64_tr_b16 a[226:227], v21 offset:384
  v_mfma_f32_16x16x32_bf16 v[76:79], a[232:235], a[124:127], v[76:79]
  v_mfma_f32_16x16x32_bf16 v[76:79], a[236:239], a[136:139], v[76:79]
  ds_read_b64_tr_b16 a[228:229], v21 offset:640
  v_mfma_f32_16x16x32_bf16 v[68:71], a[236:239], a[132:135], v[68:71]
  ds_read_b64_tr_b16 a[230:231], v21 offset:896
  v_mfma_f32_16x16x32_bf16 v[68:71], a[232:235], a[120:123], v[68:71]
  s_waitcnt lgkmcnt(9)
  v_mfma_f32_16x16x32_bf16 v[88:91], a[240:243], a[120:123], v[88:91]
  ds_read_b64_tr_b16 a[232:233], v21 offset:136
  v_mfma_f32_16x16x32_bf16 v[88:91], a[244:247], a[132:135], v[88:91]
  ds_read_b64_tr_b16 a[234:235], v21 offset:392
  v_mfma_f32_16x16x32_bf16 v[96:99], a[244:247], a[136:139], v[96:99]
  v_mfma_f32_16x16x32_bf16 v[96:99], a[240:243], a[124:127], v[96:99]
  ds_read_b64_tr_b16 a[236:237], v21 offset:648
  v_mfma_f32_16x16x32_bf16 v[104:107], a[240:243], a[128:131], v[104:107]
  ds_read_b64_tr_b16 a[238:239], v21 offset:904
  v_mfma_f32_16x16x32_bf16 v[104:107], a[244:247], a[140:143], v[104:107]
  s_waitcnt lgkmcnt(8)
  v_mfma_f32_16x16x32_bf16 v[108:111], a[252:255], a[140:143], v[108:111]
  ds_read_b64_tr_b16 a[240:241], v21 offset:192
  v_mfma_f32_16x16x32_bf16 v[108:111], a[248:251], a[128:131], v[108:111]
  ds_read_b64_tr_b16 a[242:243], v21 offset:448
  v_mfma_f32_16x16x32_bf16 v[100:103], a[248:251], a[124:127], v[100:103]
  v_mfma_f32_16x16x32_bf16 v[100:103], a[252:255], a[136:139], v[100:103]
  ds_read_b64_tr_b16 a[244:245], v21 offset:704
  v_mfma_f32_16x16x32_bf16 v[92:95], a[252:255], a[132:135], v[92:95]
  ds_read_b64_tr_b16 a[246:247], v21 offset:960
  v_mfma_f32_16x16x32_bf16 v[92:95], a[248:251], a[120:123], v[92:95]
  s_waitcnt lgkmcnt(8)
  v_mfma_f32_16x16x32_bf16 v[112:115], a[224:227], a[120:123], v[112:115]
  ds_read_b64_tr_b16 a[248:249], v21 offset:200
  v_mfma_f32_16x16x32_bf16 v[112:115], a[228:231], a[132:135], v[112:115]
  ds_read_b64_tr_b16 a[250:251], v21 offset:456
  v_mfma_f32_16x16x32_bf16 v[120:123], a[228:231], a[136:139], v[120:123]
  v_mfma_f32_16x16x32_bf16 v[120:123], a[224:227], a[124:127], v[120:123]
  ds_read_b64_tr_b16 a[252:253], v21 offset:712
  v_mfma_f32_16x16x32_bf16 v[128:131], a[224:227], a[128:131], v[128:131]
  ds_read_b64_tr_b16 a[254:255], v21 offset:968
  v_mfma_f32_16x16x32_bf16 v[128:131], a[228:231], a[140:143], v[128:131]
  s_waitcnt lgkmcnt(8)
  v_mfma_f32_16x16x32_bf16 v[132:135], a[236:239], a[140:143], v[132:135]
  s_waitcnt vmcnt(4)
  s_barrier
  v_mfma_f32_16x16x32_bf16 v[132:135], a[232:235], a[128:131], v[132:135]
  v_add_u32 v21, 118272, v20
  ds_read_b64_tr_b16 a[224:225], v21 offset:0
  v_mfma_f32_16x16x32_bf16 v[124:127], a[232:235], a[124:127], v[124:127]
  ds_read_b64_tr_b16 a[226:227], v21 offset:256
  s_add_u32 m0, s33, 84480
  s_mov_b32 s36, 2097408
  v_mfma_f32_16x16x32_bf16 v[124:127], a[236:239], a[136:139], v[124:127]
  buffer_load_dwordx4 v16, s[16:19], s36 offen lds
  ds_read_b64_tr_b16 a[228:229], v21 offset:512
  v_mfma_f32_16x16x32_bf16 v[116:119], a[236:239], a[132:135], v[116:119]
  ds_read_b128 a[152:155], v28 offset:0
  ds_read_b64_tr_b16 a[230:231], v21 offset:768
  v_mfma_f32_16x16x32_bf16 v[116:119], a[232:235], a[120:123], v[116:119]
  s_waitcnt lgkmcnt(9)
  v_mfma_f32_16x16x32_bf16 v[136:139], a[240:243], a[120:123], v[136:139]
  ds_read_b64_tr_b16 a[232:233], v21 offset:8
  v_mfma_f32_16x16x32_bf16 v[136:139], a[244:247], a[132:135], v[136:139]
  ds_read_b64_tr_b16 a[234:235], v21 offset:264
  v_mfma_f32_16x16x32_bf16 v[144:147], a[244:247], a[136:139], v[144:147]
  s_add_u32 m0, s33, 85536
  v_mfma_f32_16x16x32_bf16 v[144:147], a[240:243], a[124:127], v[144:147]
  buffer_load_dwordx4 v17, s[16:19], s36 offen lds
  ds_read_b64_tr_b16 a[236:237], v21 offset:520
  v_mfma_f32_16x16x32_bf16 v[152:155], a[240:243], a[128:131], v[152:155]
  ds_read_b128 a[164:167], v29 offset:0
  ds_read_b64_tr_b16 a[238:239], v21 offset:776
  v_mfma_f32_16x16x32_bf16 v[152:155], a[244:247], a[140:143], v[152:155]
  s_waitcnt lgkmcnt(10)
  v_mfma_f32_16x16x32_bf16 v[156:159], a[252:255], a[140:143], v[156:159]
  ds_read_b64_tr_b16 a[240:241], v21 offset:64
  v_mfma_f32_16x16x32_bf16 v[156:159], a[248:251], a[128:131], v[156:159]
  ds_read_b64_tr_b16 a[242:243], v21 offset:320
  v_mfma_f32_16x16x32_bf16 v[148:151], a[248:251], a[124:127], v[148:151]
  s_add_u32 m0, s33, 86592
  v_mfma_f32_16x16x32_bf16 v[148:151], a[252:255], a[136:139], v[148:151]
  buffer_load_dwordx4 v18, s[16:19], s36 offen lds
  ds_read_b64_tr_b16 a[244:245], v21 offset:576
  v_mfma_f32_16x16x32_bf16 v[140:143], a[252:255], a[132:135], v[140:143]
  ds_read_b64_tr_b16 a[246:247], v21 offset:832
  v_mfma_f32_16x16x32_bf16 v[140:143], a[248:251], a[120:123], v[140:143]
  s_waitcnt lgkmcnt(9)
  v_mfma_f32_16x16x32_bf16 v[160:163], a[224:227], a[72:75], v[160:163]
  ds_read_b64_tr_b16 a[248:249], v21 offset:72
  v_mfma_f32_16x16x32_bf16 v[160:163], a[228:231], a[84:87], v[160:163]
  ds_read_b64_tr_b16 a[250:251], v21 offset:328
  v_mfma_f32_16x16x32_bf16 v[168:171], a[228:231], a[88:91], v[168:171]
  s_add_u32 m0, s33, 87648
  v_mfma_f32_16x16x32_bf16 v[168:171], a[224:227], a[76:79], v[168:171]
  buffer_load_dwordx4 v19, s[16:19], s36 offen lds
  ds_read_b64_tr_b16 a[252:253], v21 offset:584
  v_mfma_f32_16x16x32_bf16 v[176:179], a[224:227], a[80:83], v[176:179]
  ds_read_b64_tr_b16 a[254:255], v21 offset:840
  v_mfma_f32_16x16x32_bf16 v[176:179], a[228:231], a[92:95], v[176:179]
  s_waitcnt lgkmcnt(8)
  v_mfma_f32_16x16x32_bf16 v[180:183], a[236:239], a[92:95], v[180:183]
  s_branch L_page2
.p2align 12
L_hop2:
  s_branch L_walked0
  s_nop 0
L_page2:
  ds_read_b64_tr_b16 a[224:225], v21 offset:128
  v_mfma_f32_16x16x32_bf16 v[180:183], a[232:235], a[80:83], v[180:183]
  ds_read_b64_tr_b16 a[226:227], v21 offset:384
  v_mfma_f32_16x16x32_bf16 v[172:175], a[232:235], a[76:79], v[172:175]
  v_mfma_f32_16x16x32_bf16 v[172:175], a[236:239], a[88:91], v[172:175]
  ds_read_b64_tr_b16 a[228:229], v21 offset:640
  v_mfma_f32_16x16x32_bf16 v[164:167], a[236:239], a[84:87], v[164:167]
  ds_read_b64_tr_b16 a[230:231], v21 offset:896
  v_mfma_f32_16x16x32_bf16 v[164:167], a[232:235], a[72:75], v[164:167]
  s_waitcnt lgkmcnt(8)
  v_mfma_f32_16x16x32_bf16 v[184:187], a[240:243], a[72:75], v[184:187]
  ds_read_b64_tr_b16 a[232:233], v21 offset:136
  v_mfma_f32_16x16x32_bf16 v[184:187], a[244:247], a[84:87], v[184:187]
  ds_read_b64_tr_b16 a[234:235], v21 offset:392
  v_mfma_f32_16x16x32_bf16 v[192:195], a[244:247], a[88:91], v[192:195]
  v_mfma_f32_16x16x32_bf16 v[192:195], a[240:243], a[76:79], v[192:195]
  ds_read_b64_tr_b16 a[236:237], v21 offset:648
  v_mfma_f32_16x16x32_bf16 v[200:203], a[240:243], a[80:83], v[200:203]
  ds_read_b64_tr_b16 a[238:239], v21 offset:904
  v_mfma_f32_16x16x32_bf16 v[200:203], a[244:247], a[92:95], v[200:203]
  s_waitcnt lgkmcnt(8)
  v_mfma_f32_16x16x32_bf16 v[204:207], a[252:255], a[92:95], v[204:207]
  ds_read_b64_tr_b16 a[240:241], v21 offset:192
  v_mfma_f32_16x16x32_bf16 v[204:207], a[248:251], a[80:83], v[204:207]
  ds_read_b64_tr_b16 a[242:243], v21 offset:448
  v_mfma_f32_16x16x32_bf16 v[196:199], a[248:251], a[76:79], v[196:199]
  v_mfma_f32_16x16x32_bf16 v[196:199], a[252:255], a[88:91], v[196:199]
  ds_read_b64_tr_b16 a[244:245], v21 offset:704
  v_mfma_f32_16x16x32_bf16 v[188:191], a[252:255], a[84:87], v[188:191]
  ds_read_b64_tr_b16 a[246:247], v21 offset:960
  v_mfma_f32_16x16x32_bf16 v[188:191], a[248:251], a[72:75], v[188:191]
  s_waitcnt lgkmcnt(8)
  v_mfma_f32_16x16x32_bf16 v[208:211], a[224:227], a[72:75], v[208:211]
  ds_read_b64_tr_b16 a[248:249], v21 offset:200
  v_mfma_f32_16x16x32_bf16 v[208:211], a[228:231], a[84:87], v[208:211]
  ds_read_b64_tr_b16 a[250:251], v21 offset:456
  v_mfma_f32_16x16x32_bf16 v[216:219], a[228:231], a[88:91], v[216:219]
  v_mfma_f32_16x16x32_bf16 v[216:219], a[224:227], a[76:79], v[216:219]
  ds_read_b64_tr_b16 a[252:253], v21 offset:712
  v_mfma_f32_16x16x32_bf16 v[224:227], a[224:227], a[80:83], v[224:227]
  ds_read_b64_tr_b16 a[254:255], v21 offset:968
  v_mfma_f32_16x16x32_bf16 v[224:227], a[228:231], a[92:95], v[224:227]
  s_waitcnt lgkmcnt(8)
  v_mfma_f32_16x16x32_bf16 v[228:231], a[236:239], a[92:95], v[228:231]
  s_waitcnt vmcnt(4)
  s_barrier
  v_mfma_f32_16x16x32_bf16 v[228:231], a[232:235], a[80:83], v[228:231]
  v_add_u32 v21, 16896, v20
  ds_read_b64_tr_b16 a[224:225], v21 offset:0
  v_mfma_f32_16x16x32_bf16 v[220:223], a[232:235], a[76:79], v[220:223]
  ds_read_b64_tr_b16 a[226:227], v21 offset:256
  s_add_u32 m0, s33, 33792
  s_mov_b32 s36, 2621696
  v_mfma_f32_16x16x32_bf16 v[220:223], a[236:239], a[88:91], v[220:223]
  buffer_load_dwordx4 v16, s[16:19], s36 offen lds
  ds_read_b64_tr_b16 a[228:229], v21 offset:512
  v_mfma_f32_16x16x32_bf16 v[212:215], a[236:239], a[84:87], v[212:215]
  ds_read_b64_tr_b16 a[230:231], v21 offset:768
  v_mfma_f32_16x16x32_bf16 v[212:215], a[232:235], a[72:75], v[212:215]
  s_waitcnt lgkmcnt(8)
  v_mfma_f32_16x16x32_bf16 v[232:235], a[240:243], a[72:75], v[232:235]
  ds_read_b64_tr_b16 a[232:233], v21 offset:8
  v_mfma_f32_16x16x32_bf16 v[232:235], a[244:247], a[84:87], v[232:235]
  ds_read_b64_tr_b16 a[234:235], v21 offset:264
  v_mfma_f32_16x16x32_bf16 v[240:243], a[244:247], a[88:91], v[240:243]
  s_add_u32 m0, s33, 34848
  v_mfma_f32_16x16x32_bf16 v[240:243], a[240:243], a[76:79], v[240:243]
  buffer_load_dwordx4 v17, s[16:19], s36 offen lds
  ds_read_b64_tr_b16 a[236:237], v21 offset:520
  v_mfma_f32_16x16x32_bf16 v[248:251], a[240:243], a[80:83], v[248:251]
  ds_read_b64_tr_b16 a[238:239], v21 offset:776
  v_mfma_f32_16x16x32_bf16 v[248:251], a[244:247], a[92:95], v[248:251]
  s_waitcnt lgkmcnt(8)
  v_mfma_f32_16x16x32_bf16 v[252:255], a[252:255], a[92:95], v[252:255]
  ds_read_b64_tr_b16 a[240:241], v21 offset:64
  v_mfma_f32_16x16x32_bf16 v[252:255], a[248:251], a[80:83], v[252:255]
  ds_read_b64_tr_b16 a[242:243], v21 offset:320
  v_mfma_f32_16x16x32_bf16 v[244:247], a[248:251], a[76:79], v[244:247]
  s_add_u32 m0, s33, 35904
  v_mfma_f32_16x16x32_bf16 v[244:247], a[252:255], a[88:91], v[244:247]
  buffer_load_dwordx4 v18, s[16:19], s36 offen lds
  ds_read_b64_tr_b16 a[244:245], v21 offset:576
  v_mfma_f32_16x16x32_bf16 v[236:239], a[252:255], a[84:87], v[236:239]
  ds_read_b64_tr_b16 a[246:247], v21 offset:832
  v_mfma_f32_16x16x32_bf16 v[236:239], a[248:251], a[72:75], v[236:239]
  s_waitcnt lgkmcnt(8)
  v_mfma_f32_16x16x32_bf16 v[64:67], a[224:227], a[144:147], v[64:67]
  ds_read_b64_tr_b16 a[248:249], v21 offset:72
  v_mfma_f32_16x16x32_bf16 v[64:67], a[228:231], a[156:159], v[64:67]
  ds_read_b64_tr_b16 a[250:251], v21 offset:328
  v_mfma_f32_16x16x32_bf16 v[72:75], a[228:231], a[160:163], v[72:75]
  s_add_u32 m0, s33, 36960
  v_mfma_f32_16x16x32_bf16 v[72:75], a[224:227], a[148:151], v[72:75]
  buffer_load_dwordx4 v19, s[16:19], s36 offen lds
  ds_read_b64_tr_b16 a[252:253], v21 offset:584
  v_mfma_f32_16x16x32_bf16 v[80:83], a[224:227], a[152:155], v[80:83]
  ds_read_b64_tr_b16 a[254:255], v21 offset:840
  v_mfma_f32_16x16x32_bf16 v[80:83], a[228:231], a[164:167], v[80:83]
  s_waitcnt lgkmcnt(8)
  v_mfma_f32_16x16x32_bf16 v[84:87], a[236:239], a[164:167], v[84:87]
  ds_read_b64_tr_b16 a[224:225], v21 offset:128
  v_mfma_f32_16x16x32_bf16 v[84:87], a[232:235], a[152:155], v[84:87]
  ds_read_b64_tr_b16 a[226:227], v21 offset:384
  v_mfma_f32_16x16x32_bf16 v[76:79], a[232:235], a[148:151], v[76:79]
  s_add_u32 m0, s33, 101376
  s_mov_b32 s71, 128
  v_mfma_f32_16x16x32_bf16 v[76:79], a[236:239], a[160:163], v[76:79]
  buffer_load_dwordx4 v2, s[20:23], s71 offen offset:0 lds
  ds_read_b64_tr_b16 a[228:229], v21 offset:640
  v_mfma_f32_16x16x32_bf16 v[68:71], a[236:239], a[156:159], v[68:71]
  ds_read_b64_tr_b16 a[230:231], v21 offset:896
  v_mfma_f32_16x16x32_bf16 v[68:71], a[232:235], a[144:147], v[68:71]
  s_waitcnt lgkmcnt(8)
  v_mfma_f32_16x16x32_bf16 v[88:91], a[240:243], a[144:147], v[88:91]
  ds_read_b64_tr_b16 a[232:233], v21 offset:136
  v_mfma_f32_16x16x32_bf16 v[88:91], a[244:247], a[156:159], v[88:91]
  ds_read_b64_tr_b16 a[234:235], v21 offset:392
  v_mfma_f32_16x16x32_bf16 v[96:99], a[244:247], a[160:163], v[96:99]
  s_add_u32 m0, s33, 101536
  v_mfma_f32_16x16x32_bf16 v[96:99], a[240:243], a[148:151], v[96:99]
  buffer_load_dwordx4 v2, s[20:23], s71 offen offset:896 lds
  ds_read_b64_tr_b16 a[236:237], v21 offset:648
  v_mul_f32 v64, s37, v64
  v_mfma_f32_16x16x32_bf16 v[104:107], a[240:243], a[152:155], v[104:107]
  ds_read_b64_tr_b16 a[238:239], v21 offset:904
  v_mul_f32 v65, s37, v65
  v_mfma_f32_16x16x32_bf16 v[104:107], a[244:247], a[164:167], v[104:107]
  v_mul_f32 v66, s37, v66
  s_waitcnt lgkmcnt(8)
  v_mfma_f32_16x16x32_bf16 v[108:111], a[252:255], a[164:167], v[108:111]
  ds_read_b64_tr_b16 a[240:241], v21 offset:192
  v_mul_f32 v67, s37, v67
  v_mfma_f32_16x16x32_bf16 v[108:111], a[248:251], a[152:155], v[108:111]
  ds_read_b64_tr_b16 a[242:243], v21 offset:448
  v_mul_f32 v68, s37, v68
  v_mfma_f32_16x16x32_bf16 v[100:103], a[248:251], a[148:151], v[100:103]
  v_mul_f32 v69, s37, v69
  v_mul_f32 v70, s37, v70
  v_mfma_f32_16x16x32_bf16 v[100:103], a[252:255], a[160:163], v[100:103]
  ds_read_b64_tr_b16 a[244:245], v21 offset:704
  v_mul_f32 v71, s37, v71
  v_mfma_f32_16x16x32_bf16 v[92:95], a[252:255], a[156:159], v[92:95]
  ds_read_b64_tr_b16 a[246:247], v21 offset:960
  v_cvt_pk_bf16_f32 v64, v64, v65
  v_mfma_f32_16x16x32_bf16 v[92:95], a[248:251], a[144:147], v[92:95]
  v_cvt_pk_bf16_f32 v65, v66, v67
  s_waitcnt lgkmcnt(8)
  v_mfma_f32_16x16x32_bf16 v[112:115], a[224:227], a[144:147], v[112:115]
  ds_read_b64_tr_b16 a[248:249], v21 offset:200
  v_cvt_pk_bf16_f32 v66, v68, v69
  v_mfma_f32_16x16x32_bf16 v[112:115], a[228:231], a[156:159], v[112:115]
  ds_read_b64_tr_b16 a[250:251], v21 offset:456
  v_cvt_pk_bf16_f32 v67, v70, v71
  v_mfma_f32_16x16x32_bf16 v[120:123], a[228:231], a[160:163], v[120:123]
  v_mul_f32 v72, s37, v72
  v_mul_f32 v73, s37, v73
  v_mfma_f32_16x16x32_bf16 v[120:123], a[224:227], a[148:151], v[120:123]
  ds_read_b64_tr_b16 a[252:253], v21 offset:712
  v_mul_f32 v74, s37, v74
  v_mul_f32 v75, s37, v75
  v_mfma_f32_16x16x32_bf16 v[128:131], a[224:227], a[152:155], v[128:131]
  ds_read_b64_tr_b16 a[254:255], v21 offset:968
  v_mul_f32 v76, s37, v76
  v_mfma_f32_16x16x32_bf16 v[128:131], a[228:231], a[164:167], v[128:131]
  v_mul_f32 v77, s37, v77
  s_waitcnt lgkmcnt(8)
  v_mfma_f32_16x16x32_bf16 v[132:135], a[236:239], a[164:167], v[132:135]
  s_waitcnt vmcnt(6)
  s_barrier
  v_mfma_f32_16x16x32_bf16 v[132:135], a[232:235], a[152:155], v[132:135]
  v_add_u32 v21, 84480, v20
  ds_read_b64_tr_b16 a[224:225], v21 offset:0
  v_mfma_f32_16x16x32_bf16 v[124:127], a[232:235], a[148:151], v[124:127]
  ds_read_b64_tr_b16 a[226:227], v21 offset:256
  s_add_u32 m0, s33, 50688
  s_mov_b32 s36, 3145984
  v_mfma_f32_16x16x32_bf16 v[124:127], a[236:239], a[160:163], v[124:127]
  buffer_load_dwordx4 v16, s[16:19], s36 offen lds
  ds_read_b64_tr_b16 a[228:229], v21 offset:512
  v_mfma_f32_16x16x32_bf16 v[116:119], a[236:239], a[156:159], v[116:119]
  ds_read_b64_tr_b16 a[230:231], v21 offset:768
  v_mul_f32 v78, s37, v78
  v_mfma_f32_16x16x32_bf16 v[116:119], a[232:235], a[144:147], v[116:119]
  v_mul_f32 v79, s37, v79
  s_waitcnt lgkmcnt(8)
  v_mfma_f32_16x16x32_bf16 v[136:139], a[240:243], a[144:147], v[136:139]
  ds_read_b64_tr_b16 a[232:233], v21 offset:8
  v_cvt_pk_bf16_f32 v72, v72, v73
  v_mfma_f32_16x16x32_bf16 v[136:139], a[244:247], a[156:159], v[136:139]
  ds_read_b64_tr_b16 a[234:235], v21 offset:264
  v_cvt_pk_bf16_f32 v73, v74, v75
  v_mfma_f32_16x16x32_bf16 v[144:147], a[244:247], a[160:163], v[144:147]
  s_add_u32 m0, s33, 51744
  v_cvt_pk_bf16_f32 v74, v76, v77
  v_mfma_f32_16x16x32_bf16 v[144:147], a[240:243], a[148:151], v[144:147]
  buffer_load_dwordx4 v17, s[16:19], s36 offen lds
  ds_read_b64_tr_b16 a[236:237], v21 offset:520
  v_mfma_f32_16x16x32_bf16 v[152:155], a[240:243], a[152:155], v[152:155]
  ds_read_b64_tr_b16 a[238:239], v21 offset:776
  v_cvt_pk_bf16_f32 v75, v78, v79
  v_mfma_f32_16x16x32_bf16 v[152:155], a[244:247], a[164:167], v[152:155]
  v_mul_f32 v80, s37, v80
  s_waitcnt lgkmcnt(8)
  v_mfma_f32_16x16x32_bf16 v[156:159], a[252:255], a[164:167], v[156:159]
  ds_read_b64_tr_b16 a[240:241], v21 offset:64
  v_mul_f32 v81, s37, v81
  v_mfma_f32_16x16x32_bf16 v[156:159], a[248:251], a[152:155], v[156:159]
  ds_read_b64_tr_b16 a[242:243], v21 offset:320
  v_mul_f32 v82, s37, v82
  v_mfma_f32_16x16x32_bf16 v[148:151], a[248:251], a[148:151], v[148:151]
  s_add_u32 m0, s33, 52800
  v_mul_f32 v83, s37, v83
  v_mfma_f32_16x16x32_bf16 v[148:151], a[252:255], a[160:163], v[148:151]
  buffer_load_dwordx4 v18, s[16:19], s36 offen lds
  ds_read_b64_tr_b16 a[244:245], v21 offset:576
  v_mfma_f32_16x16x32_bf16 v[140:143], a[252:255], a[156:159], v[140:143]
  ds_read_b64_tr_b16 a[246:247], v21 offset:832
  v_mul_f32 v84, s37, v84
  v_mfma_f32_16x16x32_bf16 v[140:143], a[248:251], a[144:147], v[140:143]
  v_mul_f32 v85, s37, v85
  s_waitcnt lgkmcnt(8)
  v_mfma_f32_16x16x32_bf16 v[160:163], a[224:227], a[96:99], v[160:163]
  ds_read_b64_tr_b16 a[248:249], v21 offset:72
  v_mul_f32 v86, s37, v86
  v_mfma_f32_16x16x32_bf16 v[160:163], a[228:231], a[108:111], v[160:163]
  ds_read_b64_tr_b16 a[250:251], v21 offset:328
  v_mul_f32 v87, s37, v87
  v_mfma_f32_16x16x32_bf16 v[168:171], a[228:231], a[112:115], v[168:171]
  s_add_u32 m0, s33, 53856
  v_cvt_pk_bf16_f32 v80, v80, v81
  v_cvt_pk_bf16_f32 v81, v82, v83
  v_mfma_f32_16x16x32_bf16 v[168:171], a[224:227], a[100:103], v[168:171]
  buffer_load_dwordx4 v19, s[16:19], s36 offen lds
  ds_read_b64_tr_b16 a[252:253], v21 offset:584
  v_mfma_f32_16x16x32_bf16 v[176:179], a[224:227], a[104:107], v[176:179]
  ds_read_b64_tr_b16 a[254:255], v21 offset:840
  v_cvt_pk_bf16_f32 v82, v84, v85
  v_mfma_f32_16x16x32_bf16 v[176:179], a[228:231], a[116:119], v[176:179]
  v_cvt_pk_bf16_f32 v83, v86, v87
  v_accvgpr_write_b32 a0, v64
  s_waitcnt lgkmcnt(8)
  v_mfma_f32_16x16x32_bf16 v[180:183], a[236:239], a[116:119], v[180:183]
  ds_read_b64_tr_b16 a[224:225], v21 offset:128
  v_accvgpr_write_b32 a1, v65
  v_mfma_f32_16x16x32_bf16 v[180:183], a[232:235], a[104:107], v[180:183]
  ds_read_b64_tr_b16 a[226:227], v21 offset:384
  v_accvgpr_write_b32 a2, v66
  v_mfma_f32_16x16x32_bf16 v[172:175], a[232:235], a[100:103], v[172:175]
  s_add_u32 m0, s33, 101696
  v_accvgpr_write_b32 a3, v67
  v_accvgpr_write_b32 a4, v72
  v_mfma_f32_16x16x32_bf16 v[172:175], a[236:239], a[112:115], v[172:175]
  buffer_load_dwordx4 v2, s[20:23], s71 offen offset:1792 lds
  ds_read_b64_tr_b16 a[228:229], v21 offset:640
  v_mfma_f32_16x16x32_bf16 v[164:167], a[236:239], a[108:111], v[164:167]
  ds_read_b64_tr_b16 a[230:231], v21 offset:896
  v_accvgpr_write_b32 a5, v73
  v_mfma_f32_16x16x32_bf16 v[164:167], a[232:235], a[96:99], v[164:167]
  v_accvgpr_write_b32 a6, v74
  v_accvgpr_write_b32 a7, v75
  s_waitcnt lgkmcnt(8)
  v_mfma_f32_16x16x32_bf16 v[184:187], a[240:243], a[96:99], v[184:187]
  ds_read_b64_tr_b16 a[232:233], v21 offset:136
  v_accvgpr_write_b32 a8, v80
  v_mfma_f32_16x16x32_bf16 v[184:187], a[244:247], a[108:111], v[184:187]
  ds_read_b64_tr_b16 a[234:235], v21 offset:392
  v_accvgpr_write_b32 a9, v81
  v_mfma_f32_16x16x32_bf16 v[192:195], a[244:247], a[112:115], v[192:195]
  s_add_u32 m0, s33, 101856
  v_accvgpr_write_b32 a10, v82
  v_accvgpr_write_b32 a11, v83
  v_mfma_f32_16x16x32_bf16 v[192:195], a[240:243], a[100:103], v[192:195]
  buffer_load_dwordx4 v2, s[20:23], s71 offen offset:2688 lds
  ds_read_b64_tr_b16 a[236:237], v21 offset:648
  v_mfma_f32_16x16x32_bf16 v[200:203], a[240:243], a[104:107], v[200:203]
  ds_read_b64_tr_b16 a[238:239], v21 offset:904
  v_mul_f32 v88, s37, v88
  v_mfma_f32_16x16x32_bf16 v[200:203], a[244:247], a[116:119], v[200:203]
  v_mul_f32 v89, s37, v89
  v_mul_f32 v90, s37, v90
  s_waitcnt lgkmcnt(8)
  v_mfma_f32_16x16x32_bf16 v[204:207], a[252:255], a[116:119], v[204:207]
  ds_read_b64_tr_b16 a[240:241], v21 offset:192
  v_mul_f32 v91, s37, v91
  v_mfma_f32_16x16x32_bf16 v[204:207], a[248:251], a[104:107], v[204:207]
  ds_read_b64_tr_b16 a[242:243], v21 offset:448
  v_mul_f32 v92, s37, v92
  v_mfma_f32_16x16x32_bf16 v[196:199], a[248:251], a[100:103], v[196:199]
  v_mul_f32 v93, s37, v93
  v_mul_f32 v94, s37, v94
  v_mul_f32 v95, s37, v95
  v_mfma_f32_16x16x32_bf16 v[196:199], a[252:255], a[112:115], v[196:199]
  ds_read_b64_tr_b16 a[244:245], v21 offset:704
  v_cvt_pk_bf16_f32 v88, v88, v89
  v_mfma_f32_16x16x32_bf16 v[188:191], a[252:255], a[108:111], v[188:191]
  ds_read_b64_tr_b16 a[246:247], v21 offset:960
  v_cvt_pk_bf16_f32 v89, v90, v91
  v_mfma_f32_16x16x32_bf16 v[188:191], a[248:251], a[96:99], v[188:191]
  v_cvt_pk_bf16_f32 v90, v92, v93
  v_cvt_pk_bf16_f32 v91, v94, v95
  s_waitcnt lgkmcnt(8)
  v_mfma_f32_16x16x32_bf16 v[208:211], a[224:227], a[96:99], v[208:211]
  ds_read_b64_tr_b16 a[248:249], v21 offset:200
  v_mul_f32 v96, s37, v96
  v_mfma_f32_16x16x32_bf16 v[208:211], a[228:231], a[108:111], v[208:211]
  ds_read_b64_tr_b16 a[250:251], v21 offset:456
  v_mul_f32 v97, s37, v97
  v_mfma_f32_16x16x32_bf16 v[216:219], a[228:231], a[112:115], v[216:219]
  v_mul_f32 v98, s37, v98
  v_mul_f32 v99, s37, v99
  v_mul_f32 v100, s37, v100
  v_mfma_f32_16x16x32_bf16 v[216:219], a[224:227], a[100:103], v[216:219]
  ds_read_b64_tr_b16 a[252:253], v21 offset:712
  v_mul_f32 v101, s37, v101
  v_mfma_f32_16x16x32_bf16 v[224:227], a[224:227], a[104:107], v[224:227]
  ds_read_b64_tr_b16 a[254:255], v21 offset:968
  v_mul_f32 v102, s37, v102
  v_mfma_f32_16x16x32_bf16 v[224:227], a[228:231], a[116:119], v[224:227]
  v_mul_f32 v103, s37, v103
  v_cvt_pk_bf16_f32 v96, v96, v97
  s_waitcnt lgkmcnt(8)
  v_mfma_f32_16x16x32_bf16 v[228:231], a[236:239], a[116:119], v[228:231]
  s_waitcnt vmcnt(8)
  s_barrier
  v_mfma_f32_16x16x32_bf16 v[228:231], a[232:235], a[104:107], v[228:231]
  v_add_u32 v21, 33792, v20
  ds_read_b64_tr_b16 a[224:225], v21 offset:0
  v_cvt_pk_bf16_f32 v97, v98, v99
  v_mfma_f32_16x16x32_bf16 v[220:223], a[232:235], a[100:103], v[220:223]
  ds_read_b64_tr_b16 a[226:227], v21 offset:256
  s_add_u32 m0, s33, 0
  s_add_u32 s34, s34, 0x1000
  v_mfma_f32_16x16x32_bf16 v[220:223], a[236:239], a[112:115], v[220:223]
  buffer_load_dwordx4 v1, s[8:11], s34 offen nt lds
  ds_read_b64_tr_b16 a[228:229], v21 offset:512
  v_mfma_f32_16x16x32_bf16 v[212:215], a[236:239], a[108:111], v[212:215]
  ds_read_b64_tr_b16 a[230:231], v21 offset:768
  v_mfma_f32_16x16x32_bf16 v[212:215], a[232:235], a[96:99], v[212:215]
  v_cvt_pk_bf16_f32 v98, v100, v101
  v_cvt_pk_bf16_f32 v99, v102, v103
  s_waitcnt lgkmcnt(8)
  v_mfma_f32_16x16x32_bf16 v[232:235], a[240:243], a[96:99], v[232:235]
  ds_read_b64_tr_b16 a[232:233], v21 offset:8
  v_mul_f32 v104, s37, v104
  v_mfma_f32_16x16x32_bf16 v[232:235], a[244:247], a[108:111], v[232:235]
  ds_read_b64_tr_b16 a[234:235], v21 offset:264
  v_mul_f32 v105, s37, v105
  v_mfma_f32_16x16x32_bf16 v[240:243], a[244:247], a[112:115], v[240:243]
  s_add_u32 m0, s33, 1056
  s_add_u32 s34, s34, 0x1000
  v_mul_f32 v106, s37, v106
  v_mfma_f32_16x16x32_bf16 v[240:243], a[240:243], a[100:103], v[240:243]
  buffer_load_dwordx4 v1, s[8:11], s34 offen nt lds
  ds_read_b64_tr_b16 a[236:237], v21 offset:520
  v_mfma_f32_16x16x32_bf16 v[248:251], a[240:243], a[104:107], v[248:251]
  ds_read_b64_tr_b16 a[238:239], v21 offset:776
  v_mul_f32 v107, s37, v107
  v_mul_f32 v108, s37, v108
  v_mfma_f32_16x16x32_bf16 v[248:251], a[244:247], a[116:119], v[248:251]
  v_mul_f32 v109, s37, v109
  s_waitcnt lgkmcnt(8)
  v_mfma_f32_16x16x32_bf16 v[252:255], a[252:255], a[116:119], v[252:255]
  ds_read_b64_tr_b16 a[240:241], v21 offset:64
  v_mul_f32 v110, s37, v110
  v_mfma_f32_16x16x32_bf16 v[252:255], a[248:251], a[104:107], v[252:255]
  ds_read_b64_tr_b16 a[242:243], v21 offset:320
  v_mul_f32 v111, s37, v111
  v_cvt_pk_bf16_f32 v104, v104, v105
  v_mfma_f32_16x16x32_bf16 v[244:247], a[248:251], a[100:103], v[244:247]
  s_add_u32 m0, s33, 2112
  s_add_u32 s34, s34, 0x1000
  v_mfma_f32_16x16x32_bf16 v[244:247], a[252:255], a[112:115], v[244:247]
  buffer_load_dwordx4 v1, s[8:11], s34 offen nt lds
  ds_read_b64_tr_b16 a[244:245], v21 offset:576
  v_mfma_f32_16x16x32_bf16 v[236:239], a[252:255], a[108:111], v[236:239]
  ds_read_b64_tr_b16 a[246:247], v21 offset:832
  v_cvt_pk_bf16_f32 v105, v106, v107
  v_cvt_pk_bf16_f32 v106, v108, v109
  v_mfma_f32_16x16x32_bf16 v[236:239], a[248:251], a[96:99], v[236:239]
  v_cvt_pk_bf16_f32 v107, v110, v111
  s_waitcnt lgkmcnt(8)
  v_mfma_f32_16x16x32_bf16 v[160:163], a[224:227], a[120:123], v[160:163]
  ds_read_b64_tr_b16 a[248:249], v21 offset:72
  v_accvgpr_write_b32 a12, v88
  v_mfma_f32_16x16x32_bf16 v[160:163], a[228:231], a[132:135], v[160:163]
  ds_read_b64_tr_b16 a[250:251], v21 offset:328
  v_accvgpr_write_b32 a13, v89
  v_accvgpr_write_b32 a14, v90
  v_mfma_f32_16x16x32_bf16 v[168:171], a[228:231], a[136:139], v[168:171]
  s_add_u32 m0, s33, 3168
  s_add_u32 s34, s34, 0x1000
  v_mfma_f32_16x16x32_bf16 v[168:171], a[224:227], a[124:127], v[168:171]
  buffer_load_dwordx4 v1, s[8:11], s34 offen nt lds
  ds_read_b64_tr_b16 a[252:253], v21 offset:584
  v_accvgpr_write_b32 a15, v91
  v_mfma_f32_16x16x32_bf16 v[176:179], a[224:227], a[128:131], v[176:179]
  ds_read_b64_tr_b16 a[254:255], v21 offset:840
  v_accvgpr_write_b32 a16, v96
  v_mfma_f32_16x16x32_bf16 v[176:179], a[228:231], a[140:143], v[176:179]
  v_accvgpr_write_b32 a17, v97
  v_accvgpr_write_b32 a18, v98
  s_waitcnt lgkmcnt(8)
  v_mfma_f32_16x16x32_bf16 v[180:183], a[236:239], a[140:143], v[180:183]
  ds_read_b64_tr_b16 a[224:225], v21 offset:128
  v_accvgpr_write_b32 a19, v99
  v_mfma_f32_16x16x32_bf16 v[180:183], a[232:235], a[128:131], v[180:183]
  ds_read_b64_tr_b16 a[226:227], v21 offset:384
  v_accvgpr_write_b32 a20, v104
  v_accvgpr_write_b32 a21, v105
  v_mfma_f32_16x16x32_bf16 v[172:175], a[232:235], a[124:127], v[172:175]
  s_add_u32 m0, s33, 118272
  s_mov_b32 s71, 114816
  v_mfma_f32_16x16x32_bf16 v[172:175], a[236:239], a[136:139], v[172:175]
  buffer_load_dwordx4 v2, s[20:23], s71 offen offset:0 lds
  ds_read_b64_tr_b16 a[228:229], v21 offset:640
  v_accvgpr_write_b32 a22, v106
  v_mfma_f32_16x16x32_bf16 v[164:167], a[236:239], a[132:135], v[164:167]
  ds_read_b64_tr_b16 a[230:231], v21 offset:896
  v_accvgpr_write_b32 a23, v107
  v_mfma_f32_16x16x32_bf16 v[164:167], a[232:235], a[120:123], v[164:167]
  v_mul_f32 v112, s37, v112
  v_mul_f32 v113, s37, v113
  s_waitcnt lgkmcnt(8)
  v_mfma_f32_16x16x32_bf16 v[184:187], a[240:243], a[120:123], v[184:187]
  ds_read_b64_tr_b16 a[232:233], v21 offset:136
  v_mul_f32 v114, s37, v114
  v_mfma_f32_16x16x32_bf16 v[184:187], a[244:247], a[132:135], v[184:187]
  ds_read_b64_tr_b16 a[234:235], v21 offset:392
  v_mul_f32 v115, s37, v115
  v_mul_f32 v116, s37, v116
  v_mfma_f32_16x16x32_bf16 v[192:195], a[244:247], a[136:139], v[192:195]
  s_add_u32 m0, s33, 118432
  v_mul_f32 v117, s37, v117
  v_mfma_f32_16x16x32_bf16 v[192:195], a[240:243], a[124:127], v[192:195]
  buffer_load_dwordx4 v2, s[20:23], s71 offen offset:896 lds
  ds_read_b64_tr_b16 a[236:237], v21 offset:648
  v_mul_f32 v118, s37, v118
  v_mfma_f32_16x16x32_bf16 v[200:203], a[240:243], a[128:131], v[200:203]
  ds_read_b64_tr_b16 a[238:239], v21 offset:904
  v_mul_f32 v119, s37, v119
  v_mfma_f32_16x16x32_bf16 v[200:203], a[244:247], a[140:143], v[200:203]
  v_cvt_pk_bf16_f32 v112, v112, v113
  v_cvt_pk_bf16_f32 v113, v114, v115
  s_waitcnt lgkmcnt(8)
  v_mfma_f32_16x16x32_bf16 v[204:207], a[252:255], a[140:143], v[204:207]
  ds_read_b64_tr_b16 a[240:241], v21 offset:192
  v_cvt_pk_bf16_f32 v114, v116, v117
  v_mfma_f32_16x16x32_bf16 v[204:207], a[248:251], a[128:131], v[204:207]
  ds_read_b64_tr_b16 a[242:243], v21 offset:448
  v_cvt_pk_bf16_f32 v115, v118, v119
  v_mul_f32 v120, s37, v120
  v_mfma_f32_16x16x32_bf16 v[196:199], a[248:251], a[124:127], v[196:199]
  v_mul_f32 v121, s37, v121
  v_mul_f32 v122, s37, v122
  v_mfma_f32_16x16x32_bf16 v[196:199], a[252:255], a[136:139], v[196:199]
  ds_read_b64_tr_b16 a[244:245], v21 offset:704
  v_mul_f32 v123, s37, v123
  v_mul_f32 v124, s37, v124
  v_mfma_f32_16x16x32_bf16 v[188:191], a[252:255], a[132:135], v[188:191]
  ds_read_b64_tr_b16 a[246:247], v21 offset:960
  v_mul_f32 v125, s37, v125
  v_mfma_f32_16x16x32_bf16 v[188:191], a[248:251], a[120:123], v[188:191]
  v_mul_f32 v126, s37, v126
  v_mul_f32 v127, s37, v127
  s_waitcnt lgkmcnt(8)
  v_mfma_f32_16x16x32_bf16 v[208:211], a[224:227], a[120:123], v[208:211]
  ds_read_b64_tr_b16 a[248:249], v21 offset:200
  v_cvt_pk_bf16_f32 v120, v120, v121
  v_mfma_f32_16x16x32_bf16 v[208:211], a[228:231], a[132:135], v[208:211]
  ds_read_b64_tr_b16 a[250:251], v21 offset:456
  v_cvt_pk_bf16_f32 v121, v122, v123
  v_cvt_pk_bf16_f32 v122, v124, v125
  v_mfma_f32_16x16x32_bf16 v[216:219], a[228:231], a[136:139], v[216:219]
  v_cvt_pk_bf16_f32 v123, v126, v127
  v_mul_f32 v128, s37, v128
  v_mfma_f32_16x16x32_bf16 v[216:219], a[224:227], a[124:127], v[216:219]
  ds_read_b64_tr_b16 a[252:253], v21 offset:712
  v_mul_f32 v129, s37, v129
  v_mul_f32 v130, s37, v130
  v_mfma_f32_16x16x32_bf16 v[224:227], a[224:227], a[128:131], v[224:227]
  ds_read_b64_tr_b16 a[254:255], v21 offset:968
  v_mul_f32 v131, s37, v131
  v_mfma_f32_16x16x32_bf16 v[224:227], a[228:231], a[140:143], v[224:227]
  v_mul_f32 v132, s37, v132
  v_mul_f32 v133, s37, v133
  s_waitcnt lgkmcnt(8)
  v_mfma_f32_16x16x32_bf16 v[228:231], a[236:239], a[140:143], v[228:231]
  s_waitcnt vmcnt(8)
  s_barrier
  v_mfma_f32_16x16x32_bf16 v[228:231], a[232:235], a[128:131], v[228:231]
  v_add_u32 v21, 50688, v20
  ds_read_b64_tr_b16 a[224:225], v21 offset:0
  v_mul_f32 v134, s37, v134
  v_mfma_f32_16x16x32_bf16 v[220:223], a[232:235], a[124:127], v[220:223]
  ds_read_b64_tr_b16 a[226:227], v21 offset:256
  s_add_u32 m0, s33, 16896
  s_add_u32 s34, s34, 0x1000
  v_mfma_f32_16x16x32_bf16 v[220:223], a[236:239], a[136:139], v[220:223]
  buffer_load_dwordx4 v1, s[8:11], s34 offen nt lds
  ds_read_b64_tr_b16 a[228:229], v21 offset:512
  v_mfma_f32_16x16x32_bf16 v[212:215], a[236:239], a[132:135], v[212:215]
  ds_read_b64_tr_b16 a[230:231], v21 offset:768
  v_mul_f32 v135, s37, v135
  v_mfma_f32_16x16x32_bf16 v[212:215], a[232:235], a[120:123], v[212:215]
  s_add_u32 m0, s33, 17952
  s_add_u32 s34, s34, 0x1000
  s_waitcnt lgkmcnt(8)
  v_mfma_f32_16x16x32_bf16 v[232:235], a[240:243], a[120:123], v[232:235]
  buffer_load_dwordx4 v1, s[8:11], s34 offen nt lds
  ds_read_b64_tr_b16 a[232:233], v21 offset:8
  v_mfma_f32_16x16x32_bf16 v[232:235], a[244:247], a[132:135], v[232:235]
  ds_read_b64_tr_b16 a[234:235], v21 offset:264
  v_cvt_pk_bf16_f32 v128, v128, v129
  v_cvt_pk_bf16_f32 v129, v130, v131
  v_mfma_f32_16x16x32_bf16 v[240:243], a[244:247], a[136:139], v[240:243]
  s_add_u32 m0, s33, 19008
  s_add_u32 s34, s34, 0x1000
  v_mfma_f32_16x16x32_bf16 v[240:243], a[240:243], a[124:127], v[240:243]
  buffer_load_dwordx4 v1, s[8:11], s34 offen nt lds
  ds_read_b64_tr_b16 a[236:237], v21 offset:520
  v_cvt_pk_bf16_f32 v130, v132, v133
  v_mfma_f32_16x16x32_bf16 v[248:251], a[240:243], a[128:131], v[248:251]
  ds_read_b64_tr_b16 a[238:239], v21 offset:776
  v_cvt_pk_bf16_f32 v131, v134, v135
  v_mfma_f32_16x16x32_bf16 v[248:251], a[244:247], a[140:143], v[248:251]
  s_add_u32 m0, s33, 20064
  s_add_u32 s34, s34, 0x1000
  s_waitcnt lgkmcnt(8)
  v_mfma_f32_16x16x32_bf16 v[252:255], a[252:255], a[140:143], v[252:255]
  buffer_load_dwordx4 v1, s[8:11], s34 offen nt lds
  ds_read_b64_tr_b16 a[240:241], v21 offset:64
  v_mfma_f32_16x16x32_bf16 v[252:255], a[248:251], a[128:131], v[252:255]
  ds_read_b64_tr_b16 a[242:243], v21 offset:320
  v_accvgpr_write_b32 a24, v112
  v_accvgpr_write_b32 a25, v113
  v_mfma_f32_16x16x32_bf16 v[244:247], a[248:251], a[124:127], v[244:247]
  s_add_u32 m0, s33, 118592
  v_accvgpr_write_b32 a26, v114
  v_accvgpr_write_b32 a27, v115
  v_mfma_f32_16x16x32_bf16 v[244:247], a[252:255], a[136:139], v[244:247]
  buffer_load_dwordx4 v2, s[20:23], s71 offen offset:1792 lds
  ds_read_b64_tr_b16 a[244:245], v21 offset:576
  v_mfma_f32_16x16x32_bf16 v[236:239], a[252:255], a[132:135], v[236:239]
  ds_read_b64_tr_b16 a[246:247], v21 offset:832
  v_accvgpr_write_b32 a28, v120
  v_mfma_f32_16x16x32_bf16 v[236:239], a[248:251], a[120:123], v[236:239]
  s_add_u32 m0, s33, 118752
  v_accvgpr_write_b32 a29, v121
  s_waitcnt lgkmcnt(8)
  v_mfma_f32_16x16x32_bf16 v[160:163], a[224:227], a[144:147], v[160:163]
  buffer_load_dwordx4 v2, s[20:23], s71 offen offset:2688 lds
  ds_read_b64_tr_b16 a[248:249], v21 offset:72
  v_mfma_f32_16x16x32_bf16 v[160:163], a[228:231], a[156:159], v[160:163]
  ds_read_b64_tr_b16 a[250:251], v21 offset:328
  v_accvgpr_write_b32 a30, v122
  v_mfma_f32_16x16x32_bf16 v[168:171], a[228:231], a[160:163], v[168:171]
  s_add_u32 m0, s33, 84480
  s_mov_b32 s71, 256
  v_mfma_f32_16x16x32_bf16 v[168:171], a[224:227], a[148:151], v[168:171]
  buffer_load_dwordx4 v2, s[20:23], s71 offen offset:0 lds
  ds_read_b64_tr_b16 a[252:253], v21 offset:584
  v_accvgpr_write_b32 a31, v123
  v_mfma_f32_16x16x32_bf16 v[176:179], a[224:227], a[152:155], v[176:179]
  ds_read_b64_tr_b16 a[254:255], v21 offset:840
  v_accvgpr_write_b32 a32, v128
  v_mfma_f32_16x16x32_bf16 v[176:179], a[228:231], a[164:167], v[176:179]
  s_branch L_page3
.p2align 12
L_hop3:
  s_branch L_walked0
  s_nop 0
L_page3:
  s_add_u32 m0, s33, 84640
  s_waitcnt lgkmcnt(8)
  v_mfma_f32_16x16x32_bf16 v[180:183], a[236:239], a[164:167], v[180:183]
  buffer_load_dwordx4 v2, s[20:23], s71 offen offset:896 lds
  ds_read_b64_tr_b16 a[224:225], v21 offset:128
  v_mfma_f32_16x16x32_bf16 v[180:183], a[232:235], a[152:155], v[180:183]
  ds_read_b64_tr_b16 a[226:227], v21 offset:384
  v_accvgpr_write_b32 a33, v129
  v_accvgpr_write_b32 a34, v130
  v_mfma_f32_16x16x32_bf16 v[172:175], a[232:235], a[148:151], v[172:175]
  v_accvgpr_write_b32 a35, v131
  v_mul_f32 v136, s37, v136
  v_mfma_f32_16x16x32_bf16 v[172:175], a[236:239], a[160:163], v[172:175]
  ds_read_b64_tr_b16 a[228:229], v21 offset:640
  v_mul_f32 v137, s37, v137
  v_mfma_f32_16x16x32_bf16 v[164:167], a[236:239], a[156:159], v[164:167]
  ds_read_b64_tr_b16 a[230:231], v21 offset:896
  v_mul_f32 v138, s37, v138
  v_mfma_f32_16x16x32_bf16 v[164:167], a[232:235], a[144:147], v[164:167]
  v_mul_f32 v139, s37, v139
  v_mul_f32 v140, s37, v140
  s_waitcnt lgkmcnt(8)
  v_mfma_f32_16x16x32_bf16 v[184:187], a[240:243], a[144:147], v[184:187]
  ds_read_b64_tr_b16 a[232:233], v21 offset:136
  v_mul_f32 v141, s37, v141
  v_mfma_f32_16x16x32_bf16 v[184:187], a[244:247], a[156:159], v[184:187]
  ds_read_b64_tr_b16 a[234:235], v21 offset:392
  v_mul_f32 v142, s37, v142
  v_mfma_f32_16x16x32_bf16 v[192:195], a[244:247], a[160:163], v[192:195]
  v_mul_f32 v143, s37, v143
  v_cvt_pk_bf16_f32 v136, v136, v137
  v_cvt_pk_bf16_f32 v137, v138, v139
  v_mfma_f32_16x16x32_bf16 v[192:195], a[240:243], a[148:151], v[192:195]
  ds_read_b64_tr_b16 a[236:237], v21 offset:648
  v_cvt_pk_bf16_f32 v138, v140, v141
  v_mfma_f32_16x16x32_bf16 v[200:203], a[240:243], a[152:155], v[200:203]
  ds_read_b64_tr_b16 a[238:239], v21 offset:904
  v_cvt_pk_bf16_f32 v139, v142, v143
  v_mfma_f32_16x16x32_bf16 v[200:203], a[244:247], a[164:167], v[200:203]
  v_mul_f32 v144, s37, v144
  s_waitcnt lgkmcnt(8)
  v_mfma_f32_16x16x32_bf16 v[204:207], a[252:255], a[164:167], v[204:207]
  ds_read_b64_tr_b16 a[240:241], v21 offset:192
  v_mul_f32 v145, s37, v145
  v_mul_f32 v146, s37, v146
  v_mfma_f32_16x16x32_bf16 v[204:207], a[248:251], a[152:155], v[204:207]
  ds_read_b64_tr_b16 a[242:243], v21 offset:448
  v_mul_f32 v147, s37, v147
  v_mfma_f32_16x16x32_bf16 v[196:199], a[248:251], a[148:151], v[196:199]
  v_mul_f32 v148, s37, v148
  v_mul_f32 v149, s37, v149
  v_mfma_f32_16x16x32_bf16 v[196:199], a[252:255], a[160:163], v[196:199]
  ds_read_b64_tr_b16 a[244:245], v21 offset:704
  v_mul_f32 v150, s37, v150
  v_mfma_f32_16x16x32_bf16 v[188:191], a[252:255], a[156:159], v[188:191]
  ds_read_b64_tr_b16 a[246:247], v21 offset:960
  v_mul_f32 v151, s37, v151
  v_cvt_pk_bf16_f32 v144, v144, v145
  v_mfma_f32_16x16x32_bf16 v[188:191], a[248:251], a[144:147], v[188:191]
  v_cvt_pk_bf16_f32 v145, v146, v147
  s_waitcnt lgkmcnt(8)
  v_mfma_f32_16x16x32_bf16 v[208:211], a[224:227], a[144:147], v[208:211]
  ds_read_b64_tr_b16 a[248:249], v21 offset:200
  v_cvt_pk_bf16_f32 v146, v148, v149
  v_mfma_f32_16x16x32_bf16 v[208:211], a[228:231], a[156:159], v[208:211]
  ds_read_b64_tr_b16 a[250:251], v21 offset:456
  v_cvt_pk_bf16_f32 v147, v150, v151
  v_mul_f32 v152, s37, v152
  v_mfma_f32_16x16x32_bf16 v[216:219], a[228:231], a[160:163], v[216:219]
  v_mul_f32 v153, s37, v153
  v_mul_f32 v154, s37, v154
  v_mfma_f32_16x16x32_bf16 v[216:219], a[224:227], a[148:151], v[216:219]
  ds_read_b64_tr_b16 a[252:253], v21 offset:712
  v_mul_f32 v155, s37, v155
  v_mfma_f32_16x16x32_bf16 v[224:227], a[224:227], a[152:155], v[224:227]
  ds_read_b64_tr_b16 a[254:255], v21 offset:968
  v_mul_f32 v156, s37, v156
  v_mfma_f32_16x16x32_bf16 v[224:227], a[228:231], a[164:167], v[224:227]
  v_mul_f32 v157, s37, v157
  v_mul_f32 v158, s37, v158
  s_waitcnt lgkmcnt(8)
  v_mfma_f32_16x16x32_bf16 v[228:231], a[236:239], a[164:167], v[228:231]
  s_waitcnt vmcnt(10)
  s_barrier
  v_mfma_f32_16x16x32_bf16 v[228:231], a[232:235], a[152:155], v[228:231]
  ds_read_b128 a[224:227], v3 offset:0
  v_mul_f32 v159, s37, v159
  v_mfma_f32_16x16x32_bf16 v[220:223], a[232:235], a[148:151], v[220:223]
  s_add_u32 m0, s33, 33792
  s_add_u32 s34, s34, 0x1000
  v_mfma_f32_16x16x32_bf16 v[220:223], a[236:239], a[160:163], v[220:223]
  buffer_load_dwordx4 v1, s[8:11], s34 offen nt lds
  ds_read_b128 a[228:231], v3 offset:64
  v_cvt_pk_bf16_f32 v152, v152, v153
  v_mfma_f32_16x16x32_bf16 v[212:215], a[236:239], a[156:159], v[212:215]
  v_cvt_pk_bf16_f32 v153, v154, v155
  v_cvt_pk_bf16_f32 v154, v156, v157
  v_mfma_f32_16x16x32_bf16 v[212:215], a[232:235], a[144:147], v[212:215]
  v_cvt_pk_bf16_f32 v155, v158, v159
  s_waitcnt lgkmcnt(6)
  v_mfma_f32_16x16x32_bf16 v[232:235], a[240:243], a[144:147], v[232:235]
  ds_read_b128 a[232:235], v3 offset:512
  v_accvgpr_write_b32 a36, v136
  v_accvgpr_write_b32 a37, v137
  v_mfma_f32_16x16x32_bf16 v[232:235], a[244:247], a[156:159], v[232:235]
  v_accvgpr_write_b32 a38, v138
  v_accvgpr_write_b32 a39, v139
  v_mfma_f32_16x16x32_bf16 v[240:243], a[244:247], a[160:163], v[240:243]
  s_add_u32 m0, s33, 34848
  s_add_u32 s34, s34, 0x1000
  v_mfma_f32_16x16x32_bf16 v[240:243], a[240:243], a[148:151], v[240:243]
  buffer_load_dwordx4 v1, s[8:11], s34 offen nt lds
  ds_read_b128 a[236:239], v3 offset:576
  v_mfma_f32_16x16x32_bf16 v[248:251], a[240:243], a[152:155], v[248:251]
  v_accvgpr_write_b32 a40, v144
  v_accvgpr_write_b32 a41, v145
  v_accvgpr_write_b32 a42, v146
  v_mfma_f32_16x16x32_bf16 v[248:251], a[244:247], a[164:167], v[248:251]
  v_accvgpr_write_b32 a43, v147
  s_waitcnt lgkmcnt(4)
  v_mfma_f32_16x16x32_bf16 v[252:255], a[252:255], a[164:167], v[252:255]
  ds_read_b128 a[240:243], v3 offset:128
  v_accvgpr_write_b32 a44, v152
  v_mfma_f32_16x16x32_bf16 v[252:255], a[248:251], a[152:155], v[252:255]
  v_accvgpr_write_b32 a45, v153
  v_accvgpr_write_b32 a46, v154
  v_mfma_f32_16x16x32_bf16 v[244:247], a[248:251], a[148:151], v[244:247]
  s_add_u32 m0, s33, 35904
  s_add_u32 s34, s34, 0x1000
  v_accvgpr_write_b32 a47, v155
  v_mfma_f32_16x16x32_bf16 v[244:247], a[252:255], a[160:163], v[244:247]
  buffer_load_dwordx4 v1, s[8:11], s34 offen nt lds
  ds_read_b128 a[244:247], v3 offset:192
  v_mfma_f32_16x16x32_bf16 v[236:239], a[252:255], a[156:159], v[236:239]
  v_mfma_f32_16x16x32_bf16 v[236:239], a[248:251], a[144:147], v[236:239]
  s_waitcnt lgkmcnt(4)
  v_mfma_f32_16x16x32_bf16 v[40:43], a[224:227], a[0:3], 0
  ds_read_b128 a[248:251], v3 offset:640
  v_mul_f32 v160, s37, v160
  v_mul_f32 v161, s37, v161
  v_mul_f32 v162, s37, v162
  v_mul_f32 v163, s37, v163
  v_mfma_f32_16x16x32_bf16 v[40:43], a[228:231], a[12:15], v[40:43]
  v_mul_f32 v164, s37, v164
  v_mul_f32 v165, s37, v165
  v_mul_f32 v166, s37, v166
  v_mul_f32 v167, s37, v167
  v_cvt_pk_bf16_f32 v160, v160, v161
  v_mfma_f32_16x16x32_bf16 v[44:47], a[228:231], a[16:19], 0
  s_add_u32 m0, s33, 36960
  s_add_u32 s34, s34, 0x1000
  v_cvt_pk_bf16_f32 v161, v162, v163
  v_cvt_pk_bf16_f32 v162, v164, v165
  v_cvt_pk_bf16_f32 v163, v166, v167
  v_mfma_f32_16x16x32_bf16 v[44:47], a[224:227], a[4:7], v[44:47]
  buffer_load_dwordx4 v1, s[8:11], s34 offen nt lds
  ds_read_b128 a[252:255], v3 offset:704
  v_mul_f32 v168, s37, v168
  v_mul_f32 v169, s37, v169
  v_mul_f32 v170, s37, v170
  v_mfma_f32_16x16x32_bf16 v[48:51], a[224:227], a[8:11], 0
  v_mul_f32 v171, s37, v171
  v_mul_f32 v172, s37, v172
  v_mul_f32 v173, s37, v173
  v_mul_f32 v174, s37, v174
  v_mul_f32 v175, s37, v175
  v_mfma_f32_16x16x32_bf16 v[48:51], a[228:231], a[20:23], v[48:51]
  v_cvt_pk_bf16_f32 v168, v168, v169
  v_cvt_pk_bf16_f32 v169, v170, v171
  v_cvt_pk_bf16_f32 v170, v172, v173
  v_cvt_pk_bf16_f32 v171, v174, v175
  s_waitcnt lgkmcnt(4)
  v_mfma_f32_16x16x32_bf16 v[60:63], a[232:235], a[8:11], 0
  ds_read_b128 a[224:227], v3 offset:256
  v_mul_f32 v176, s37, v176
  v_mul_f32 v177, s37, v177
  v_mul_f32 v178, s37, v178
  v_mul_f32 v179, s37, v179
  v_mfma_f32_16x16x32_bf16 v[60:63], a[236:239], a[20:23], v[60:63]
  v_mul_f32 v180, s37, v180
  v_mul_f32 v181, s37, v181
  v_mul_f32 v182, s37, v182
  v_mul_f32 v183, s37, v183
  v_cvt_pk_bf16_f32 v176, v176, v177
  v_cvt_pk_bf16_f32 v177, v178, v179
  v_mfma_f32_16x16x32_bf16 v[56:59], a[236:239], a[16:19], 0
  global_load_dword a182, v8, s[88:89]
  s_add_u32 m0, s33, 84800
  v_cvt_pk_bf16_f32 v178, v180, v181
  v_cvt_pk_bf16_f32 v179, v182, v183
  v_mul_f32 v184, s37, v184
  v_mfma_f32_16x16x32_bf16 v[56:59], a[232:235], a[4:7], v[56:59]
  buffer_load_dwordx4 v2, s[20:23], s71 offen offset:1792 lds
  ds_read_b128 a[228:231], v3 offset:320
  v_mul_f32 v185, s37, v185
  v_mul_f32 v186, s37, v186
  v_mul_f32 v187, s37, v187
  v_mfma_f32_16x16x32_bf16 v[52:55], a[232:235], a[0:3], 0
  v_mul_f32 v188, s37, v188
  v_mul_f32 v189, s37, v189
  v_mul_f32 v190, s37, v190
  v_mul_f32 v191, s37, v191
  v_cvt_pk_bf16_f32 v184, v184, v185
  v_mfma_f32_16x16x32_bf16 v[52:55], a[236:239], a[12:15], v[52:55]
  v_cvt_pk_bf16_f32 v185, v186, v187
  v_cvt_pk_bf16_f32 v186, v188, v189
  v_cvt_pk_bf16_f32 v187, v190, v191
  v_mul_f32 v192, s37, v192
  s_waitcnt lgkmcnt(4)
  v_mfma_f32_16x16x32_bf16 v[40:43], a[240:243], a[24:27], v[40:43]
  ds_read_b128 a[232:235], v3 offset:768
  v_mul_f32 v193, s37, v193
  v_mul_f32 v194, s37, v194
  v_mul_f32 v195, s37, v195
  v_mul_f32 v196, s37, v196
  v_mfma_f32_16x16x32_bf16 v[40:43], a[244:247], a[36:39], v[40:43]
  v_mul_f32 v197, s37, v197
  v_mul_f32 v198, s37, v198
  v_mul_f32 v199, s37, v199
  v_cvt_pk_bf16_f32 v192, v192, v193
  v_cvt_pk_bf16_f32 v193, v194, v195
  v_mfma_f32_16x16x32_bf16 v[44:47], a[244:247], a[40:43], v[44:47]
  s_add_u32 m0, s33, 84960
  v_cvt_pk_bf16_f32 v194, v196, v197
  v_cvt_pk_bf16_f32 v195, v198, v199
  v_mul_f32 v200, s37, v200
  v_mul_f32 v201, s37, v201
  v_mfma_f32_16x16x32_bf16 v[44:47], a[240:243], a[28:31], v[44:47]
  buffer_load_dwordx4 v2, s[20:23], s71 offen offset:2688 lds
  ds_read_b128 a[236:239], v3 offset:832
  v_mul_f32 v202, s37, v202
  v_mul_f32 v203, s37, v203
  v_mul_f32 v204, s37, v204
  v_mul_f32 v205, s37, v205
  v_mfma_f32_16x16x32_bf16 v[48:51], a[240:243], a[32:35], v[48:51]
  v_mul_f32 v206, s37, v206
  v_mul_f32 v207, s37, v207
  v_cvt_pk_bf16_f32 v200, v200, v201
  v_cvt_pk_bf16_f32 v201, v202, v203
  v_cvt_pk_bf16_f32 v202, v204, v205
  v_mfma_f32_16x16x32_bf16 v[48:51], a[244:247], a[44:47], v[48:51]
  v_cvt_pk_bf16_f32 v203, v206, v207
  v_mul_f32 v208, s37, v208
  v_mul_f32 v209, s37, v209
  v_mul_f32 v210, s37, v210
  s_waitcnt lgkmcnt(4)
  v_mfma_f32_16x16x32_bf16 v[60:63], a[248:251], a[32:35], v[60:63]
  ds_read_b128 a[240:243], v3 offset:384
  v_mul_f32 v211, s37, v211
  v_mul_f32 v212, s37, v212
  v_mul_f32 v213, s37, v213
  v_mul_f32 v214, s37, v214
  v_mfma_f32_16x16x32_bf16 v[60:63], a[252:255], a[44:47], v[60:63]
  v_mul_f32 v215, s37, v215
  v_cvt_pk_bf16_f32 v208, v208, v209
  v_cvt_pk_bf16_f32 v209, v210, v211
  v_cvt_pk_bf16_f32 v210, v212, v213
  v_cvt_pk_bf16_f32 v211, v214, v215
  v_mfma_f32_16x16x32_bf16 v[56:59], a[252:255], a[40:43], v[56:59]
  v_mul_f32 v216, s37, v216
  v_mul_f32 v217, s37, v217
  v_mul_f32 v218, s37, v218
  v_mul_f32 v219, s37, v219
  v_mul_f32 v220, s37, v220
  v_mfma_f32_16x16x32_bf16 v[56:59], a[248:251], a[28:31], v[56:59]
  ds_read_b128 a[244:247], v3 offset:448
  v_mul_f32 v221, s37, v221
  v_mul_f32 v222, s37, v222
  v_mul_f32 v223, s37, v223
  v_cvt_pk_bf16_f32 v216, v216, v217
  v_mfma_f32_16x16x32_bf16 v[52:55], a[248:251], a[24:27], v[52:55]
  v_cvt_pk_bf16_f32 v217, v218, v219
  v_cvt_pk_bf16_f32 v218, v220, v221
  v_cvt_pk_bf16_f32 v219, v222, v223
  v_mul_f32 v224, s37, v224
  v_mul_f32 v225, s37, v225
  v_mul_f32 v226, s37, v226
  v_mfma_f32_16x16x32_bf16 v[52:55], a[252:255], a[36:39], v[52:55]
  v_mul_f32 v227, s37, v227
  v_mul_f32 v228, s37, v228
  v_mul_f32 v229, s37, v229
  v_mul_f32 v230, s37, v230
  s_waitcnt lgkmcnt(4)
  v_mfma_f32_16x16x32_bf16 v[40:43], a[224:227], v[160:163], v[40:43]
  ds_read_b128 a[248:251], v3 offset:896
  v_mul_f32 v231, s37, v231
  v_cvt_pk_bf16_f32 v224, v224, v225
  v_cvt_pk_bf16_f32 v225, v226, v227
  v_cvt_pk_bf16_f32 v226, v228, v229
  v_mfma_f32_16x16x32_bf16 v[40:43], a[228:231], v[184:187], v[40:43]
  v_cvt_pk_bf16_f32 v227, v230, v231
  v_mul_f32 v232, s37, v232
  v_mul_f32 v233, s37, v233
  v_mul_f32 v234, s37, v234
  v_mul_f32 v235, s37, v235
  v_mfma_f32_16x16x32_bf16 v[44:47], a[228:231], v[192:195], v[44:47]
  v_mul_f32 v236, s37, v236
  v_mul_f32 v237, s37, v237
  v_mul_f32 v238, s37, v238
  v_mul_f32 v239, s37, v239
  v_cvt_pk_bf16_f32 v188, v232, v233
  v_mfma_f32_16x16x32_bf16 v[44:47], a[224:227], v[168:171], v[44:47]
  ds_read_b128 a[252:255], v3 offset:960
  v_cvt_pk_bf16_f32 v189, v234, v235
  v_cvt_pk_bf16_f32 v190, v236, v237
  v_cvt_pk_bf16_f32 v191, v238, v239
  v_mul_f32 v240, s37, v240
  v_mfma_f32_16x16x32_bf16 v[48:51], a[224:227], v[176:179], v[48:51]
  v_mul_f32 v241, s37, v241
  v_mul_f32 v242, s37, v242
  v_mul_f32 v243, s37, v243
  v_mul_f32 v244, s37, v244
  v_mul_f32 v245, s37, v245
  v_mfma_f32_16x16x32_bf16 v[48:51], a[228:231], v[200:203], v[48:51]
  v_mul_f32 v246, s37, v246
  v_mul_f32 v247, s37, v247
  v_cvt_pk_bf16_f32 v196, v240, v241
  v_cvt_pk_bf16_f32 v197, v242, v243
  v_cvt_pk_bf16_f32 v198, v244, v245
  s_waitcnt lgkmcnt(4)
  v_mfma_f32_16x16x32_bf16 v[60:63], a[232:235], v[176:179], v[60:63]
  s_waitcnt vmcnt(11)
  s_barrier
  v_cvt_pk_bf16_f32 v199, v246, v247
  v_mul_f32 v248, s37, v248
  v_mul_f32 v249, s37, v249
  v_mfma_f32_16x16x32_bf16 v[60:63], a[236:239], v[200:203], v[60:63]
  ds_read_b128 a[224:227], v3 offset:16896
  v_mul_f32 v250, s37, v250
  v_mul_f32 v251, s37, v251
  v_mul_f32 v252, s37, v252
  v_mul_f32 v253, s37, v253
  v_mfma_f32_16x16x32_bf16 v[56:59], a[236:239], v[192:195], v[56:59]
  s_add_u32 m0, s33, 50688
  s_add_u32 s35, s35, 0x4f00
  v_mul_f32 v254, s37, v254
  v_mul_f32 v255, s37, v255
  v_cvt_pk_bf16_f32 v204, v248, v249
  v_mfma_f32_16x16x32_bf16 v[56:59], a[232:235], v[168:171], v[56:59]
  buffer_load_dwordx4 v4, s[12:15], s35 offen nt lds
  ds_read_b128 a[228:231], v3 offset:16960
  v_cvt_pk_bf16_f32 v205, v250, v251
  v_cvt_pk_bf16_f32 v206, v252, v253
  v_cvt_pk_bf16_f32 v207, v254, v255
  v_mfma_f32_16x16x32_bf16 v[52:55], a[232:235], v[160:163], v[52:55]
  v_mfma_f32_16x16x32_bf16 v[52:55], a[236:239], v[184:187], v[52:55]
  s_add_u32 m0, s33, 51744
  s_add_u32 s35, s35, 0x1000
  s_waitcnt lgkmcnt(4)
  v_mfma_f32_16x16x32_bf16 v[40:43], a[240:243], v[208:211], v[40:43]
  buffer_load_dwordx4 v4, s[12:15], s35 offen nt lds
  ds_read_b128 a[232:235], v3 offset:17024
  v_mfma_f32_16x16x32_bf16 v[40:43], a[244:247], v[188:191], v[40:43]
  v_mfma_f32_16x16x32_bf16 v[44:47], a[244:247], v[196:199], v[44:47]
  s_add_u32 m0, s33, 52800
  s_add_u32 s35, s35, 0x1000
  v_mfma_f32_16x16x32_bf16 v[44:47], a[240:243], v[216:219], v[44:47]
  buffer_load_dwordx4 v4, s[12:15], s35 offen nt lds
  ds_read_b128 a[236:239], v3 offset:17088
  v_mfma_f32_16x16x32_bf16 v[48:51], a[240:243], v[224:227], v[48:51]
  v_mfma_f32_16x16x32_bf16 v[48:51], a[244:247], v[204:207], v[48:51]
  s_add_u32 m0, s33, 53856
  s_add_u32 s35, s35, 0x1000
  s_waitcnt lgkmcnt(4)
  v_mfma_f32_16x16x32_bf16 v[60:63], a[248:251], v[224:227], v[60:63]
  buffer_load_dwordx4 v4, s[12:15], s35 offen nt lds
  ds_read_b128 a[240:243], v3 offset:17152
  v_mfma_f32_16x16x32_bf16 v[60:63], a[252:255], v[204:207], v[60:63]
  v_mfma_f32_16x16x32_bf16 v[56:59], a[252:255], v[196:199], v[56:59]
  v_mfma_f32_16x16x32_bf16 v[56:59], a[248:251], v[216:219], v[56:59]
  ds_read_b128 a[244:247], v3 offset:17216
  v_mfma_f32_16x16x32_bf16 v[52:55], a[248:251], v[208:211], v[52:55]
  v_mfma_f32_16x16x32_bf16 v[52:55], a[252:255], v[188:191], v[52:55]
  s_nop 7
  v_max_f32 v16, v40, v41
  v_max3_f32 v16, v16, v42, v43
  v_max3_f32 v16, v16, v52, v53
  v_max3_f32 v16, v16, v54, v55
  v_max_f32 v18, v44, v45
  v_max3_f32 v18, v18, v46, v47
  v_max3_f32 v18, v18, v56, v57
  v_max3_f32 v18, v18, v58, v59
  v_max_f32 v20, v48, v49
  v_max3_f32 v20, v20, v50, v51
  v_max3_f32 v20, v20, v60, v61
  v_max3_f32 v20, v20, v62, v63
  v_mov_b32 v17, v16
  v_mov_b32 v19, v18
  v_mov_b32 v21, v20
  s_nop 0
  v_permlane32_swap_b32 v16, v17
  v_permlane32_swap_b32 v18, v19
  v_permlane32_swap_b32 v20, v21
  v_max_f32 v16, v16, v17
  v_max_f32 v18, v18, v19
  v_max_f32 v20, v20, v21
  v_mov_b32 v17, v16
  v_mov_b32 v19, v18
  v_mov_b32 v21, v20
  s_nop 0
  v_permlane16_swap_b32 v16, v17
  v_permlane16_swap_b32 v18, v19
  v_permlane16_swap_b32 v20, v21
  v_max_f32 v16, v16, v17
  v_max_f32 v18, v18, v19
  v_max_f32 v20, v20, v21
  v_sub_f32 v28, 0, v16
  v_sub_f32 v29, 0, v16
  v_sub_f32 v30, 0, v16
  v_sub_f32 v31, 0, v16
  v_sub_f32 v32, 0, v18
  v_sub_f32 v33, 0, v18
  v_sub_f32 v34, 0, v18
  v_sub_f32 v35, 0, v18
  v_sub_f32 v36, 0, v20
  v_sub_f32 v37, 0, v20
  v_sub_f32 v38, 0, v20
  v_sub_f32 v39, 0, v20
  v_add_f32 v40, v40, v28
  v_add_f32 v41, v41, v28
  v_add_f32 v42, v42, v28
  v_add_f32 v43, v43, v28
  v_add_f32 v44, v44, v32
  v_add_f32 v45, v45, v32
  v_add_f32 v46, v46, v32
  v_add_f32 v47, v47, v32
  v_add_f32 v48, v48, v36
  v_add_f32 v49, v49, v36
  v_add_f32 v50, v50, v36
  v_add_f32 v51, v51, v36
  v_add_f32 v52, v52, v28
  v_add_f32 v53, v53, v28
  v_add_f32 v54, v54, v28
  v_add_f32 v55, v55, v28
  v_add_f32 v56, v56, v32
  v_add_f32 v57, v57, v32
  v_add_f32 v58, v58, v32
  v_add_f32 v59, v59, v32
  v_add_f32 v60, v60, v36
  v_add_f32 v61, v61, v36
  v_add_f32 v62, v62, v36
  v_add_f32 v63, v63, v36
L_attn:
  s_waitcnt lgkmcnt(4)
  v_mfma_f32_16x16x32_bf16 v[64:67], a[224:227], a[0:3], v[28:31]
  ds_read_b128 a[248:251], v3 offset:17280
  v_mfma_f32_16x16x32_bf16 v[64:67], a[228:231], a[12:15], v[64:67]
  v_exp_f32 v40, v40
  v_mfma_f32_16x16x32_bf16 v[68:71], a[228:231], a[16:19], v[32:35]
  v_exp_f32 v41, v41
  v_mfma_f32_16x16x32_bf16 v[68:71], a[224:227], a[4:7], v[68:71]
  ds_read_b128 a[252:255], v3 offset:17344
  v_exp_f32 v42, v42
  v_mfma_f32_16x16x32_bf16 v[72:75], a[224:227], a[8:11], v[36:39]
  v_exp_f32 v43, v43
  v_mfma_f32_16x16x32_bf16 v[72:75], a[228:231], a[20:23], v[72:75]
  s_waitcnt lgkmcnt(4)
  v_mfma_f32_16x16x32_bf16 v[72:75], a[232:235], a[32:35], v[72:75]
  ds_read_b128 a[224:227], v3 offset:17792
  v_exp_f32 v44, v44
  v_mfma_f32_16x16x32_bf16 v[72:75], a[236:239], a[44:47], v[72:75]
  v_exp_f32 v45, v45
  v_mfma_f32_16x16x32_bf16 v[68:71], a[236:239], a[40:43], v[68:71]
  v_exp_f32 v46, v46
  v_mfma_f32_16x16x32_bf16 v[68:71], a[232:235], a[28:31], v[68:71]
  ds_read_b128 a[228:231], v3 offset:17856
  v_mfma_f32_16x16x32_bf16 v[64:67], a[232:235], a[24:27], v[64:67]
  v_exp_f32 v47, v47
  v_mfma_f32_16x16x32_bf16 v[64:67], a[236:239], a[36:39], v[64:67]
  v_exp_f32 v48, v48
  s_waitcnt lgkmcnt(4)
  v_mfma_f32_16x16x32_bf16 v[64:67], a[240:243], v[160:163], v[64:67]
  ds_read_b128 a[232:235], v3 offset:17664
  v_mfma_f32_16x16x32_bf16 v[64:67], a[244:247], v[184:187], v[64:67]
  v_exp_f32 v49, v49
  v_mfma_f32_16x16x32_bf16 v[68:71], a[244:247], v[192:195], v[68:71]
  v_exp_f32 v50, v50
  v_mfma_f32_16x16x32_bf16 v[68:71], a[240:243], v[168:171], v[68:71]
  ds_read_b128 a[236:239], v3 offset:17728
  v_exp_f32 v51, v51
  v_mfma_f32_16x16x32_bf16 v[72:75], a[240:243], v[176:179], v[72:75]
  v_exp_f32 v52, v52
  v_mfma_f32_16x16x32_bf16 v[72:75], a[244:247], v[200:203], v[72:75]
  s_waitcnt lgkmcnt(4)
  v_mfma_f32_16x16x32_bf16 v[72:75], a[248:251], v[224:227], v[72:75]
  ds_read_b128 a[240:243], v3 offset:17536
  v_exp_f32 v53, v53
  v_mfma_f32_16x16x32_bf16 v[72:75], a[252:255], v[204:207], v[72:75]
  v_exp_f32 v54, v54
  v_mfma_f32_16x16x32_bf16 v[68:71], a[252:255], v[196:199], v[68:71]
  v_exp_f32 v55, v55
  v_mfma_f32_16x16x32_bf16 v[68:71], a[248:251], v[216:219], v[68:71]
  ds_read_b128 a[244:247], v3 offset:17600
  v_mfma_f32_16x16x32_bf16 v[64:67], a[248:251], v[208:211], v[64:67]
  v_exp_f32 v56, v56
  v_mfma_f32_16x16x32_bf16 v[64:67], a[252:255], v[188:191], v[64:67]
  v_exp_f32 v57, v57
  s_waitcnt lgkmcnt(4)
  v_mfma_f32_16x16x32_bf16 v[76:79], a[224:227], v[208:211], v[28:31]
  ds_read_b128 a[248:251], v3 offset:17408
  v_mfma_f32_16x16x32_bf16 v[76:79], a[228:231], v[188:191], v[76:79]
  v_exp_f32 v58, v58
  v_mfma_f32_16x16x32_bf16 v[80:83], a[228:231], v[196:199], v[32:35]
  v_exp_f32 v59, v59
  v_mfma_f32_16x16x32_bf16 v[80:83], a[224:227], v[216:219], v[80:83]
  ds_read_b128 a[252:255], v3 offset:17472
  v_exp_f32 v60, v60
  v_mfma_f32_16x16x32_bf16 v[84:87], a[224:227], v[224:227], v[36:39]
  v_exp_f32 v61, v61
  v_mfma_f32_16x16x32_bf16 v[84:87], a[228:231], v[204:207], v[84:87]
  s_waitcnt lgkmcnt(4)
  v_mfma_f32_16x16x32_bf16 v[84:87], a[232:235], v[176:179], v[84:87]
  s_waitcnt vmcnt(7)
  s_barrier
  v_mfma_f32_16x16x32_bf16 v[84:87], a[236:239], v[200:203], v[84:87]
  ds_read_b128 a[224:227], v3 offset:33792
  v_exp_f32 v62, v62
  v_mfma_f32_16x16x32_bf16 v[80:83], a[236:239], v[192:195], v[80:83]
  s_add_u32 m0, s33, 0
  s_add_u32 s34, s34, 0x1000
  v_mfma_f32_16x16x32_bf16 v[80:83], a[232:235], v[168:171], v[80:83]
  buffer_load_dwordx4 v1, s[8:11], s34 offen nt lds
  ds_read_b128 a[228:231], v3 offset:33856
  v_mfma_f32_16x16x32_bf16 v[76:79], a[232:235], v[160:163], v[76:79]
  v_exp_f32 v63, v63
  v_mfma_f32_16x16x32_bf16 v[76:79], a[236:239], v[184:187], v[76:79]
  v_cvt_pk_bf16_f32 v16, v40, v41
  s_waitcnt lgkmcnt(4)
  v_mfma_f32_16x16x32_bf16 v[76:79], a[240:243], a[24:27], v[76:79]
  s_waitcnt vmcnt(4)
  ds_read_b128 a[232:235], v3 offset:33920
  v_mfma_f32_16x16x32_bf16 v[76:79], a[244:247], a[36:39], v[76:79]
  v_cvt_pk_bf16_f32 v17, v42, v43
  v_cvt_pk_bf16_f32 v20, v44, v45
  v_mfma_f32_16x16x32_bf16 v[80:83], a[244:247], a[40:43], v[80:83]
  v_cvt_pk_bf16_f32 v21, v46, v47
  v_cvt_pk_bf16_f32 v24, v48, v49
  v_mfma_f32_16x16x32_bf16 v[80:83], a[240:243], a[28:31], v[80:83]
  ds_read_b128 a[236:239], v3 offset:33984
  v_cvt_pk_bf16_f32 v25, v50, v51
  v_mfma_f32_16x16x32_bf16 v[84:87], a[240:243], a[32:35], v[84:87]
  v_cvt_pk_bf16_f32 v18, v52, v53
  v_cvt_pk_bf16_f32 v19, v54, v55
  v_cvt_pk_bf16_f32 v22, v56, v57
  v_mfma_f32_16x16x32_bf16 v[84:87], a[244:247], a[44:47], v[84:87]
  v_cvt_pk_bf16_f32 v23, v58, v59
  s_waitcnt lgkmcnt(4)
  v_mfma_f32_16x16x32_bf16 v[84:87], a[248:251], a[8:11], v[84:87]
  ds_read_b128 a[240:243], v3 offset:34048
  v_cvt_pk_bf16_f32 v26, v60, v61
  v_mfma_f32_16x16x32_bf16 v[84:87], a[252:255], a[20:23], v[84:87]
  v_cvt_pk_bf16_f32 v27, v62, v63
  v_mfma_f32_16x16x32_bf16 v[80:83], a[252:255], a[16:19], v[80:83]
  s_add_u32 m0, s33, 1056
  s_add_u32 s34, s34, 0x1000
  v_mfma_f32_16x16x32_bf16 v[80:83], a[248:251], a[4:7], v[80:83]
  buffer_load_dwordx4 v1, s[8:11], s34 offen nt lds
  ds_read_b128 a[244:247], v3 offset:34112
  v_mfma_f32_16x16x32_bf16 v[76:79], a[248:251], a[0:3], v[76:79]
  v_mfma_f32_16x16x32_bf16 v[76:79], a[252:255], a[12:15], v[76:79]
  s_waitcnt lgkmcnt(4)
  v_mfma_f32_16x16x32_bf16 v[40:43], a[224:227], a[0:3], v[28:31]
  s_waitcnt vmcnt(4)
  ds_read_b128 a[248:251], v3 offset:34176
  v_mfma_f32_16x16x32_bf16 v[40:43], a[228:231], a[12:15], v[40:43]
  v_exp_f32 v64, v64
  v_mfma_f32_16x16x32_bf16 v[44:47], a[228:231], a[16:19], v[32:35]
  v_exp_f32 v65, v65
  v_mfma_f32_16x16x32_bf16 v[44:47], a[224:227], a[4:7], v[44:47]
  ds_read_b128 a[252:255], v3 offset:34240
  v_exp_f32 v66, v66
  v_mfma_f32_16x16x32_bf16 v[48:51], a[224:227], a[8:11], v[36:39]
  v_exp_f32 v67, v67
  v_mfma_f32_16x16x32_bf16 v[48:51], a[228:231], a[20:23], v[48:51]
  v_exp_f32 v68, v68
  s_waitcnt lgkmcnt(4)
  v_mfma_f32_16x16x32_bf16 v[48:51], a[232:235], a[32:35], v[48:51]
  ds_read_b128 a[224:227], v3 offset:34688
  v_mfma_f32_16x16x32_bf16 v[48:51], a[236:239], a[44:47], v[48:51]
  v_exp_f32 v69, v69
  v_mfma_f32_16x16x32_bf16 v[44:47], a[236:239], a[40:43], v[44:47]
  s_add_u32 m0, s33, 2112
  s_add_u32 s34, s34, 0x1000
  v_mfma_f32_16x16x32_bf16 v[44:47], a[232:235], a[28:31], v[44:47]
  buffer_load_dwordx4 v1, s[8:11], s34 offen nt lds
  ds_read_b128 a[228:231], v3 offset:34752
  v_mfma_f32_16x16x32_bf16 v[40:43], a[232:235], a[24:27], v[40:43]
  v_exp_f32 v70, v70
  v_mfma_f32_16x16x32_bf16 v[40:43], a[236:239], a[36:39], v[40:43]
  v_exp_f32 v71, v71
  s_waitcnt lgkmcnt(4)
  v_mfma_f32_16x16x32_bf16 v[40:43], a[240:243], v[160:163], v[40:43]
  s_waitcnt vmcnt(4)
  ds_read_b128 a[232:235], v3 offset:34560
  v_mfma_f32_16x16x32_bf16 v[40:43], a[244:247], v[184:187], v[40:43]
  v_exp_f32 v72, v72
  v_mfma_f32_16x16x32_bf16 v[44:47], a[244:247], v[192:195], v[44:47]
  v_exp_f32 v73, v73
  v_mfma_f32_16x16x32_bf16 v[44:47], a[240:243], v[168:171], v[44:47]
  ds_read_b128 a[236:239], v3 offset:34624
  v_exp_f32 v74, v74
  v_mfma_f32_16x16x32_bf16 v[48:51], a[240:243], v[176:179], v[48:51]
  v_exp_f32 v75, v75
  v_mfma_f32_16x16x32_bf16 v[48:51], a[244:247], v[200:203], v[48:51]
  v_exp_f32 v76, v76
  s_waitcnt lgkmcnt(4)
  v_mfma_f32_16x16x32_bf16 v[48:51], a[248:251], v[224:227], v[48:51]
  ds_read_b128 a[240:243], v3 offset:34432
  v_mfma_f32_16x16x32_bf16 v[48:51], a[252:255], v[204:207], v[48:51]
  v_exp_f32 v77, v77
  v_mfma_f32_16x16x32_bf16 v[44:47], a[252:255], v[196:199], v[44:47]
  s_add_u32 m0, s33, 3168
  s_add_u32 s34, s34, 0x1000
  v_mfma_f32_16x16x32_bf16 v[44:47], a[248:251], v[216:219], v[44:47]
  buffer_load_dwordx4 v1, s[8:11], s34 offen nt lds
  ds_read_b128 a[244:247], v3 offset:34496
  v_mfma_f32_16x16x32_bf16 v[40:43], a[248:251], v[208:211], v[40:43]
  v_exp_f32 v78, v78
  v_mfma_f32_16x16x32_bf16 v[40:43], a[252:255], v[188:191], v[40:43]
  v_exp_f32 v79, v79
  s_waitcnt lgkmcnt(4)
  v_mfma_f32_16x16x32_bf16 v[52:55], a[224:227], v[208:211], v[28:31]
  s_waitcnt vmcnt(4)
  ds_read_b128 a[248:251], v3 offset:34304
  v_mfma_f32_16x16x32_bf16 v[52:55], a[228:231], v[188:191], v[52:55]
  v_exp_f32 v80, v80
  v_mfma_f32_16x16x32_bf16 v[56:59], a[228:231], v[196:199], v[32:35]
  v_exp_f32 v81, v81
  v_mfma_f32_16x16x32_bf16 v[56:59], a[224:227], v[216:219], v[56:59]
  ds_read_b128 a[252:255], v3 offset:34368
  v_exp_f32 v82, v82
  v_mfma_f32_16x16x32_bf16 v[60:63], a[224:227], v[224:227], v[36:39]
  v_exp_f32 v83, v83
  v_mfma_f32_16x16x32_bf16 v[60:63], a[228:231], v[204:207], v[60:63]
  v_exp_f32 v84, v84
  s_waitcnt lgkmcnt(4)
  v_mfma_f32_16x16x32_bf16 v[60:63], a[232:235], v[176:179], v[60:63]
  s_waitcnt vmcnt(4)
  s_barrier
  v_mfma_f32_16x16x32_bf16 v[60:63], a[236:239], v[200:203], v[60:63]
  ds_read_b64_tr_b16 a[224:225], v5 offset:50688
  v_exp_f32 v85, v85
  v_mfma_f32_16x16x32_bf16 v[56:59], a[236:239], v[192:195], v[56:59]
  s_branch L_page4
.p2align 12
L_hop4:
  s_branch L_walked0
  s_nop 0
L_page4:
  ds_read_b64_tr_b16 a[226:227], v5 offset:50944
  s_add_u32 m0, s33, 16896
  s_add_u32 s35, s35, 0xffffd100
  v_mfma_f32_16x16x32_bf16 v[56:59], a[232:235], v[168:171], v[56:59]
  buffer_load_dwordx4 v4, s[12:15], s35 offen nt lds
  ds_read_b64_tr_b16 a[228:229], v5 offset:51200
  v_mfma_f32_16x16x32_bf16 v[52:55], a[232:235], v[160:163], v[52:55]
  ds_read_b64_tr_b16 a[230:231], v5 offset:51456
  v_mfma_f32_16x16x32_bf16 v[52:55], a[236:239], v[184:187], v[52:55]
  v_exp_f32 v86, v86
  s_waitcnt lgkmcnt(6)
  v_mfma_f32_16x16x32_bf16 v[52:55], a[240:243], a[24:27], v[52:55]
  s_waitcnt vmcnt(4)
  ds_read_b64_tr_b16 a[232:233], v5 offset:50720
  v_mfma_f32_16x16x32_bf16 v[52:55], a[244:247], a[36:39], v[52:55]
  ds_read_b64_tr_b16 a[234:235], v5 offset:50976
  v_exp_f32 v87, v87
  v_mfma_f32_16x16x32_bf16 v[56:59], a[244:247], a[40:43], v[56:59]
  v_cvt_pk_bf16_f32 v240, v64, v65
  v_cvt_pk_bf16_f32 v241, v66, v67
  v_cvt_pk_bf16_f32 v244, v68, v69
  v_mfma_f32_16x16x32_bf16 v[56:59], a[240:243], a[28:31], v[56:59]
  ds_read_b64_tr_b16 a[236:237], v5 offset:51232
  v_cvt_pk_bf16_f32 v245, v70, v71
  v_cvt_pk_bf16_f32 v248, v72, v73
  v_mfma_f32_16x16x32_bf16 v[60:63], a[240:243], a[32:35], v[60:63]
  ds_read_b64_tr_b16 a[238:239], v5 offset:51488
  v_cvt_pk_bf16_f32 v249, v74, v75
  v_mfma_f32_16x16x32_bf16 v[60:63], a[244:247], a[44:47], v[60:63]
  v_cvt_pk_bf16_f32 v242, v76, v77
  v_cvt_pk_bf16_f32 v243, v78, v79
  s_waitcnt lgkmcnt(8)
  v_mfma_f32_16x16x32_bf16 v[60:63], a[248:251], a[8:11], v[60:63]
  ds_read_b64_tr_b16 a[240:241], v5 offset:50752
  v_cvt_pk_bf16_f32 v246, v80, v81
  v_cvt_pk_bf16_f32 v247, v82, v83
  v_mfma_f32_16x16x32_bf16 v[60:63], a[252:255], a[20:23], v[60:63]
  ds_read_b64_tr_b16 a[242:243], v5 offset:51008
  v_cvt_pk_bf16_f32 v250, v84, v85
  v_cvt_pk_bf16_f32 v251, v86, v87
  v_mfma_f32_16x16x32_bf16 v[56:59], a[252:255], a[16:19], v[56:59]
  s_add_u32 m0, s33, 17952
  s_add_u32 s35, s35, 0x1000
  v_mfma_f32_16x16x32_bf16 v[56:59], a[248:251], a[4:7], v[56:59]
  buffer_load_dwordx4 v4, s[12:15], s35 offen nt lds
  ds_read_b64_tr_b16 a[244:245], v5 offset:51264
  v_mfma_f32_16x16x32_bf16 v[52:55], a[248:251], a[0:3], v[52:55]
  ds_read_b64_tr_b16 a[246:247], v5 offset:51520
  v_mfma_f32_16x16x32_bf16 v[52:55], a[252:255], a[12:15], v[52:55]
  v_mfma_f32_16x16x32_bf16 a[144:147], a[168:171], v[24:27], 0
  s_waitcnt vmcnt(4)
  v_accvgpr_write_b32 a48, v160
  v_mfma_f32_16x16x32_bf16 a[140:143], a[168:171], v[20:23], 0
  v_accvgpr_write_b32 a49, v161
  v_accvgpr_write_b32 a50, v162
  v_accvgpr_write_b32 a51, v163
  v_mfma_f32_16x16x32_bf16 a[136:139], a[168:171], v[16:19], 0
  v_accvgpr_write_b32 a52, v168
  s_waitcnt lgkmcnt(8)
  v_mfma_f32_16x16x32_bf16 v[88:91], a[224:227], v[16:19], 0
  ds_read_b64_tr_b16 a[248:249], v5 offset:50784
  v_accvgpr_write_b32 a53, v169
  v_accvgpr_write_b32 a54, v170
  v_mfma_f32_16x16x32_bf16 v[88:91], a[228:231], v[240:243], v[88:91]
  ds_read_b64_tr_b16 a[250:251], v5 offset:51040
  v_accvgpr_write_b32 a55, v171
  v_mfma_f32_16x16x32_bf16 v[96:99], a[228:231], v[244:247], 0
  v_accvgpr_write_b32 a56, v176
  v_accvgpr_write_b32 a57, v177
  v_accvgpr_write_b32 a58, v178
  v_mfma_f32_16x16x32_bf16 v[96:99], a[224:227], v[20:23], v[96:99]
  ds_read_b64_tr_b16 a[252:253], v5 offset:51296
  v_accvgpr_write_b32 a59, v179
  v_mfma_f32_16x16x32_bf16 v[104:107], a[224:227], v[24:27], 0
  ds_read_b64_tr_b16 a[254:255], v5 offset:51552
  v_accvgpr_write_b32 a60, v184
  v_accvgpr_write_b32 a61, v185
  v_mfma_f32_16x16x32_bf16 v[104:107], a[228:231], v[248:251], v[104:107]
  s_add_u32 m0, s33, 19008
  s_add_u32 s35, s35, 0x1000
  s_waitcnt lgkmcnt(8)
  v_mfma_f32_16x16x32_bf16 v[108:111], a[236:239], v[248:251], 0
  buffer_load_dwordx4 v4, s[12:15], s35 offen nt lds
  ds_read_b64_tr_b16 a[224:225], v5 offset:50816
  v_mfma_f32_16x16x32_bf16 v[108:111], a[232:235], v[24:27], v[108:111]
  ds_read_b64_tr_b16 a[226:227], v5 offset:51072
  v_mfma_f32_16x16x32_bf16 v[100:103], a[232:235], v[20:23], 0
  v_accvgpr_write_b32 a62, v186
  v_accvgpr_write_b32 a63, v187
  v_accvgpr_write_b32 a64, v192
  v_mfma_f32_16x16x32_bf16 v[100:103], a[236:239], v[244:247], v[100:103]
  s_waitcnt vmcnt(4)
  ds_read_b64_tr_b16 a[228:229], v5 offset:51328
  v_mfma_f32_16x16x32_bf16 v[92:95], a[236:239], v[240:243], 0
  ds_read_b64_tr_b16 a[230:231], v5 offset:51584
  v_accvgpr_write_b32 a65, v193
  v_accvgpr_write_b32 a66, v194
  v_mfma_f32_16x16x32_bf16 v[92:95], a[232:235], v[16:19], v[92:95]
  v_accvgpr_write_b32 a67, v195
  v_accvgpr_write_b32 a68, v200
  s_waitcnt lgkmcnt(8)
  v_mfma_f32_16x16x32_bf16 v[112:115], a[240:243], v[16:19], 0
  ds_read_b64_tr_b16 a[232:233], v5 offset:50848
  v_accvgpr_write_b32 a69, v201
  v_mfma_f32_16x16x32_bf16 v[112:115], a[244:247], v[240:243], v[112:115]
  ds_read_b64_tr_b16 a[234:235], v5 offset:51104
  v_accvgpr_write_b32 a70, v202
  v_accvgpr_write_b32 a71, v203
  v_mfma_f32_16x16x32_bf16 v[120:123], a[244:247], v[244:247], 0
  v_accvgpr_write_b32 a72, v208
  v_accvgpr_write_b32 a73, v209
  v_mfma_f32_16x16x32_bf16 v[120:123], a[240:243], v[20:23], v[120:123]
  ds_read_b64_tr_b16 a[236:237], v5 offset:51360
  v_accvgpr_write_b32 a74, v210
  v_accvgpr_write_b32 a75, v211
  v_mfma_f32_16x16x32_bf16 v[128:131], a[240:243], v[24:27], 0
  ds_read_b64_tr_b16 a[238:239], v5 offset:51616
  v_accvgpr_write_b32 a76, v216
  v_mfma_f32_16x16x32_bf16 v[128:131], a[244:247], v[248:251], v[128:131]
  s_add_u32 m0, s33, 20064
  s_add_u32 s35, s35, 0x1000
  s_waitcnt lgkmcnt(8)
  v_mfma_f32_16x16x32_bf16 v[132:135], a[252:255], v[248:251], 0
  buffer_load_dwordx4 v4, s[12:15], s35 offen nt lds
  ds_read_b64_tr_b16 a[240:241], v5 offset:50880
  v_mfma_f32_16x16x32_bf16 v[132:135], a[248:251], v[24:27], v[132:135]
  ds_read_b64_tr_b16 a[242:243], v5 offset:51136
  v_accvgpr_write_b32 a77, v217
  v_mfma_f32_16x16x32_bf16 v[124:127], a[248:251], v[20:23], 0
  v_accvgpr_write_b32 a78, v218
  v_accvgpr_write_b32 a79, v219
  v_mfma_f32_16x16x32_bf16 v[124:127], a[252:255], v[244:247], v[124:127]
  s_waitcnt vmcnt(4)
  ds_read_b64_tr_b16 a[244:245], v5 offset:51392
  v_accvgpr_write_b32 a80, v224
  v_mfma_f32_16x16x32_bf16 v[116:119], a[252:255], v[240:243], 0
  ds_read_b64_tr_b16 a[246:247], v5 offset:51648
  v_accvgpr_write_b32 a81, v225
  v_mfma_f32_16x16x32_bf16 v[116:119], a[248:251], v[16:19], v[116:119]
  v_accvgpr_write_b32 a82, v226
  v_accvgpr_write_b32 a83, v227
  s_waitcnt lgkmcnt(8)
  v_mfma_f32_16x16x32_bf16 v[136:139], a[224:227], v[16:19], 0
  ds_read_b64_tr_b16 a[248:249], v5 offset:50912
  v_accvgpr_write_b32 a84, v188
  v_mfma_f32_16x16x32_bf16 v[136:139], a[228:231], v[240:243], v[136:139]
  ds_read_b64_tr_b16 a[250:251], v5 offset:51168
  v_accvgpr_write_b32 a85, v189
  v_accvgpr_write_b32 a86, v190
  v_mfma_f32_16x16x32_bf16 v[144:147], a[228:231], v[244:247], 0
  v_accvgpr_write_b32 a87, v191
  v_accvgpr_write_b32 a88, v196
  v_accvgpr_write_b32 a89, v197
  v_mfma_f32_16x16x32_bf16 v[144:147], a[224:227], v[20:23], v[144:147]
  ds_read_b64_tr_b16 a[252:253], v5 offset:51424
  v_accvgpr_write_b32 a90, v198
  v_mfma_f32_16x16x32_bf16 v[152:155], a[224:227], v[24:27], 0
  ds_read_b64_tr_b16 a[254:255], v5 offset:51680
  v_accvgpr_write_b32 a91, v199
  v_accvgpr_write_b32 a92, v204
  v_mfma_f32_16x16x32_bf16 v[152:155], a[228:231], v[248:251], v[152:155]
  s_waitcnt lgkmcnt(8)
  v_mfma_f32_16x16x32_bf16 v[156:159], a[236:239], v[248:251], 0
  s_waitcnt vmcnt(4)
  s_barrier
  v_accvgpr_write_b32 a93, v205
  v_mfma_f32_16x16x32_bf16 v[156:159], a[232:235], v[24:27], v[156:159]
  ds_read_b128 a[224:227], v3 offset:0
  v_accvgpr_write_b32 a94, v206
  v_mfma_f32_16x16x32_bf16 v[148:151], a[232:235], v[20:23], 0
  s_add_u32 m0, s33, 33792
  s_add_u32 s34, s34, 0x1000
  v_accvgpr_write_b32 a95, v207
  v_mfma_f32_16x16x32_bf16 v[148:151], a[236:239], v[244:247], v[148:151]
  buffer_load_dwordx4 v1, s[8:11], s34 offen nt lds
  ds_read_b128 a[228:231], v3 offset:64
  v_mfma_f32_16x16x32_bf16 v[140:143], a[236:239], v[240:243], 0
  v_exp_f32 v40, v40
  v_mfma_f32_16x16x32_bf16 v[140:143], a[232:235], v[16:19], v[140:143]
  v_exp_f32 v41, v41
  s_waitcnt lgkmcnt(6)
  v_mfma_f32_16x16x32_bf16 v[160:163], a[240:243], v[16:19], 0
  s_waitcnt vmcnt(4)
  ds_read_b128 a[232:235], v3 offset:128
  v_mfma_f32_16x16x32_bf16 v[160:163], a[244:247], v[240:243], v[160:163]
  v_exp_f32 v42, v42
  v_mfma_f32_16x16x32_bf16 v[168:171], a[244:247], v[244:247], 0
  v_exp_f32 v43, v43
  v_mfma_f32_16x16x32_bf16 v[168:171], a[240:243], v[20:23], v[168:171]
  ds_read_b128 a[236:239], v3 offset:192
  v_exp_f32 v44, v44
  v_mfma_f32_16x16x32_bf16 v[176:179], a[240:243], v[24:27], 0
  v_exp_f32 v45, v45
  v_mfma_f32_16x16x32_bf16 v[176:179], a[244:247], v[248:251], v[176:179]
  v_exp_f32 v46, v46
  s_waitcnt lgkmcnt(4)
  v_mfma_f32_16x16x32_bf16 v[180:183], a[252:255], v[248:251], 0
  ds_read_b128 a[240:243], v3 offset:256
  v_exp_f32 v47, v47
  v_mfma_f32_16x16x32_bf16 v[180:183], a[248:251], v[24:27], v[180:183]
  v_exp_f32 v48, v48
  v_mfma_f32_16x16x32_bf16 v[172:175], a[248:251], v[20:23], 0
  s_add_u32 m0, s33, 34848
  s_add_u32 s34, s34, 0x1000
  v_mfma_f32_16x16x32_bf16 v[172:175], a[252:255], v[244:247], v[172:175]
  buffer_load_dwordx4 v1, s[8:11], s34 offen nt lds
  ds_read_b128 a[244:247], v3 offset:320
  v_exp_f32 v49, v49
  v_mfma_f32_16x16x32_bf16 v[164:167], a[252:255], v[240:243], 0
  v_accvgpr_write_b32 a148, 0
  v_accvgpr_write_b32 a149, 0
  v_mfma_f32_16x16x32_bf16 v[164:167], a[248:251], v[16:19], v[164:167]
  v_accvgpr_write_b32 a150, 0
  v_accvgpr_write_b32 a151, 0
  s_waitcnt lgkmcnt(4)
  v_mfma_f32_16x16x32_bf16 v[64:67], a[224:227], a[0:3], v[28:31]
  s_waitcnt vmcnt(4)
  ds_read_b128 a[248:251], v3 offset:384
  v_mfma_f32_16x16x32_bf16 v[64:67], a[228:231], a[12:15], v[64:67]
  v_exp_f32 v50, v50
  v_mfma_f32_16x16x32_bf16 v[68:71], a[228:231], a[16:19], v[32:35]
  v_exp_f32 v51, v51
  v_mfma_f32_16x16x32_bf16 v[68:71], a[224:227], a[4:7], v[68:71]
  ds_read_b128 a[252:255], v3 offset:448
  v_mfma_f32_16x16x32_bf16 v[72:75], a[224:227], a[8:11], v[36:39]
  v_exp_f32 v52, v52
  v_mfma_f32_16x16x32_bf16 v[72:75], a[228:231], a[20:23], v[72:75]
  s_waitcnt lgkmcnt(4)
  v_mfma_f32_16x16x32_bf16 v[72:75], a[232:235], a[32:35], v[72:75]
  ds_read_b128 a[224:227], v3 offset:896
  v_mfma_f32_16x16x32_bf16 v[72:75], a[236:239], a[44:47], v[72:75]
  v_exp_f32 v53, v53
  v_mfma_f32_16x16x32_bf16 v[68:71], a[236:239], a[40:43], v[68:71]
  s_add_u32 m0, s33, 35904
  s_add_u32 s34, s34, 0x1000
  v_mfma_f32_16x16x32_bf16 v[68:71], a[232:235], a[28:31], v[68:71]
  buffer_load_dwordx4 v1, s[8:11], s34 offen nt lds
  ds_read_b128 a[228:231], v3 offset:960
  v_mfma_f32_16x16x32_bf16 v[64:67], a[232:235], a[24:27], v[64:67]
  v_exp_f32 v54, v54
  v_mfma_f32_16x16x32_bf16 v[64:67], a[236:239], a[36:39], v[64:67]
  s_waitcnt lgkmcnt(4)
  v_mfma_f32_16x16x32_bf16 v[64:67], a[240:243], a[48:51], v[64:67]
  s_waitcnt vmcnt(4)
  ds_read_b128 a[232:235], v3 offset:768
  v_mfma_f32_16x16x32_bf16 v[64:67], a[244:247], a[60:63], v[64:67]
  v_exp_f32 v55, v55
  v_mfma_f32_16x16x32_bf16 v[68:71], a[244:247], a[64:67], v[68:71]
  v_exp_f32 v56, v56
  v_mfma_f32_16x16x32_bf16 v[68:71], a[240:243], a[52:55], v[68:71]
  ds_read_b128 a[236:239], v3 offset:832
  v_mfma_f32_16x16x32_bf16 v[72:75], a[240:243], a[56:59], v[72:75]
  v_exp_f32 v57, v57
  v_mfma_f32_16x16x32_bf16 v[72:75], a[244:247], a[68:71], v[72:75]
  s_waitcnt lgkmcnt(4)
  v_mfma_f32_16x16x32_bf16 v[72:75], a[248:251], a[80:83], v[72:75]
  ds_read_b128 a[240:243], v3 offset:640
  v_mfma_f32_16x16x32_bf16 v[72:75], a[252:255], a[92:95], v[72:75]
  v_exp_f32 v58, v58
  v_mfma_f32_16x16x32_bf16 v[68:71], a[252:255], a[88:91], v[68:71]
  s_add_u32 m0, s33, 36960
  s_add_u32 s34, s34, 0x1000
  v_mfma_f32_16x16x32_bf16 v[68:71], a[248:251], a[76:79], v[68:71]
  buffer_load_dwordx4 v1, s[8:11], s34 offen nt lds
  ds_read_b128 a[244:247], v3 offset:704
  v_mfma_f32_16x16x32_bf16 v[64:67], a[248:251], a[72:75], v[64:67]
  v_exp_f32 v59, v59
  v_mfma_f32_16x16x32_bf16 v[64:67], a[252:255], a[84:87], v[64:67]
  s_waitcnt lgkmcnt(4)
  v_mfma_f32_16x16x32_bf16 v[76:79], a[224:227], a[72:75], v[28:31]
  s_waitcnt vmcnt(4)
  ds_read_b128 a[248:251], v3 offset:512
  v_mfma_f32_16x16x32_bf16 v[76:79], a[228:231], a[84:87], v[76:79]
  v_exp_f32 v60, v60
  v_mfma_f32_16x16x32_bf16 v[80:83], a[228:231], a[88:91], v[32:35]
  v_exp_f32 v61, v61
  v_mfma_f32_16x16x32_bf16 v[80:83], a[224:227], a[76:79], v[80:83]
  ds_read_b128 a[252:255], v3 offset:576
  v_mfma_f32_16x16x32_bf16 v[84:87], a[224:227], a[80:83], v[36:39]
  v_exp_f32 v62, v62
  v_mfma_f32_16x16x32_bf16 v[84:87], a[228:231], a[92:95], v[84:87]
  s_waitcnt lgkmcnt(4)
  v_mfma_f32_16x16x32_bf16 v[84:87], a[232:235], a[56:59], v[84:87]
  s_waitcnt vmcnt(4)
  s_barrier
  v_mfma_f32_16x16x32_bf16 v[84:87], a[236:239], a[68:71], v[84:87]
  ds_read_b64_tr_b16 a[224:225], v5 offset:16896
  v_mfma_f32_16x16x32_bf16 v[80:83], a[236:239], a[64:67], v[80:83]
  ds_read_b64_tr_b16 a[226:227], v5 offset:17152
  s_add_u32 m0, s33, 50688
  s_add_u32 s35, s35, 0x4f00
  v_mfma_f32_16x16x32_bf16 v[80:83], a[232:235], a[52:55], v[80:83]
  buffer_load_dwordx4 v4, s[12:15], s35 offen nt lds
  ds_read_b64_tr_b16 a[228:229], v5 offset:17408
  v_mfma_f32_16x16x32_bf16 v[76:79], a[232:235], a[48:51], v[76:79]
  ds_read_b64_tr_b16 a[230:231], v5 offset:17664
  v_mfma_f32_16x16x32_bf16 v[76:79], a[236:239], a[60:63], v[76:79]
  s_waitcnt lgkmcnt(6)
  v_mfma_f32_16x16x32_bf16 v[76:79], a[240:243], a[24:27], v[76:79]
  s_waitcnt vmcnt(4)
  ds_read_b64_tr_b16 a[232:233], v5 offset:16928
  v_mfma_f32_16x16x32_bf16 v[76:79], a[244:247], a[36:39], v[76:79]
  ds_read_b64_tr_b16 a[234:235], v5 offset:17184
  v_mfma_f32_16x16x32_bf16 v[80:83], a[244:247], a[40:43], v[80:83]
  v_exp_f32 v63, v63
  v_mfma_f32_16x16x32_bf16 v[80:83], a[240:243], a[28:31], v[80:83]
  ds_read_b64_tr_b16 a[236:237], v5 offset:17440
  v_mfma_f32_16x16x32_bf16 v[84:87], a[240:243], a[32:35], v[84:87]
  ds_read_b64_tr_b16 a[238:239], v5 offset:17696
  v_mfma_f32_16x16x32_bf16 v[84:87], a[244:247], a[44:47], v[84:87]
  s_waitcnt lgkmcnt(8)
  v_mfma_f32_16x16x32_bf16 v[84:87], a[248:251], a[8:11], v[84:87]
  ds_read_b64_tr_b16 a[240:241], v5 offset:16960
  v_mfma_f32_16x16x32_bf16 v[84:87], a[252:255], a[20:23], v[84:87]
  ds_read_b64_tr_b16 a[242:243], v5 offset:17216
  v_mfma_f32_16x16x32_bf16 v[80:83], a[252:255], a[16:19], v[80:83]
  s_add_u32 m0, s33, 51744
  s_add_u32 s35, s35, 0x1000
  v_mfma_f32_16x16x32_bf16 v[80:83], a[248:251], a[4:7], v[80:83]
  buffer_load_dwordx4 v4, s[12:15], s35 offen nt lds
  ds_read_b64_tr_b16 a[244:245], v5 offset:17472
  v_mfma_f32_16x16x32_bf16 v[76:79], a[248:251], a[0:3], v[76:79]
  ds_read_b64_tr_b16 a[246:247], v5 offset:17728
  v_mfma_f32_16x16x32_bf16 v[76:79], a[252:255], a[12:15], v[76:79]
  v_mfma_f32_16x16x32_bf16 a[144:147], a[168:171], v[248:251], a[144:147]
  s_waitcnt vmcnt(4)
  v_mfma_f32_16x16x32_bf16 a[140:143], a[168:171], v[244:247], a[140:143]
  v_exp_f32 v64, v64
  v_mfma_f32_16x16x32_bf16 a[136:139], a[168:171], v[240:243], a[136:139]
  s_waitcnt lgkmcnt(8)
  v_mfma_f32_16x16x32_bf16 v[184:187], a[224:227], v[16:19], 0
  ds_read_b64_tr_b16 a[248:249], v5 offset:16992
  v_mfma_f32_16x16x32_bf16 v[184:187], a[228:231], v[240:243], v[184:187]
  ds_read_b64_tr_b16 a[250:251], v5 offset:17248
  v_mfma_f32_16x16x32_bf16 v[192:195], a[228:231], v[244:247], 0
  v_exp_f32 v65, v65
  v_mfma_f32_16x16x32_bf16 v[192:195], a[224:227], v[20:23], v[192:195]
  ds_read_b64_tr_b16 a[252:253], v5 offset:17504
  v_mfma_f32_16x16x32_bf16 v[200:203], a[224:227], v[24:27], 0
  ds_read_b64_tr_b16 a[254:255], v5 offset:17760
  v_mfma_f32_16x16x32_bf16 v[200:203], a[228:231], v[248:251], v[200:203]
  s_add_u32 m0, s33, 52800
  s_add_u32 s35, s35, 0x1000
  s_waitcnt lgkmcnt(8)
  v_mfma_f32_16x16x32_bf16 v[204:207], a[236:239], v[248:251], 0
  buffer_load_dwordx4 v4, s[12:15], s35 offen nt lds
  ds_read_b64_tr_b16 a[224:225], v5 offset:17024
  v_mfma_f32_16x16x32_bf16 v[204:207], a[232:235], v[24:27], v[204:207]
  ds_read_b64_tr_b16 a[226:227], v5 offset:17280
  v_mfma_f32_16x16x32_bf16 v[196:199], a[232:235], v[20:23], 0
  v_exp_f32 v66, v66
  v_mfma_f32_16x16x32_bf16 v[196:199], a[236:239], v[244:247], v[196:199]
  s_waitcnt vmcnt(4)
  ds_read_b64_tr_b16 a[228:229], v5 offset:17536
  v_mfma_f32_16x16x32_bf16 v[188:191], a[236:239], v[240:243], 0
  ds_read_b64_tr_b16 a[230:231], v5 offset:17792
  v_mfma_f32_16x16x32_bf16 v[188:191], a[232:235], v[16:19], v[188:191]
  s_waitcnt lgkmcnt(8)
  v_mfma_f32_16x16x32_bf16 v[208:211], a[240:243], v[16:19], 0
  ds_read_b64_tr_b16 a[232:233], v5 offset:17056
  v_mfma_f32_16x16x32_bf16 v[208:211], a[244:247], v[240:243], v[208:211]
  ds_read_b64_tr_b16 a[234:235], v5 offset:17312
  v_mfma_f32_16x16x32_bf16 v[216:219], a[244:247], v[244:247], 0
  v_exp_f32 v67, v67
  v_mfma_f32_16x16x32_bf16 v[216:219], a[240:243], v[20:23], v[216:219]
  ds_read_b64_tr_b16 a[236:237], v5 offset:17568
  v_mfma_f32_16x16x32_bf16 v[224:227], a[240:243], v[24:27], 0
  ds_read_b64_tr_b16 a[238:239], v5 offset:17824
  v_mfma_f32_16x16x32_bf16 v[224:227], a[244:247], v[248:251], v[224:227]
  s_add_u32 m0, s33, 53856
  s_add_u32 s35, s35, 0x1000
  s_waitcnt lgkmcnt(8)
  v_mfma_f32_16x16x32_bf16 v[228:231], a[252:255], v[248:251], 0
  buffer_load_dwordx4 v4, s[12:15], s35 offen nt lds
  ds_read_b64_tr_b16 a[240:241], v5 offset:17088
  v_mfma_f32_16x16x32_bf16 v[228:231], a[248:251], v[24:27], v[228:231]
  ds_read_b64_tr_b16 a[242:243], v5 offset:17344
  v_mfma_f32_16x16x32_bf16 v[220:223], a[248:251], v[20:23], 0
  v_exp_f32 v68, v68
  v_mfma_f32_16x16x32_bf16 v[220:223], a[252:255], v[244:247], v[220:223]
  s_waitcnt vmcnt(4)
  ds_read_b64_tr_b16 a[244:245], v5 offset:17600
  v_mfma_f32_16x16x32_bf16 v[212:215], a[252:255], v[240:243], 0
  ds_read_b64_tr_b16 a[246:247], v5 offset:17856
  v_mfma_f32_16x16x32_bf16 v[212:215], a[248:251], v[16:19], v[212:215]
  s_waitcnt lgkmcnt(8)
  v_mfma_f32_16x16x32_bf16 v[232:235], a[224:227], v[16:19], 0
  ds_read_b64_tr_b16 a[248:249], v5 offset:17120
  v_mfma_f32_16x16x32_bf16 v[232:235], a[228:231], v[240:243], v[232:235]
  ds_read_b64_tr_b16 a[250:251], v5 offset:17376
  v_mfma_f32_16x16x32_bf16 a[96:99], a[228:231], v[244:247], 0
  v_exp_f32 v69, v69
  v_mfma_f32_16x16x32_bf16 a[96:99], a[224:227], v[20:23], a[96:99]
  ds_read_b64_tr_b16 a[252:253], v5 offset:17632
  v_mfma_f32_16x16x32_bf16 a[104:107], a[224:227], v[24:27], 0
  ds_read_b64_tr_b16 a[254:255], v5 offset:17888
  v_mfma_f32_16x16x32_bf16 a[104:107], a[228:231], v[248:251], a[104:107]
  s_waitcnt lgkmcnt(8)
  v_mfma_f32_16x16x32_bf16 a[108:111], a[236:239], v[248:251], 0
  s_waitcnt vmcnt(4)
  s_barrier
  v_mfma_f32_16x16x32_bf16 a[108:111], a[232:235], v[24:27], a[108:111]
  ds_read_b128 a[224:227], v3 offset:33792
  v_mfma_f32_16x16x32_bf16 a[100:103], a[232:235], v[20:23], 0
  s_add_u32 m0, s33, 0
  s_add_u32 s34, s34, 0x1000
  v_mfma_f32_16x16x32_bf16 a[100:103], a[236:239], v[244:247], a[100:103]
  buffer_load_dwordx4 v1, s[8:11], s34 offen nt lds
  ds_read_b128 a[228:231], v3 offset:33856
  v_mfma_f32_16x16x32_bf16 v[236:239], a[236:239], v[240:243], 0
  v_exp_f32 v70, v70
  v_mfma_f32_16x16x32_bf16 v[236:239], a[232:235], v[16:19], v[236:239]
  s_waitcnt lgkmcnt(6)
  v_mfma_f32_16x16x32_bf16 a[112:115], a[240:243], v[16:19], 0
  s_waitcnt vmcnt(4)
  ds_read_b128 a[232:235], v3 offset:33920
  v_mfma_f32_16x16x32_bf16 a[112:115], a[244:247], v[240:243], a[112:115]
  v_exp_f32 v71, v71
  v_mfma_f32_16x16x32_bf16 a[120:123], a[244:247], v[244:247], 0
  v_exp_f32 v72, v72
  v_mfma_f32_16x16x32_bf16 a[120:123], a[240:243], v[20:23], a[120:123]
  ds_read_b128 a[236:239], v3 offset:33984
  v_mfma_f32_16x16x32_bf16 a[128:131], a[240:243], v[24:27], 0
  v_exp_f32 v73, v73
  v_mfma_f32_16x16x32_bf16 a[128:131], a[244:247], v[248:251], a[128:131]
  s_waitcnt lgkmcnt(4)
  v_mfma_f32_16x16x32_bf16 a[132:135], a[252:255], v[248:251], 0
  ds_read_b128 a[240:243], v3 offset:34048
  v_mfma_f32_16x16x32_bf16 a[132:135], a[248:251], v[24:27], a[132:135]
  v_mfma_f32_16x16x32_bf16 a[124:127], a[248:251], v[20:23], 0
  s_add_u32 m0, s33, 1056
  s_add_u32 s34, s34, 0x1000
  v_mfma_f32_16x16x32_bf16 a[124:127], a[252:255], v[244:247], a[124:127]
  buffer_load_dwordx4 v1, s[8:11], s34 offen nt lds
  ds_read_b128 a[244:247], v3 offset:34112
  v_mfma_f32_16x16x32_bf16 a[116:119], a[252:255], v[240:243], 0
  v_mfma_f32_16x16x32_bf16 a[116:119], a[248:251], v[16:19], a[116:119]
  v_cvt_pk_bf16_f32 v16, v40, v41
  v_cvt_pk_bf16_f32 v17, v42, v43
  v_cvt_pk_bf16_f32 v20, v44, v45
  v_cvt_pk_bf16_f32 v21, v46, v47
  v_cvt_pk_bf16_f32 v24, v48, v49
  v_cvt_pk_bf16_f32 v25, v50, v51
  s_waitcnt lgkmcnt(4)
  v_mfma_f32_16x16x32_bf16 v[40:43], a[224:227], a[0:3], v[28:31]
  s_waitcnt vmcnt(4)
  ds_read_b128 a[248:251], v3 offset:34176
  v_mfma_f32_16x16x32_bf16 v[40:43], a[228:231], a[12:15], v[40:43]
  v_cvt_pk_bf16_f32 v18, v52, v53
  v_cvt_pk_bf16_f32 v19, v54, v55
  v_mfma_f32_16x16x32_bf16 v[44:47], a[228:231], a[16:19], v[32:35]
  v_cvt_pk_bf16_f32 v22, v56, v57
  v_cvt_pk_bf16_f32 v23, v58, v59
  v_mfma_f32_16x16x32_bf16 v[44:47], a[224:227], a[4:7], v[44:47]
  ds_read_b128 a[252:255], v3 offset:34240
  v_cvt_pk_bf16_f32 v26, v60, v61
  v_mfma_f32_16x16x32_bf16 v[48:51], a[224:227], a[8:11], v[36:39]
  v_cvt_pk_bf16_f32 v27, v62, v63
  v_mfma_f32_16x16x32_bf16 v[48:51], a[228:231], a[20:23], v[48:51]
  v_exp_f32 v74, v74
  s_waitcnt lgkmcnt(4)
  v_mfma_f32_16x16x32_bf16 v[48:51], a[232:235], a[32:35], v[48:51]
  ds_read_b128 a[224:227], v3 offset:34688
  v_mfma_f32_16x16x32_bf16 v[48:51], a[236:239], a[44:47], v[48:51]
  v_exp_f32 v75, v75
  v_mfma_f32_16x16x32_bf16 v[44:47], a[236:239], a[40:43], v[44:47]
  s_add_u32 m0, s33, 2112
  s_add_u32 s34, s34, 0x1000
  v_mfma_f32_16x16x32_bf16 v[44:47], a[232:235], a[28:31], v[44:47]
  buffer_load_dwordx4 v1, s[8:11], s34 offen nt lds
  ds_read_b128 a[228:231], v3 offset:34752
  v_mfma_f32_16x16x32_bf16 v[40:43], a[232:235], a[24:27], v[40:43]
  v_exp_f32 v76, v76
  v_mfma_f32_16x16x32_bf16 v[40:43], a[236:239], a[36:39], v[40:43]
  s_waitcnt lgkmcnt(4)
  v_mfma_f32_16x16x32_bf16 v[40:43], a[240:243], a[48:51], v[40:43]
  s_waitcnt vmcnt(4)
  ds_read_b128 a[232:235], v3 offset:34560
  v_mfma_f32_16x16x32_bf16 v[40:43], a[244:247], a[60:63], v[40:43]
  v_exp_f32 v77, v77
  v_mfma_f32_16x16x32_bf16 v[44:47], a[244:247], a[64:67], v[44:47]
  v_exp_f32 v78, v78
  v_mfma_f32_16x16x32_bf16 v[44:47], a[240:243], a[52:55], v[44:47]
  ds_read_b128 a[236:239], v3 offset:34624
  v_exp_f32 v79, v79
  v_mfma_f32_16x16x32_bf16 v[48:51], a[240:243], a[56:59], v[48:51]
  v_exp_f32 v80, v80
  v_mfma_f32_16x16x32_bf16 v[48:51], a[244:247], a[68:71], v[48:51]
  s_waitcnt lgkmcnt(4)
  v_mfma_f32_16x16x32_bf16 v[48:51], a[248:251], a[80:83], v[48:51]
  ds_read_b128 a[240:243], v3 offset:34432
  v_exp_f32 v81, v81
  v_mfma_f32_16x16x32_bf16 v[48:51], a[252:255], a[92:95], v[48:51]
  v_exp_f32 v82, v82
  v_mfma_f32_16x16x32_bf16 v[44:47], a[252:255], a[88:91], v[44:47]
  s_add_u32 m0, s33, 3168
  s_add_u32 s34, s34, 0x1000
  v_mfma_f32_16x16x32_bf16 v[44:47], a[248:251], a[76:79], v[44:47]
  buffer_load_dwordx4 v1, s[8:11], s34 offen nt lds
  ds_read_b128 a[244:247], v3 offset:34496
  v_mfma_f32_16x16x32_bf16 v[40:43], a[248:251], a[72:75], v[40:43]
  v_mfma_f32_16x16x32_bf16 v[40:43], a[252:255], a[84:87], v[40:43]
  v_exp_f32 v83, v83
  s_waitcnt lgkmcnt(4)
  v_mfma_f32_16x16x32_bf16 v[52:55], a[224:227], a[72:75], v[28:31]
  s_waitcnt vmcnt(4)
  ds_read_b128 a[248:251], v3 offset:34304
  v_mfma_f32_16x16x32_bf16 v[52:55], a[228:231], a[84:87], v[52:55]
  v_exp_f32 v84, v84
  v_mfma_f32_16x16x32_bf16 v[56:59], a[228:231], a[88:91], v[32:35]
  v_exp_f32 v85, v85
  v_mfma_f32_16x16x32_bf16 v[56:59], a[224:227], a[76:79], v[56:59]
  ds_read_b128 a[252:255], v3 offset:34368
  v_exp_f32 v86, v86
  v_mfma_f32_16x16x32_bf16 v[60:63], a[224:227], a[80:83], v[36:39]
  v_exp_f32 v87, v87
  v_mfma_f32_16x16x32_bf16 v[60:63], a[228:231], a[92:95], v[60:63]
  v_cvt_pk_bf16_f32 v240, v64, v65
  s_waitcnt lgkmcnt(4)
  v_mfma_f32_16x16x32_bf16 v[60:63], a[232:235], a[56:59], v[60:63]
  s_waitcnt vmcnt(4)
  s_barrier
  v_mfma_f32_16x16x32_bf16 v[60:63], a[236:239], a[68:71], v[60:63]
  ds_read_b64_tr_b16 a[224:225], v5 offset:50688
  v_cvt_pk_bf16_f32 v241, v66, v67
  v_mfma_f32_16x16x32_bf16 v[56:59], a[236:239], a[64:67], v[56:59]
  ds_read_b64_tr_b16 a[226:227], v5 offset:50944
  s_add_u32 m0, s33, 16896
  s_add_u32 s35, s35, 0xffffd100
  v_mfma_f32_16x16x32_bf16 v[56:59], a[232:235], a[52:55], v[56:59]
  buffer_load_dwordx4 v4, s[12:15], s35 offen nt lds
  ds_read_b64_tr_b16 a[228:229], v5 offset:51200
  v_mfma_f32_16x16x32_bf16 v[52:55], a[232:235], a[48:51], v[52:55]
  ds_read_b64_tr_b16 a[230:231], v5 offset:51456
  v_mfma_f32_16x16x32_bf16 v[52:55], a[236:239], a[60:63], v[52:55]
  v_cvt_pk_bf16_f32 v244, v68, v69
  s_waitcnt lgkmcnt(6)
  v_mfma_f32_16x16x32_bf16 v[52:55], a[240:243], a[24:27], v[52:55]
  s_waitcnt vmcnt(4)
  ds_read_b64_tr_b16 a[232:233], v5 offset:50720
  v_mfma_f32_16x16x32_bf16 v[52:55], a[244:247], a[36:39], v[52:55]
  ds_read_b64_tr_b16 a[234:235], v5 offset:50976
  v_cvt_pk_bf16_f32 v245, v70, v71
  v_mfma_f32_16x16x32_bf16 v[56:59], a[244:247], a[40:43], v[56:59]
  v_cvt_pk_bf16_f32 v248, v72, v73
  v_cvt_pk_bf16_f32 v249, v74, v75
  v_mfma_f32_16x16x32_bf16 v[56:59], a[240:243], a[28:31], v[56:59]
  ds_read_b64_tr_b16 a[236:237], v5 offset:51232
  v_cvt_pk_bf16_f32 v242, v76, v77
  v_cvt_pk_bf16_f32 v243, v78, v79
  v_mfma_f32_16x16x32_bf16 v[60:63], a[240:243], a[32:35], v[60:63]
  ds_read_b64_tr_b16 a[238:239], v5 offset:51488
  v_cvt_pk_bf16_f32 v246, v80, v81
  v_mfma_f32_16x16x32_bf16 v[60:63], a[244:247], a[44:47], v[60:63]
  v_cvt_pk_bf16_f32 v247, v82, v83
  s_waitcnt lgkmcnt(8)
  v_mfma_f32_16x16x32_bf16 v[60:63], a[248:251], a[8:11], v[60:63]
  ds_read_b64_tr_b16 a[240:241], v5 offset:50752
  v_cvt_pk_bf16_f32 v250, v84, v85
  v_mfma_f32_16x16x32_bf16 v[60:63], a[252:255], a[20:23], v[60:63]
  ds_read_b64_tr_b16 a[242:243], v5 offset:51008
  v_cvt_pk_bf16_f32 v251, v86, v87
  v_mfma_f32_16x16x32_bf16 v[56:59], a[252:255], a[16:19], v[56:59]
  s_branch L_page5
.p2align 12
L_hop5:
  s_branch L_walked0
  s_nop 0
L_page5:
  s_add_u32 m0, s33, 17952
  s_add_u32 s35, s35, 0x1000
  v_mfma_f32_16x16x32_bf16 v[56:59], a[248:251], a[4:7], v[56:59]
  buffer_load_dwordx4 v4, s[12:15], s35 offen nt lds
  ds_read_b64_tr_b16 a[244:245], v5 offset:51264
  v_mfma_f32_16x16x32_bf16 v[52:55], a[248:251], a[0:3], v[52:55]
  ds_read_b64_tr_b16 a[246:247], v5 offset:51520
  v_mfma_f32_16x16x32_bf16 v[52:55], a[252:255], a[12:15], v[52:55]
  s_mov_b32 s84, 0x1e
  s_mov_b32 s39, 13
L_loop:
  s_bitcmp1_b32 s84, s39
  s_cbranch_scc1 L_depth11
L_depth3:
  v_mfma_f32_16x16x32_bf16 a[144:147], a[168:171], v[24:27], a[144:147]
  s_waitcnt vmcnt(4)
  v_mfma_f32_16x16x32_bf16 a[140:143], a[168:171], v[20:23], a[140:143]
  v_exp_f32 v40, v40
  v_mfma_f32_16x16x32_bf16 a[136:139], a[168:171], v[16:19], a[136:139]
  s_waitcnt lgkmcnt(8)
  v_mfma_f32_16x16x32_bf16 v[88:91], a[224:227], v[16:19], v[88:91]
  ds_read_b64_tr_b16 a[248:249], v5 offset:50784
  v_mfma_f32_16x16x32_bf16 v[88:91], a[228:231], v[240:243], v[88:91]
  ds_read_b64_tr_b16 a[250:251], v5 offset:51040
  v_mfma_f32_16x16x32_bf16 v[96:99], a[228:231], v[244:247], v[96:99]
  buffer_store_dwordx4 a[148:151], v14, s[44:47], s70 offen sc1
  v_mfma_f32_16x16x32_bf16 v[96:99], a[224:227], v[20:23], v[96:99]
  ds_read_b64_tr_b16 a[252:253], v5 offset:51296
  v_mfma_f32_16x16x32_bf16 v[104:107], a[224:227], v[24:27], v[104:107]
  ds_read_b64_tr_b16 a[254:255], v5 offset:51552
  v_mfma_f32_16x16x32_bf16 v[104:107], a[228:231], v[248:251], v[104:107]
  s_add_u32 m0, s33, 19008
  s_add_u32 s35, s35, 0x1000
  s_waitcnt lgkmcnt(8)
  v_mfma_f32_16x16x32_bf16 v[108:111], a[236:239], v[248:251], v[108:111]
  buffer_load_dwordx4 v4, s[12:15], s35 offen nt lds
  ds_read_b64_tr_b16 a[224:225], v5 offset:50816
  v_mfma_f32_16x16x32_bf16 v[108:111], a[232:235], v[24:27], v[108:111]
  ds_read_b64_tr_b16 a[226:227], v5 offset:51072
  v_mfma_f32_16x16x32_bf16 v[100:103], a[232:235], v[20:23], v[100:103]
  v_exp_f32 v41, v41
  v_mfma_f32_16x16x32_bf16 v[100:103], a[236:239], v[244:247], v[100:103]
  s_waitcnt vmcnt(5)
  ds_read_b64_tr_b16 a[228:229], v5 offset:51328
  v_mfma_f32_16x16x32_bf16 v[92:95], a[236:239], v[240:243], v[92:95]
  ds_read_b64_tr_b16 a[230:231], v5 offset:51584
  v_mfma_f32_16x16x32_bf16 v[92:95], a[232:235], v[16:19], v[92:95]
  s_waitcnt lgkmcnt(8)
  v_mfma_f32_16x16x32_bf16 v[112:115], a[240:243], v[16:19], v[112:115]
  ds_read_b64_tr_b16 a[232:233], v5 offset:50848
  v_mfma_f32_16x16x32_bf16 v[112:115], a[244:247], v[240:243], v[112:115]
  ds_read_b64_tr_b16 a[234:235], v5 offset:51104
  v_mfma_f32_16x16x32_bf16 v[120:123], a[244:247], v[244:247], v[120:123]
  v_exp_f32 v42, v42
  v_mfma_f32_16x16x32_bf16 v[120:123], a[240:243], v[20:23], v[120:123]
  ds_read_b64_tr_b16 a[236:237], v5 offset:51360
  v_mfma_f32_16x16x32_bf16 v[128:131], a[240:243], v[24:27], v[128:131]
  ds_read_b64_tr_b16 a[238:239], v5 offset:51616
  v_mfma_f32_16x16x32_bf16 v[128:131], a[244:247], v[248:251], v[128:131]
  s_add_u32 m0, s33, 20064
  s_add_u32 s35, s35, 0x1000
  s_waitcnt lgkmcnt(8)
  v_mfma_f32_16x16x32_bf16 v[132:135], a[252:255], v[248:251], v[132:135]
  buffer_load_dwordx4 v4, s[12:15], s35 offen nt lds
  ds_read_b64_tr_b16 a[240:241], v5 offset:50880
  v_mfma_f32_16x16x32_bf16 v[132:135], a[248:251], v[24:27], v[132:135]
  ds_read_b64_tr_b16 a[242:243], v5 offset:51136
  v_mfma_f32_16x16x32_bf16 v[124:127], a[248:251], v[20:23], v[124:127]
  v_exp_f32 v43, v43
  v_mfma_f32_16x16x32_bf16 v[124:127], a[252:255], v[244:247], v[124:127]
  s_waitcnt vmcnt(5)
  ds_read_b64_tr_b16 a[244:245], v5 offset:51392
  v_mfma_f32_16x16x32_bf16 v[116:119], a[252:255], v[240:243], v[116:119]
  ds_read_b64_tr_b16 a[246:247], v5 offset:51648
  v_mfma_f32_16x16x32_bf16 v[116:119], a[248:251], v[16:19], v[116:119]
  s_waitcnt lgkmcnt(8)
  v_mfma_f32_16x16x32_bf16 v[136:139], a[224:227], v[16:19], v[136:139]
  ds_read_b64_tr_b16 a[248:249], v5 offset:50912
  v_mfma_f32_16x16x32_bf16 v[136:139], a[228:231], v[240:243], v[136:139]
  ds_read_b64_tr_b16 a[250:251], v5 offset:51168
  v_mfma_f32_16x16x32_bf16 v[144:147], a[228:231], v[244:247], v[144:147]
  v_exp_f32 v44, v44
  v_mfma_f32_16x16x32_bf16 v[144:147], a[224:227], v[20:23], v[144:147]
  ds_read_b64_tr_b16 a[252:253], v5 offset:51424
  v_mfma_f32_16x16x32_bf16 v[152:155], a[224:227], v[24:27], v[152:155]
  ds_read_b64_tr_b16 a[254:255], v5 offset:51680
  v_mfma_f32_16x16x32_bf16 v[152:155], a[228:231], v[248:251], v[152:155]
  s_waitcnt lgkmcnt(8)
  v_mfma_f32_16x16x32_bf16 v[156:159], a[236:239], v[248:251], v[156:159]
  s_waitcnt vmcnt(5)
  s_barrier
  v_mfma_f32_16x16x32_bf16 v[156:159], a[232:235], v[24:27], v[156:159]
  ds_read_b128 a[224:227], v3 offset:0
  v_mfma_f32_16x16x32_bf16 v[148:151], a[232:235], v[20:23], v[148:151]
  s_add_u32 m0, s33, 33792
  s_add_u32 s34, s34, 0x1000
  v_mfma_f32_16x16x32_bf16 v[148:151], a[236:239], v[244:247], v[148:151]
  buffer_load_dwordx4 v1, s[8:11], s34 offen nt lds
  ds_read_b128 a[228:231], v3 offset:64
  v_mfma_f32_16x16x32_bf16 v[140:143], a[236:239], v[240:243], v[140:143]
  v_exp_f32 v45, v45
  v_mfma_f32_16x16x32_bf16 v[140:143], a[232:235], v[16:19], v[140:143]
  s_waitcnt lgkmcnt(6)
  v_mfma_f32_16x16x32_bf16 v[160:163], a[240:243], v[16:19], v[160:163]
  s_waitcnt vmcnt(5)
  ds_read_b128 a[232:235], v3 offset:128
  v_mfma_f32_16x16x32_bf16 v[160:163], a[244:247], v[240:243], v[160:163]
  v_exp_f32 v46, v46
  v_mfma_f32_16x16x32_bf16 v[168:171], a[244:247], v[244:247], v[168:171]
  v_exp_f32 v47, v47
  v_mfma_f32_16x16x32_bf16 v[168:171], a[240:243], v[20:23], v[168:171]
  ds_read_b128 a[236:239], v3 offset:192
  v_mfma_f32_16x16x32_bf16 v[176:179], a[240:243], v[24:27], v[176:179]
  v_exp_f32 v48, v48
  v_mfma_f32_16x16x32_bf16 v[176:179], a[244:247], v[248:251], v[176:179]
  s_waitcnt lgkmcnt(4)
  v_mfma_f32_16x16x32_bf16 v[180:183], a[252:255], v[248:251], v[180:183]
  ds_read_b128 a[240:243], v3 offset:256
  v_mfma_f32_16x16x32_bf16 v[180:183], a[248:251], v[24:27], v[180:183]
  v_exp_f32 v49, v49
  v_mfma_f32_16x16x32_bf16 v[172:175], a[248:251], v[20:23], v[172:175]
  s_add_u32 m0, s33, 34848
  s_add_u32 s34, s34, 0x1000
  v_mfma_f32_16x16x32_bf16 v[172:175], a[252:255], v[244:247], v[172:175]
  buffer_load_dwordx4 v1, s[8:11], s34 offen nt lds
  ds_read_b128 a[244:247], v3 offset:320
  v_mfma_f32_16x16x32_bf16 v[164:167], a[252:255], v[240:243], v[164:167]
  v_mfma_f32_16x16x32_bf16 v[164:167], a[248:251], v[16:19], v[164:167]
  s_waitcnt lgkmcnt(4)
  v_mfma_f32_16x16x32_bf16 v[64:67], a[224:227], a[0:3], v[28:31]
  s_waitcnt vmcnt(5)
  ds_read_b128 a[248:251], v3 offset:384
  v_mfma_f32_16x16x32_bf16 v[64:67], a[228:231], a[12:15], v[64:67]
  v_exp_f32 v50, v50
  v_mfma_f32_16x16x32_bf16 v[68:71], a[228:231], a[16:19], v[32:35]
  v_exp_f32 v51, v51
  v_mfma_f32_16x16x32_bf16 v[68:71], a[224:227], a[4:7], v[68:71]
  ds_read_b128 a[252:255], v3 offset:448
  v_mfma_f32_16x16x32_bf16 v[72:75], a[224:227], a[8:11], v[36:39]
  v_exp_f32 v52, v52
  v_mfma_f32_16x16x32_bf16 v[72:75], a[228:231], a[20:23], v[72:75]
  s_waitcnt lgkmcnt(4)
  v_mfma_f32_16x16x32_bf16 v[72:75], a[232:235], a[32:35], v[72:75]
  ds_read_b128 a[224:227], v3 offset:896
  v_mfma_f32_16x16x32_bf16 v[72:75], a[236:239], a[44:47], v[72:75]
  v_exp_f32 v53, v53
  v_mfma_f32_16x16x32_bf16 v[68:71], a[236:239], a[40:43], v[68:71]
  s_add_u32 m0, s33, 35904
  s_add_u32 s34, s34, 0x1000
  v_mfma_f32_16x16x32_bf16 v[68:71], a[232:235], a[28:31], v[68:71]
  buffer_load_dwordx4 v1, s[8:11], s34 offen nt lds
  ds_read_b128 a[228:231], v3 offset:960
  v_mfma_f32_16x16x32_bf16 v[64:67], a[232:235], a[24:27], v[64:67]
  v_exp_f32 v54, v54
  v_mfma_f32_16x16x32_bf16 v[64:67], a[236:239], a[36:39], v[64:67]
  s_waitcnt lgkmcnt(4)
  v_mfma_f32_16x16x32_bf16 v[64:67], a[240:243], a[48:51], v[64:67]
  s_waitcnt vmcnt(4)
  ds_read_b128 a[232:235], v3 offset:768
  v_mfma_f32_16x16x32_bf16 v[64:67], a[244:247], a[60:63], v[64:67]
  v_exp_f32 v55, v55
  v_mfma_f32_16x16x32_bf16 v[68:71], a[244:247], a[64:67], v[68:71]
  v_exp_f32 v56, v56
  v_mfma_f32_16x16x32_bf16 v[68:71], a[240:243], a[52:55], v[68:71]
  ds_read_b128 a[236:239], v3 offset:832
  v_mfma_f32_16x16x32_bf16 v[72:75], a[240:243], a[56:59], v[72:75]
  v_exp_f32 v57, v57
  v_mfma_f32_16x16x32_bf16 v[72:75], a[244:247], a[68:71], v[72:75]
  s_waitcnt lgkmcnt(4)
  v_mfma_f32_16x16x32_bf16 v[72:75], a[248:251], a[80:83], v[72:75]
  ds_read_b128 a[240:243], v3 offset:640
  v_mfma_f32_16x16x32_bf16 v[72:75], a[252:255], a[92:95], v[72:75]
  v_exp_f32 v58, v58
  v_mfma_f32_16x16x32_bf16 v[68:71], a[252:255], a[88:91], v[68:71]
  s_add_u32 m0, s33, 36960
  s_add_u32 s34, s34, 0x1000
  v_mfma_f32_16x16x32_bf16 v[68:71], a[248:251], a[76:79], v[68:71]
  buffer_load_dwordx4 v1, s[8:11], s34 offen nt lds
  ds_read_b128 a[244:247], v3 offset:704
  v_mfma_f32_16x16x32_bf16 v[64:67], a[248:251], a[72:75], v[64:67]
  v_exp_f32 v59, v59
  v_mfma_f32_16x16x32_bf16 v[64:67], a[252:255], a[84:87], v[64:67]
  s_waitcnt lgkmcnt(4)
  v_mfma_f32_16x16x32_bf16 v[76:79], a[224:227], a[72:75], v[28:31]
  s_waitcnt vmcnt(4)
  ds_read_b128 a[248:251], v3 offset:512
  v_mfma_f32_16x16x32_bf16 v[76:79], a[228:231], a[84:87], v[76:79]
  v_exp_f32 v60, v60
  v_mfma_f32_16x16x32_bf16 v[80:83], a[228:231], a[88:91], v[32:35]
  v_exp_f32 v61, v61
  v_mfma_f32_16x16x32_bf16 v[80:83], a[224:227], a[76:79], v[80:83]
  ds_read_b128 a[252:255], v3 offset:576
  v_mfma_f32_16x16x32_bf16 v[84:87], a[224:227], a[80:83], v[36:39]
  v_exp_f32 v62, v62
  v_mfma_f32_16x16x32_bf16 v[84:87], a[228:231], a[92:95], v[84:87]
  s_waitcnt lgkmcnt(4)
  v_mfma_f32_16x16x32_bf16 v[84:87], a[232:235], a[56:59], v[84:87]
  s_waitcnt vmcnt(4)
  s_barrier
  v_mfma_f32_16x16x32_bf16 v[84:87], a[236:239], a[68:71], v[84:87]
  ds_read_b64_tr_b16 a[224:225], v5 offset:16896
  v_mfma_f32_16x16x32_bf16 v[80:83], a[236:239], a[64:67], v[80:83]
  ds_read_b64_tr_b16 a[226:227], v5 offset:17152
  s_add_u32 m0, s33, 50688
  s_add_u32 s35, s35, 0x4f00
  v_mfma_f32_16x16x32_bf16 v[80:83], a[232:235], a[52:55], v[80:83]
  buffer_load_dwordx4 v4, s[12:15], s35 offen nt lds
  ds_read_b64_tr_b16 a[228:229], v5 offset:17408
  v_mfma_f32_16x16x32_bf16 v[76:79], a[232:235], a[48:51], v[76:79]
  ds_read_b64_tr_b16 a[230:231], v5 offset:17664
  v_mfma_f32_16x16x32_bf16 v[76:79], a[236:239], a[60:63], v[76:79]
  s_waitcnt lgkmcnt(6)
  v_mfma_f32_16x16x32_bf16 v[76:79], a[240:243], a[24:27], v[76:79]
  s_waitcnt vmcnt(4)
  ds_read_b64_tr_b16 a[232:233], v5 offset:16928
  v_mfma_f32_16x16x32_bf16 v[76:79], a[244:247], a[36:39], v[76:79]
  ds_read_b64_tr_b16 a[234:235], v5 offset:17184
  v_mfma_f32_16x16x32_bf16 v[80:83], a[244:247], a[40:43], v[80:83]
  v_exp_f32 v63, v63
  v_mfma_f32_16x16x32_bf16 v[80:83], a[240:243], a[28:31], v[80:83]
  ds_read_b64_tr_b16 a[236:237], v5 offset:17440
  v_mfma_f32_16x16x32_bf16 v[84:87], a[240:243], a[32:35], v[84:87]
  ds_read_b64_tr_b16 a[238:239], v5 offset:17696
  v_mfma_f32_16x16x32_bf16 v[84:87], a[244:247], a[44:47], v[84:87]
  s_waitcnt lgkmcnt(8)
  v_mfma_f32_16x16x32_bf16 v[84:87], a[248:251], a[8:11], v[84:87]
  ds_read_b64_tr_b16 a[240:241], v5 offset:16960
  v_mfma_f32_16x16x32_bf16 v[84:87], a[252:255], a[20:23], v[84:87]
  ds_read_b64_tr_b16 a[242:243], v5 offset:17216
  v_mfma_f32_16x16x32_bf16 v[80:83], a[252:255], a[16:19], v[80:83]
  s_add_u32 m0, s33, 51744
  s_add_u32 s35, s35, 0x1000
  v_mfma_f32_16x16x32_bf16 v[80:83], a[248:251], a[4:7], v[80:83]
  buffer_load_dwordx4 v4, s[12:15], s35 offen nt lds
  ds_read_b64_tr_b16 a[244:245], v5 offset:17472
  v_mfma_f32_16x16x32_bf16 v[76:79], a[248:251], a[0:3], v[76:79]
  ds_read_b64_tr_b16 a[246:247], v5 offset:17728
  v_mfma_f32_16x16x32_bf16 v[76:79], a[252:255], a[12:15], v[76:79]
  v_mfma_f32_16x16x32_bf16 a[144:147], a[168:171], v[248:251], a[144:147]
  s_waitcnt vmcnt(4)
  v_mfma_f32_16x16x32_bf16 a[140:143], a[168:171], v[244:247], a[140:143]
  v_exp_f32 v64, v64
  v_mfma_f32_16x16x32_bf16 a[136:139], a[168:171], v[240:243], a[136:139]
  s_waitcnt lgkmcnt(8)
  v_mfma_f32_16x16x32_bf16 v[184:187], a[224:227], v[16:19], v[184:187]
  ds_read_b64_tr_b16 a[248:249], v5 offset:16992
  v_mfma_f32_16x16x32_bf16 v[184:187], a[228:231], v[240:243], v[184:187]
  ds_read_b64_tr_b16 a[250:251], v5 offset:17248
  s_waitcnt vmcnt(8)
  v_mfma_f32_16x16x32_bf16 v[192:195], a[228:231], v[244:247], v[192:195]
  buffer_atomic_add_x2 a[180:181], v14, s[48:51], 0 offen sc1
  v_subrev_u32 v14, 0x200, v14
  v_mfma_f32_16x16x32_bf16 v[192:195], a[224:227], v[20:23], v[192:195]
  ds_read_b64_tr_b16 a[252:253], v5 offset:17504
  v_mfma_f32_16x16x32_bf16 v[200:203], a[224:227], v[24:27], v[200:203]
  ds_read_b64_tr_b16 a[254:255], v5 offset:17760
  v_mfma_f32_16x16x32_bf16 v[200:203], a[228:231], v[248:251], v[200:203]
  s_add_u32 m0, s33, 52800
  s_add_u32 s35, s35, 0x1000
  s_waitcnt lgkmcnt(8)
  v_mfma_f32_16x16x32_bf16 v[204:207], a[236:239], v[248:251], v[204:207]
  buffer_load_dwordx4 v4, s[12:15], s35 offen nt lds
  ds_read_b64_tr_b16 a[224:225], v5 offset:17024
  v_mfma_f32_16x16x32_bf16 v[204:207], a[232:235], v[24:27], v[204:207]
  ds_read_b64_tr_b16 a[226:227], v5 offset:17280
  v_mfma_f32_16x16x32_bf16 v[196:199], a[232:235], v[20:23], v[196:199]
  v_exp_f32 v65, v65
  v_mfma_f32_16x16x32_bf16 v[196:199], a[236:239], v[244:247], v[196:199]
  s_waitcnt vmcnt(5)
  ds_read_b64_tr_b16 a[228:229], v5 offset:17536
  v_mfma_f32_16x16x32_bf16 v[188:191], a[236:239], v[240:243], v[188:191]
  ds_read_b64_tr_b16 a[230:231], v5 offset:17792
  v_mfma_f32_16x16x32_bf16 v[188:191], a[232:235], v[16:19], v[188:191]
  s_waitcnt lgkmcnt(8)
  v_mfma_f32_16x16x32_bf16 v[208:211], a[240:243], v[16:19], v[208:211]
  ds_read_b64_tr_b16 a[232:233], v5 offset:17056
  v_mfma_f32_16x16x32_bf16 v[208:211], a[244:247], v[240:243], v[208:211]
  ds_read_b64_tr_b16 a[234:235], v5 offset:17312
  v_mfma_f32_16x16x32_bf16 v[216:219], a[244:247], v[244:247], v[216:219]
  v_exp_f32 v66, v66
  v_mfma_f32_16x16x32_bf16 v[216:219], a[240:243], v[20:23], v[216:219]
  ds_read_b64_tr_b16 a[236:237], v5 offset:17568
  v_mfma_f32_16x16x32_bf16 v[224:227], a[240:243], v[24:27], v[224:227]
  ds_read_b64_tr_b16 a[238:239], v5 offset:17824
  v_mfma_f32_16x16x32_bf16 v[224:227], a[244:247], v[248:251], v[224:227]
  s_add_u32 m0, s33, 53856
  s_add_u32 s35, s35, 0x1000
  s_waitcnt lgkmcnt(8)
  v_mfma_f32_16x16x32_bf16 v[228:231], a[252:255], v[248:251], v[228:231]
  buffer_load_dwordx4 v4, s[12:15], s35 offen nt lds
  ds_read_b64_tr_b16 a[240:241], v5 offset:17088
  v_mfma_f32_16x16x32_bf16 v[228:231], a[248:251], v[24:27], v[228:231]
  ds_read_b64_tr_b16 a[242:243], v5 offset:17344
  v_mfma_f32_16x16x32_bf16 v[220:223], a[248:251], v[20:23], v[220:223]
  v_exp_f32 v67, v67
  v_mfma_f32_16x16x32_bf16 v[220:223], a[252:255], v[244:247], v[220:223]
  s_waitcnt vmcnt(5)
  ds_read_b64_tr_b16 a[244:245], v5 offset:17600
  v_mfma_f32_16x16x32_bf16 v[212:215], a[252:255], v[240:243], v[212:215]
  ds_read_b64_tr_b16 a[246:247], v5 offset:17856
  v_mfma_f32_16x16x32_bf16 v[212:215], a[248:251], v[16:19], v[212:215]
  s_waitcnt lgkmcnt(8)
  v_mfma_f32_16x16x32_bf16 v[232:235], a[224:227], v[16:19], v[232:235]
  ds_read_b64_tr_b16 a[248:249], v5 offset:17120
  v_mfma_f32_16x16x32_bf16 v[232:235], a[228:231], v[240:243], v[232:235]
  ds_read_b64_tr_b16 a[250:251], v5 offset:17376
  v_mfma_f32_16x16x32_bf16 a[96:99], a[228:231], v[244:247], a[96:99]
  v_exp_f32 v68, v68
  v_mfma_f32_16x16x32_bf16 a[96:99], a[224:227], v[20:23], a[96:99]
  ds_read_b64_tr_b16 a[252:253], v5 offset:17632
  v_mfma_f32_16x16x32_bf16 a[104:107], a[224:227], v[24:27], a[104:107]
  ds_read_b64_tr_b16 a[254:255], v5 offset:17888
  v_mfma_f32_16x16x32_bf16 a[104:107], a[228:231], v[248:251], a[104:107]
  s_waitcnt lgkmcnt(8)
  v_mfma_f32_16x16x32_bf16 a[108:111], a[236:239], v[248:251], a[108:111]
  s_waitcnt vmcnt(5)
  s_barrier
  v_mfma_f32_16x16x32_bf16 a[108:111], a[232:235], v[24:27], a[108:111]
  ds_read_b128 a[224:227], v3 offset:33792
  v_mfma_f32_16x16x32_bf16 a[100:103], a[232:235], v[20:23], a[100:103]
  s_add_u32 m0, s33, 0
  s_add_u32 s34, s34, 0x1000
  v_mfma_f32_16x16x32_bf16 a[100:103], a[236:239], v[244:247], a[100:103]
  buffer_load_dwordx4 v1, s[8:11], s34 offen nt lds
  ds_read_b128 a[228:231], v3 offset:33856
  v_mfma_f32_16x16x32_bf16 v[236:239], a[236:239], v[240:243], v[236:239]
  v_exp_f32 v69, v69
  v_mfma_f32_16x16x32_bf16 v[236:239], a[232:235], v[16:19], v[236:239]
  s_waitcnt lgkmcnt(6)
  v_mfma_f32_16x16x32_bf16 a[112:115], a[240:243], v[16:19], a[112:115]
  s_waitcnt vmcnt(5)
  ds_read_b128 a[232:235], v3 offset:33920
  v_mfma_f32_16x16x32_bf16 a[112:115], a[244:247], v[240:243], a[112:115]
  v_exp_f32 v70, v70
  v_mfma_f32_16x16x32_bf16 a[120:123], a[244:247], v[244:247], a[120:123]
  v_exp_f32 v71, v71
  v_mfma_f32_16x16x32_bf16 a[120:123], a[240:243], v[20:23], a[120:123]
  ds_read_b128 a[236:239], v3 offset:33984
  v_mfma_f32_16x16x32_bf16 a[128:131], a[240:243], v[24:27], a[128:131]
  v_exp_f32 v72, v72
  v_mfma_f32_16x16x32_bf16 a[128:131], a[244:247], v[248:251], a[128:131]
  s_waitcnt lgkmcnt(4)
  v_mfma_f32_16x16x32_bf16 a[132:135], a[252:255], v[248:251], a[132:135]
  ds_read_b128 a[240:243], v3 offset:34048
  v_mfma_f32_16x16x32_bf16 a[132:135], a[248:251], v[24:27], a[132:135]
  v_exp_f32 v73, v73
  v_mfma_f32_16x16x32_bf16 a[124:127], a[248:251], v[20:23], a[124:127]
  s_add_u32 m0, s33, 1056
  s_add_u32 s34, s34, 0x1000
  v_mfma_f32_16x16x32_bf16 a[124:127], a[252:255], v[244:247], a[124:127]
  buffer_load_dwordx4 v1, s[8:11], s34 offen nt lds
  ds_read_b128 a[244:247], v3 offset:34112
  v_mfma_f32_16x16x32_bf16 a[116:119], a[252:255], v[240:243], a[116:119]
  v_mfma_f32_16x16x32_bf16 a[116:119], a[248:251], v[16:19], a[116:119]
  v_cvt_pk_bf16_f32 v16, v40, v41
  v_cvt_pk_bf16_f32 v17, v42, v43
  v_cvt_pk_bf16_f32 v20, v44, v45
  v_cvt_pk_bf16_f32 v21, v46, v47
  v_cvt_pk_bf16_f32 v24, v48, v49
  v_cvt_pk_bf16_f32 v25, v50, v51
  s_waitcnt lgkmcnt(4)
  v_mfma_f32_16x16x32_bf16 v[40:43], a[224:227], a[0:3], v[28:31]
  s_waitcnt vmcnt(5)
  ds_read_b128 a[248:251], v3 offset:34176
  v_mfma_f32_16x16x32_bf16 v[40:43], a[228:231], a[12:15], v[40:43]
  v_cvt_pk_bf16_f32 v18, v52, v53
  v_cvt_pk_bf16_f32 v19, v54, v55
  v_mfma_f32_16x16x32_bf16 v[44:47], a[228:231], a[16:19], v[32:35]
  v_cvt_pk_bf16_f32 v22, v56, v57
  v_cvt_pk_bf16_f32 v23, v58, v59
  v_mfma_f32_16x16x32_bf16 v[44:47], a[224:227], a[4:7], v[44:47]
  ds_read_b128 a[252:255], v3 offset:34240
  v_cvt_pk_bf16_f32 v26, v60, v61
  v_mfma_f32_16x16x32_bf16 v[48:51], a[224:227], a[8:11], v[36:39]
  v_cvt_pk_bf16_f32 v27, v62, v63
  v_mfma_f32_16x16x32_bf16 v[48:51], a[228:231], a[20:23], v[48:51]
  v_exp_f32 v74, v74
  s_waitcnt lgkmcnt(4)
  v_mfma_f32_16x16x32_bf16 v[48:51], a[232:235], a[32:35], v[48:51]
  ds_read_b128 a[224:227], v3 offset:34688
  v_mfma_f32_16x16x32_bf16 v[48:51], a[236:239], a[44:47], v[48:51]
  v_exp_f32 v75, v75
  v_mfma_f32_16x16x32_bf16 v[44:47], a[236:239], a[40:43], v[44:47]
  s_add_u32 m0, s33, 2112
  s_add_u32 s34, s34, 0x1000
  v_mfma_f32_16x16x32_bf16 v[44:47], a[232:235], a[28:31], v[44:47]
  buffer_load_dwordx4 v1, s[8:11], s34 offen nt lds
  ds_read_b128 a[228:231], v3 offset:34752
  v_mfma_f32_16x16x32_bf16 v[40:43], a[232:235], a[24:27], v[40:43]
  v_exp_f32 v76, v76
  v_mfma_f32_16x16x32_bf16 v[40:43], a[236:239], a[36:39], v[40:43]
  s_waitcnt lgkmcnt(4)
  v_mfma_f32_16x16x32_bf16 v[40:43], a[240:243], a[48:51], v[40:43]
  s_waitcnt vmcnt(4)
  ds_read_b128 a[232:235], v3 offset:34560
  v_mfma_f32_16x16x32_bf16 v[40:43], a[244:247], a[60:63], v[40:43]
  v_exp_f32 v77, v77
  v_mfma_f32_16x16x32_bf16 v[44:47], a[244:247], a[64:67], v[44:47]
  v_exp_f32 v78, v78
  v_mfma_f32_16x16x32_bf16 v[44:47], a[240:243], a[52:55], v[44:47]
  ds_read_b128 a[236:239], v3 offset:34624
  v_exp_f32 v79, v79
  v_mfma_f32_16x16x32_bf16 v[48:51], a[240:243], a[56:59], v[48:51]
  v_exp_f32 v80, v80
  v_mfma_f32_16x16x32_bf16 v[48:51], a[244:247], a[68:71], v[48:51]
  s_waitcnt lgkmcnt(4)
  v_mfma_f32_16x16x32_bf16 v[48:51], a[248:251], a[80:83], v[48:51]
  ds_read_b128 a[240:243], v3 offset:34432
  v_exp_f32 v81, v81
  v_mfma_f32_16x16x32_bf16 v[48:51], a[252:255], a[92:95], v[48:51]
  v_exp_f32 v82, v82
  v_mfma_f32_16x16x32_bf16 v[44:47], a[252:255], a[88:91], v[44:47]
  s_add_u32 m0, s33, 3168
  s_add_u32 s34, s34, 0x1000
  v_mfma_f32_16x16x32_bf16 v[44:47], a[248:251], a[76:79], v[44:47]
  buffer_load_dwordx4 v1, s[8:11], s34 offen nt lds
  ds_read_b128 a[244:247], v3 offset:34496
  v_mfma_f32_16x16x32_bf16 v[40:43], a[248:251], a[72:75], v[40:43]
  v_mfma_f32_16x16x32_bf16 v[40:43], a[252:255], a[84:87], v[40:43]
  v_exp_f32 v83, v83
  s_waitcnt lgkmcnt(4)
  v_mfma_f32_16x16x32_bf16 v[52:55], a[224:227], a[72:75], v[28:31]
  s_waitcnt vmcnt(4)
  ds_read_b128 a[248:251], v3 offset:34304
  v_mfma_f32_16x16x32_bf16 v[52:55], a[228:231], a[84:87], v[52:55]
  v_exp_f32 v84, v84
  v_mfma_f32_16x16x32_bf16 v[56:59], a[228:231], a[88:91], v[32:35]
  v_exp_f32 v85, v85
  v_mfma_f32_16x16x32_bf16 v[56:59], a[224:227], a[76:79], v[56:59]
  ds_read_b128 a[252:255], v3 offset:34368
  v_exp_f32 v86, v86
  v_mfma_f32_16x16x32_bf16 v[60:63], a[224:227], a[80:83], v[36:39]
  v_exp_f32 v87, v87
  v_mfma_f32_16x16x32_bf16 v[60:63], a[228:231], a[92:95], v[60:63]
  v_cvt_pk_bf16_f32 v240, v64, v65
  s_waitcnt lgkmcnt(4)
  v_mfma_f32_16x16x32_bf16 v[60:63], a[232:235], a[56:59], v[60:63]
  s_waitcnt vmcnt(4)
  s_barrier
  v_mfma_f32_16x16x32_bf16 v[60:63], a[236:239], a[68:71], v[60:63]
  ds_read_b64_tr_b16 a[224:225], v5 offset:50688
  v_cvt_pk_bf16_f32 v241, v66, v67
  v_mfma_f32_16x16x32_bf16 v[56:59], a[236:239], a[64:67], v[56:59]
  ds_read_b64_tr_b16 a[226:227], v5 offset:50944
  s_add_u32 m0, s33, 16896
  s_add_u32 s35, s35, 0xffffd100
  v_mfma_f32_16x16x32_bf16 v[56:59], a[232:235], a[52:55], v[56:59]
  buffer_load_dwordx4 v4, s[12:15], s35 offen nt lds
  ds_read_b64_tr_b16 a[228:229], v5 offset:51200
  v_mfma_f32_16x16x32_bf16 v[52:55], a[232:235], a[48:51], v[52:55]
  ds_read_b64_tr_b16 a[230:231], v5 offset:51456
  v_mfma_f32_16x16x32_bf16 v[52:55], a[236:239], a[60:63], v[52:55]
  v_cvt_pk_bf16_f32 v244, v68, v69
  s_waitcnt lgkmcnt(6)
  v_mfma_f32_16x16x32_bf16 v[52:55], a[240:243], a[24:27], v[52:55]
  s_waitcnt vmcnt(4)
  ds_read_b64_tr_b16 a[232:233], v5 offset:50720
  v_mfma_f32_16x16x32_bf16 v[52:55], a[244:247], a[36:39], v[52:55]
  ds_read_b64_tr_b16 a[234:235], v5 offset:50976
  v_cvt_pk_bf16_f32 v245, v70, v71
  v_mfma_f32_16x16x32_bf16 v[56:59], a[244:247], a[40:43], v[56:59]
  v_cvt_pk_bf16_f32 v248, v72, v73
  v_cvt_pk_bf16_f32 v249, v74, v75
  v_mfma_f32_16x16x32_bf16 v[56:59], a[240:243], a[28:31], v[56:59]
  ds_read_b64_tr_b16 a[236:237], v5 offset:51232
  v_cvt_pk_bf16_f32 v242, v76, v77
  v_cvt_pk_bf16_f32 v243, v78, v79
  v_mfma_f32_16x16x32_bf16 v[60:63], a[240:243], a[32:35], v[60:63]
  ds_read_b64_tr_b16 a[238:239], v5 offset:51488
  v_cvt_pk_bf16_f32 v246, v80, v81
  v_mfma_f32_16x16x32_bf16 v[60:63], a[244:247], a[44:47], v[60:63]
  v_cvt_pk_bf16_f32 v247, v82, v83
  s_waitcnt lgkmcnt(8)
  v_mfma_f32_16x16x32_bf16 v[60:63], a[248:251], a[8:11], v[60:63]
  ds_read_b64_tr_b16 a[240:241], v5 offset:50752
  v_cvt_pk_bf16_f32 v250, v84, v85
  v_mfma_f32_16x16x32_bf16 v[60:63], a[252:255], a[20:23], v[60:63]
  ds_read_b64_tr_b16 a[242:243], v5 offset:51008
  v_cvt_pk_bf16_f32 v251, v86, v87
  v_mfma_f32_16x16x32_bf16 v[56:59], a[252:255], a[16:19], v[56:59]
  s_add_u32 m0, s33, 17952
  s_add_u32 s35, s35, 0x1000
  v_mfma_f32_16x16x32_bf16 v[56:59], a[248:251], a[4:7], v[56:59]
  buffer_load_dwordx4 v4, s[12:15], s35 offen nt lds
  ds_read_b64_tr_b16 a[244:245], v5 offset:51264
  v_mfma_f32_16x16x32_bf16 v[52:55], a[248:251], a[0:3], v[52:55]
  ds_read_b64_tr_b16 a[246:247], v5 offset:51520
  v_mfma_f32_16x16x32_bf16 v[52:55], a[252:255], a[12:15], v[52:55]
  s_sub_u32 s39, s39, 1
  s_cmp_gt_u32 s39, 1
  s_cbranch_scc1 L_loop
  s_branch L_loop_end
L_depth11:
  v_mfma_f32_16x16x32_bf16 a[144:147], a[168:171], v[24:27], a[144:147]
  v_mfma_f32_16x16x32_bf16 a[140:143], a[168:171], v[20:23], a[140:143]
  v_exp_f32 v40, v40
  v_mfma_f32_16x16x32_bf16 a[136:139], a[168:171], v[16:19], a[136:139]
  s_waitcnt lgkmcnt(8)
  v_mfma_f32_16x16x32_bf16 v[88:91], a[224:227], v[16:19], v[88:91]
  ds_read_b64_tr_b16 a[248:249], v5 offset:50784
  v_mfma_f32_16x16x32_bf16 v[88:91], a[228:231], v[240:243], v[88:91]
  ds_read_b64_tr_b16 a[250:251], v5 offset:51040
  v_mfma_f32_16x16x32_bf16 v[96:99], a[228:231], v[244:247], v[96:99]
  buffer_store_dwordx4 a[148:151], v14, s[44:47], s70 offen sc1
  v_mfma_f32_16x16x32_bf16 v[96:99], a[224:227], v[20:23], v[96:99]
  ds_read_b64_tr_b16 a[252:253], v5 offset:51296
  v_mfma_f32_16x16x32_bf16 v[104:107], a[224:227], v[24:27], v[104:107]
  ds_read_b64_tr_b16 a[254:255], v5 offset:51552
  v_mfma_f32_16x16x32_bf16 v[104:107], a[228:231], v[248:251], v[104:107]
  s_waitcnt vmcnt(5)
  s_add_u32 m0, s33, 19008
  s_add_u32 s35, s35, 0x1000
  s_waitcnt lgkmcnt(8)
  v_mfma_f32_16x16x32_bf16 v[108:111], a[236:239], v[248:251], v[108:111]
  buffer_load_dwordx4 v4, s[12:15], s35 offen nt lds
  ds_read_b64_tr_b16 a[224:225], v5 offset:50816
  v_mfma_f32_16x16x32_bf16 v[108:111], a[232:235], v[24:27], v[108:111]
  ds_read_b64_tr_b16 a[226:227], v5 offset:51072
  v_mfma_f32_16x16x32_bf16 v[100:103], a[232:235], v[20:23], v[100:103]
  v_exp_f32 v41, v41
  v_mfma_f32_16x16x32_bf16 v[100:103], a[236:239], v[244:247], v[100:103]
  ds_read_b64_tr_b16 a[228:229], v5 offset:51328
  v_mfma_f32_16x16x32_bf16 v[92:95], a[236:239], v[240:243], v[92:95]
  ds_read_b64_tr_b16 a[230:231], v5 offset:51584
  v_mfma_f32_16x16x32_bf16 v[92:95], a[232:235], v[16:19], v[92:95]
  s_waitcnt lgkmcnt(8)
  v_mfma_f32_16x16x32_bf16 v[112:115], a[240:243], v[16:19], v[112:115]
  ds_read_b64_tr_b16 a[232:233], v5 offset:50848
  v_mfma_f32_16x16x32_bf16 v[112:115], a[244:247], v[240:243], v[112:115]
  ds_read_b64_tr_b16 a[234:235], v5 offset:51104
  v_mfma_f32_16x16x32_bf16 v[120:123], a[244:247], v[244:247], v[120:123]
  v_exp_f32 v42, v42
  v_mfma_f32_16x16x32_bf16 v[120:123], a[240:243], v[20:23], v[120:123]
  ds_read_b64_tr_b16 a[236:237], v5 offset:51360
  v_mfma_f32_16x16x32_bf16 v[128:131], a[240:243], v[24:27], v[128:131]
  ds_read_b64_tr_b16 a[238:239], v5 offset:51616
  v_mfma_f32_16x16x32_bf16 v[128:131], a[244:247], v[248:251], v[128:131]
  s_waitcnt vmcnt(5)
  s_add_u32 m0, s33, 20064
  s_add_u32 s35, s35, 0x1000
  s_waitcnt lgkmcnt(8)
  v_mfma_f32_16x16x32_bf16 v[132:135], a[252:255], v[248:251], v[132:135]
  buffer_load_dwordx4 v4, s[12:15], s35 offen nt lds
  ds_read_b64_tr_b16 a[240:241], v5 offset:50880
  v_mfma_f32_16x16x32_bf16 v[132:135], a[248:251], v[24:27], v[132:135]
  ds_read_b64_tr_b16 a[242:243], v5 offset:51136
  v_mfma_f32_16x16x32_bf16 v[124:127], a[248:251], v[20:23], v[124:127]
  v_exp_f32 v43, v43
  v_mfma_f32_16x16x32_bf16 v[124:127], a[252:255], v[244:247], v[124:127]
  ds_read_b64_tr_b16 a[244:245], v5 offset:51392
  v_mfma_f32_16x16x32_bf16 v[116:119], a[252:255], v[240:243], v[116:119]
  ds_read_b64_tr_b16 a[246:247], v5 offset:51648
  v_mfma_f32_16x16x32_bf16 v[116:119], a[248:251], v[16:19], v[116:119]
  s_waitcnt lgkmcnt(8)
  v_mfma_f32_16x16x32_bf16 v[136:139], a[224:227], v[16:19], v[136:139]
  ds_read_b64_tr_b16 a[248:249], v5 offset:50912
  v_mfma_f32_16x16x32_bf16 v[136:139], a[228:231], v[240:243], v[136:139]
  ds_read_b64_tr_b16 a[250:251], v5 offset:51168
  v_mfma_f32_16x16x32_bf16 v[144:147], a[228:231], v[244:247], v[144:147]
  v_exp_f32 v44, v44
  v_mfma_f32_16x16x32_bf16 v[144:147], a[224:227], v[20:23], v[144:147]
  ds_read_b64_tr_b16 a[252:253], v5 offset:51424
  v_mfma_f32_16x16x32_bf16 v[152:155], a[224:227], v[24:27], v[152:155]
  ds_read_b64_tr_b16 a[254:255], v5 offset:51680
  v_mfma_f32_16x16x32_bf16 v[152:155], a[228:231], v[248:251], v[152:155]
  s_waitcnt vmcnt(5)
  s_waitcnt lgkmcnt(8)
  v_mfma_f32_16x16x32_bf16 v[156:159], a[236:239], v[248:251], v[156:159]
  s_waitcnt vmcnt(5)
  s_barrier
  v_mfma_f32_16x16x32_bf16 v[156:159], a[232:235], v[24:27], v[156:159]
  ds_read_b128 a[224:227], v3 offset:0
  v_mfma_f32_16x16x32_bf16 v[148:151], a[232:235], v[20:23], v[148:151]
  s_add_u32 m0, s33, 33792
  s_add_u32 s34, s34, 0x1000
  v_mfma_f32_16x16x32_bf16 v[148:151], a[236:239], v[244:247], v[148:151]
  buffer_load_dwordx4 v1, s[8:11], s34 offen nt lds
  ds_read_b128 a[228:231], v3 offset:64
  v_mfma_f32_16x16x32_bf16 v[140:143], a[236:239], v[240:243], v[140:143]
  v_exp_f32 v45, v45
  v_mfma_f32_16x16x32_bf16 v[140:143], a[232:235], v[16:19], v[140:143]
  s_waitcnt lgkmcnt(6)
  v_mfma_f32_16x16x32_bf16 v[160:163], a[240:243], v[16:19], v[160:163]
  ds_read_b128 a[232:235], v3 offset:128
  v_mfma_f32_16x16x32_bf16 v[160:163], a[244:247], v[240:243], v[160:163]
  v_exp_f32 v46, v46
  v_mfma_f32_16x16x32_bf16 v[168:171], a[244:247], v[244:247], v[168:171]
  v_exp_f32 v47, v47
  v_mfma_f32_16x16x32_bf16 v[168:171], a[240:243], v[20:23], v[168:171]
  ds_read_b128 a[236:239], v3 offset:192
  v_mfma_f32_16x16x32_bf16 v[176:179], a[240:243], v[24:27], v[176:179]
  v_exp_f32 v48, v48
  v_mfma_f32_16x16x32_bf16 v[176:179], a[244:247], v[248:251], v[176:179]
  s_waitcnt lgkmcnt(4)
  v_mfma_f32_16x16x32_bf16 v[180:183], a[252:255], v[248:251], v[180:183]
  ds_read_b128 a[240:243], v3 offset:256
  v_mfma_f32_16x16x32_bf16 v[180:183], a[248:251], v[24:27], v[180:183]
  v_exp_f32 v49, v49
  v_mfma_f32_16x16x32_bf16 v[172:175], a[248:251], v[20:23], v[172:175]
  s_waitcnt vmcnt(5)
  s_add_u32 m0, s33, 34848
  s_add_u32 s34, s34, 0x1000
  v_mfma_f32_16x16x32_bf16 v[172:175], a[252:255], v[244:247], v[172:175]
  buffer_load_dwordx4 v1, s[8:11], s34 offen nt lds
  ds_read_b128 a[244:247], v3 offset:320
  v_mfma_f32_16x16x32_bf16 v[164:167], a[252:255], v[240:243], v[164:167]
  v_mfma_f32_16x16x32_bf16 v[164:167], a[248:251], v[16:19], v[164:167]
  s_waitcnt lgkmcnt(4)
  v_mfma_f32_16x16x32_bf16 v[64:67], a[224:227], a[0:3], v[28:31]
  ds_read_b128 a[248:251], v3 offset:384
  v_mfma_f32_16x16x32_bf16 v[64:67], a[228:231], a[12:15], v[64:67]
  v_exp_f32 v50, v50
  v_mfma_f32_16x16x32_bf16 v[68:71], a[228:231], a[16:19], v[32:35]
  v_exp_f32 v51, v51
  v_mfma_f32_16x16x32_bf16 v[68:71], a[224:227], a[4:7], v[68:71]
  ds_read_b128 a[252:255], v3 offset:448
  v_mfma_f32_16x16x32_bf16 v[72:75], a[224:227], a[8:11], v[36:39]
  v_exp_f32 v52, v52
  v_mfma_f32_16x16x32_bf16 v[72:75], a[228:231], a[20:23], v[72:75]
  s_waitcnt lgkmcnt(4)
  v_mfma_f32_16x16x32_bf16 v[72:75], a[232:235], a[32:35], v[72:75]
  ds_read_b128 a[224:227], v3 offset:896
  v_mfma_f32_16x16x32_bf16 v[72:75], a[236:239], a[44:47], v[72:75]
  v_exp_f32 v53, v53
  v_mfma_f32_16x16x32_bf16 v[68:71], a[236:239], a[40:43], v[68:71]
  s_waitcnt vmcnt(5)
  s_add_u32 m0, s33, 35904
  s_add_u32 s34, s34, 0x1000
  v_mfma_f32_16x16x32_bf16 v[68:71], a[232:235], a[28:31], v[68:71]
  buffer_load_dwordx4 v1, s[8:11], s34 offen nt lds
  ds_read_b128 a[228:231], v3 offset:960
  v_mfma_f32_16x16x32_bf16 v[64:67], a[232:235], a[24:27], v[64:67]
  v_exp_f32 v54, v54
  v_mfma_f32_16x16x32_bf16 v[64:67], a[236:239], a[36:39], v[64:67]
  s_waitcnt lgkmcnt(4)
  v_mfma_f32_16x16x32_bf16 v[64:67], a[240:243], a[48:51], v[64:67]
  ds_read_b128 a[232:235], v3 offset:768
  v_mfma_f32_16x16x32_bf16 v[64:67], a[244:247], a[60:63], v[64:67]
  v_exp_f32 v55, v55
  v_mfma_f32_16x16x32_bf16 v[68:71], a[244:247], a[64:67], v[68:71]
  v_exp_f32 v56, v56
  v_mfma_f32_16x16x32_bf16 v[68:71], a[240:243], a[52:55], v[68:71]
  ds_read_b128 a[236:239], v3 offset:832
  v_mfma_f32_16x16x32_bf16 v[72:75], a[240:243], a[56:59], v[72:75]
  v_exp_f32 v57, v57
  v_mfma_f32_16x16x32_bf16 v[72:75], a[244:247], a[68:71], v[72:75]
  s_waitcnt lgkmcnt(4)
  v_mfma_f32_16x16x32_bf16 v[72:75], a[248:251], a[80:83], v[72:75]
  ds_read_b128 a[240:243], v3 offset:640
  v_mfma_f32_16x16x32_bf16 v[72:75], a[252:255], a[92:95], v[72:75]
  v_exp_f32 v58, v58
  v_mfma_f32_16x16x32_bf16 v[68:71], a[252:255], a[88:91], v[68:71]
  s_waitcnt vmcnt(4)
  s_add_u32 m0, s33, 36960
  s_add_u32 s34, s34, 0x1000
  v_mfma_f32_16x16x32_bf16 v[68:71], a[248:251], a[76:79], v[68:71]
  buffer_load_dwordx4 v1, s[8:11], s34 offen nt lds
  ds_read_b128 a[244:247], v3 offset:704
  v_mfma_f32_16x16x32_bf16 v[64:67], a[248:251], a[72:75], v[64:67]
  v_exp_f32 v59, v59
  v_mfma_f32_16x16x32_bf16 v[64:67], a[252:255], a[84:87], v[64:67]
  s_waitcnt lgkmcnt(4)
  v_mfma_f32_16x16x32_bf16 v[76:79], a[224:227], a[72:75], v[28:31]
  ds_read_b128 a[248:251], v3 offset:512
  v_mfma_f32_16x16x32_bf16 v[76:79], a[228:231], a[84:87], v[76:79]
  v_exp_f32 v60, v60
  v_mfma_f32_16x16x32_bf16 v[80:83], a[228:231], a[88:91], v[32:35]
  v_exp_f32 v61, v61
  v_mfma_f32_16x16x32_bf16 v[80:83], a[224:227], a[76:79], v[80:83]
  ds_read_b128 a[252:255], v3 offset:576
  v_mfma_f32_16x16x32_bf16 v[84:87], a[224:227], a[80:83], v[36:39]
  v_exp_f32 v62, v62
  v_mfma_f32_16x16x32_bf16 v[84:87], a[228:231], a[92:95], v[84:87]
  s_waitcnt lgkmcnt(4)
  v_mfma_f32_16x16x32_bf16 v[84:87], a[232:235], a[56:59], v[84:87]
  s_waitcnt vmcnt(4)
  s_barrier
  v_mfma_f32_16x16x32_bf16 v[84:87], a[236:239], a[68:71], v[84:87]
  ds_read_b64_tr_b16 a[224:225], v5 offset:16896
  v_mfma_f32_16x16x32_bf16 v[80:83], a[236:239], a[64:67], v[80:83]
  s_waitcnt vmcnt(4)
  ds_read_b64_tr_b16 a[226:227], v5 offset:17152
  s_add_u32 m0, s33, 50688
  s_add_u32 s35, s35, 0x4f00
  v_mfma_f32_16x16x32_bf16 v[80:83], a[232:235], a[52:55], v[80:83]
  buffer_load_dwordx4 v4, s[12:15], s35 offen nt lds
  ds_read_b64_tr_b16 a[228:229], v5 offset:17408
  v_mfma_f32_16x16x32_bf16 v[76:79], a[232:235], a[48:51], v[76:79]
  ds_read_b64_tr_b16 a[230:231], v5 offset:17664
  v_mfma_f32_16x16x32_bf16 v[76:79], a[236:239], a[60:63], v[76:79]
  s_waitcnt lgkmcnt(6)
  v_mfma_f32_16x16x32_bf16 v[76:79], a[240:243], a[24:27], v[76:79]
  ds_read_b64_tr_b16 a[232:233], v5 offset:16928
  v_mfma_f32_16x16x32_bf16 v[76:79], a[244:247], a[36:39], v[76:79]
  ds_read_b64_tr_b16 a[234:235], v5 offset:17184
  v_mfma_f32_16x16x32_bf16 v[80:83], a[244:247], a[40:43], v[80:83]
  v_exp_f32 v63, v63
  v_mfma_f32_16x16x32_bf16 v[80:83], a[240:243], a[28:31], v[80:83]
  ds_read_b64_tr_b16 a[236:237], v5 offset:17440
  v_mfma_f32_16x16x32_bf16 v[84:87], a[240:243], a[32:35], v[84:87]
  ds_read_b64_tr_b16 a[238:239], v5 offset:17696
  v_mfma_f32_16x16x32_bf16 v[84:87], a[244:247], a[44:47], v[84:87]
  s_waitcnt lgkmcnt(8)
  v_mfma_f32_16x16x32_bf16 v[84:87], a[248:251], a[8:11], v[84:87]
  ds_read_b64_tr_b16 a[240:241], v5 offset:16960
  v_mfma_f32_16x16x32_bf16 v[84:87], a[252:255], a[20:23], v[84:87]
  ds_read_b64_tr_b16 a[242:243], v5 offset:17216
  v_mfma_f32_16x16x32_bf16 v[80:83], a[252:255], a[16:19], v[80:83]
  s_waitcnt vmcnt(4)
  s_add_u32 m0, s33, 51744
  s_add_u32 s35, s35, 0x1000
  v_mfma_f32_16x16x32_bf16 v[80:83], a[248:251], a[4:7], v[80:83]
  buffer_load_dwordx4 v4, s[12:15], s35 offen nt lds
  ds_read_b64_tr_b16 a[244:245], v5 offset:17472
  v_mfma_f32_16x16x32_bf16 v[76:79], a[248:251], a[0:3], v[76:79]
  ds_read_b64_tr_b16 a[246:247], v5 offset:17728
  v_mfma_f32_16x16x32_bf16 v[76:79], a[252:255], a[12:15], v[76:79]
  v_mfma_f32_16x16x32_bf16 a[144:147], a[168:171], v[248:251], a[144:147]
  v_mfma_f32_16x16x32_bf16 a[140:143], a[168:171], v[244:247], a[140:143]
  v_exp_f32 v64, v64
  v_mfma_f32_16x16x32_bf16 a[136:139], a[168:171], v[240:243], a[136:139]
  s_waitcnt lgkmcnt(8)
  v_mfma_f32_16x16x32_bf16 v[184:187], a[224:227], v[16:19], v[184:187]
  ds_read_b64_tr_b16 a[248:249], v5 offset:16992
  v_mfma_f32_16x16x32_bf16 v[184:187], a[228:231], v[240:243], v[184:187]
  ds_read_b64_tr_b16 a[250:251], v5 offset:17248
  s_waitcnt vmcnt(8)
  v_mfma_f32_16x16x32_bf16 v[192:195], a[228:231], v[244:247], v[192:195]
  buffer_atomic_add_x2 a[180:181], v14, s[48:51], 0 offen sc1
  v_subrev_u32 v14, 0x200, v14
  v_mfma_f32_16x16x32_bf16 v[192:195], a[224:227], v[20:23], v[192:195]
  ds_read_b64_tr_b16 a[252:253], v5 offset:17504
  v_mfma_f32_16x16x32_bf16 v[200:203], a[224:227], v[24:27], v[200:203]
  ds_read_b64_tr_b16 a[254:255], v5 offset:17760
  v_mfma_f32_16x16x32_bf16 v[200:203], a[228:231], v[248:251], v[200:203]
  s_waitcnt vmcnt(5)
  s_add_u32 m0, s33, 52800
  s_add_u32 s35, s35, 0x1000
  s_waitcnt lgkmcnt(8)
  v_mfma_f32_16x16x32_bf16 v[204:207], a[236:239], v[248:251], v[204:207]
  buffer_load_dwordx4 v4, s[12:15], s35 offen nt lds
  ds_read_b64_tr_b16 a[224:225], v5 offset:17024
  v_mfma_f32_16x16x32_bf16 v[204:207], a[232:235], v[24:27], v[204:207]
  ds_read_b64_tr_b16 a[226:227], v5 offset:17280
  v_mfma_f32_16x16x32_bf16 v[196:199], a[232:235], v[20:23], v[196:199]
  v_exp_f32 v65, v65
  v_mfma_f32_16x16x32_bf16 v[196:199], a[236:239], v[244:247], v[196:199]
  ds_read_b64_tr_b16 a[228:229], v5 offset:17536
  v_mfma_f32_16x16x32_bf16 v[188:191], a[236:239], v[240:243], v[188:191]
  ds_read_b64_tr_b16 a[230:231], v5 offset:17792
  v_mfma_f32_16x16x32_bf16 v[188:191], a[232:235], v[16:19], v[188:191]
  s_waitcnt lgkmcnt(8)
  v_mfma_f32_16x16x32_bf16 v[208:211], a[240:243], v[16:19], v[208:211]
  ds_read_b64_tr_b16 a[232:233], v5 offset:17056
  v_mfma_f32_16x16x32_bf16 v[208:211], a[244:247], v[240:243], v[208:211]
  ds_read_b64_tr_b16 a[234:235], v5 offset:17312
  v_mfma_f32_16x16x32_bf16 v[216:219], a[244:247], v[244:247], v[216:219]
  v_exp_f32 v66, v66
  v_mfma_f32_16x16x32_bf16 v[216:219], a[240:243], v[20:23], v[216:219]
  ds_read_b64_tr_b16 a[236:237], v5 offset:17568
  v_mfma_f32_16x16x32_bf16 v[224:227], a[240:243], v[24:27], v[224:227]
  ds_read_b64_tr_b16 a[238:239], v5 offset:17824
  v_mfma_f32_16x16x32_bf16 v[224:227], a[244:247], v[248:251], v[224:227]
  s_waitcnt vmcnt(5)
  s_add_u32 m0, s33, 53856
  s_add_u32 s35, s35, 0x1000
  s_waitcnt lgkmcnt(8)
  v_mfma_f32_16x16x32_bf16 v[228:231], a[252:255], v[248:251], v[228:231]
  buffer_load_dwordx4 v4, s[12:15], s35 offen nt lds
  ds_read_b64_tr_b16 a[240:241], v5 offset:17088
  v_mfma_f32_16x16x32_bf16 v[228:231], a[248:251], v[24:27], v[228:231]
  ds_read_b64_tr_b16 a[242:243], v5 offset:17344
  v_mfma_f32_16x16x32_bf16 v[220:223], a[248:251], v[20:23], v[220:223]
  v_exp_f32 v67, v67
  v_mfma_f32_16x16x32_bf16 v[220:223], a[252:255], v[244:247], v[220:223]
  ds_read_b64_tr_b16 a[244:245], v5 offset:17600
  v_mfma_f32_16x16x32_bf16 v[212:215], a[252:255], v[240:243], v[212:215]
  ds_read_b64_tr_b16 a[246:247], v5 offset:17856
  v_mfma_f32_16x16x32_bf16 v[212:215], a[248:251], v[16:19], v[212:215]
  s_waitcnt lgkmcnt(8)
  v_mfma_f32_16x16x32_bf16 v[232:235], a[224:227], v[16:19], v[232:235]
  ds_read_b64_tr_b16 a[248:249], v5 offset:17120
  v_mfma_f32_16x16x32_bf16 v[232:235], a[228:231], v[240:243], v[232:235]
  ds_read_b64_tr_b16 a[250:251], v5 offset:17376
  v_mfma_f32_16x16x32_bf16 a[96:99], a[228:231], v[244:247], a[96:99]
  v_exp_f32 v68, v68
  v_mfma_f32_16x16x32_bf16 a[96:99], a[224:227], v[20:23], a[96:99]
  ds_read_b64_tr_b16 a[252:253], v5 offset:17632
  v_mfma_f32_16x16x32_bf16 a[104:107], a[224:227], v[24:27], a[104:107]
  ds_read_b64_tr_b16 a[254:255], v5 offset:17888
  v_mfma_f32_16x16x32_bf16 a[104:107], a[228:231], v[248:251], a[104:107]
  s_waitcnt vmcnt(5)
  s_waitcnt lgkmcnt(8)
  v_mfma_f32_16x16x32_bf16 a[108:111], a[236:239], v[248:251], a[108:111]
  s_waitcnt vmcnt(5)
  s_barrier
  v_mfma_f32_16x16x32_bf16 a[108:111], a[232:235], v[24:27], a[108:111]
  ds_read_b128 a[224:227], v3 offset:33792
  v_mfma_f32_16x16x32_bf16 a[100:103], a[232:235], v[20:23], a[100:103]
  s_add_u32 m0, s33, 0
  s_add_u32 s34, s34, 0x1000
  v_mfma_f32_16x16x32_bf16 a[100:103], a[236:239], v[244:247], a[100:103]
  buffer_load_dwordx4 v1, s[8:11], s34 offen nt lds
  ds_read_b128 a[228:231], v3 offset:33856
  v_mfma_f32_16x16x32_bf16 v[236:239], a[236:239], v[240:243], v[236:239]
  v_exp_f32 v69, v69
  v_mfma_f32_16x16x32_bf16 v[236:239], a[232:235], v[16:19], v[236:239]
  s_waitcnt lgkmcnt(6)
  v_mfma_f32_16x16x32_bf16 a[112:115], a[240:243], v[16:19], a[112:115]
  ds_read_b128 a[232:235], v3 offset:33920
  v_mfma_f32_16x16x32_bf16 a[112:115], a[244:247], v[240:243], a[112:115]
  v_exp_f32 v70, v70
  v_mfma_f32_16x16x32_bf16 a[120:123], a[244:247], v[244:247], a[120:123]
  v_exp_f32 v71, v71
  v_mfma_f32_16x16x32_bf16 a[120:123], a[240:243], v[20:23], a[120:123]
  ds_read_b128 a[236:239], v3 offset:33984
  v_mfma_f32_16x16x32_bf16 a[128:131], a[240:243], v[24:27], a[128:131]
  v_exp_f32 v72, v72
  v_mfma_f32_16x16x32_bf16 a[128:131], a[244:247], v[248:251], a[128:131]
  s_waitcnt lgkmcnt(4)
  v_mfma_f32_16x16x32_bf16 a[132:135], a[252:255], v[248:251], a[132:135]
  ds_read_b128 a[240:243], v3 offset:34048
  v_mfma_f32_16x16x32_bf16 a[132:135], a[248:251], v[24:27], a[132:135]
  v_exp_f32 v73, v73
  v_mfma_f32_16x16x32_bf16 a[124:127], a[248:251], v[20:23], a[124:127]
  s_waitcnt vmcnt(5)
  s_add_u32 m0, s33, 1056
  s_add_u32 s34, s34, 0x1000
  v_mfma_f32_16x16x32_bf16 a[124:127], a[252:255], v[244:247], a[124:127]
  buffer_load_dwordx4 v1, s[8:11], s34 offen nt lds
  ds_read_b128 a[244:247], v3 offset:34112
  v_mfma_f32_16x16x32_bf16 a[116:119], a[252:255], v[240:243], a[116:119]
  v_mfma_f32_16x16x32_bf16 a[116:119], a[248:251], v[16:19], a[116:119]
  v_cvt_pk_bf16_f32 v16, v40, v41
  v_cvt_pk_bf16_f32 v17, v42, v43
  v_cvt_pk_bf16_f32 v20, v44, v45
  v_cvt_pk_bf16_f32 v21, v46, v47
  v_cvt_pk_bf16_f32 v24, v48, v49
  v_cvt_pk_bf16_f32 v25, v50, v51
  s_waitcnt lgkmcnt(4)
  v_mfma_f32_16x16x32_bf16 v[40:43], a[224:227], a[0:3], v[28:31]
  ds_read_b128 a[248:251], v3 offset:34176
  v_mfma_f32_16x16x32_bf16 v[40:43], a[228:231], a[12:15], v[40:43]
  v_cvt_pk_bf16_f32 v18, v52, v53
  v_cvt_pk_bf16_f32 v19, v54, v55
  v_mfma_f32_16x16x32_bf16 v[44:47], a[228:231], a[16:19], v[32:35]
  v_cvt_pk_bf16_f32 v22, v56, v57
  v_cvt_pk_bf16_f32 v23, v58, v59
  v_mfma_f32_16x16x32_bf16 v[44:47], a[224:227], a[4:7], v[44:47]
  ds_read_b128 a[252:255], v3 offset:34240
  v_cvt_pk_bf16_f32 v26, v60, v61
  v_mfma_f32_16x16x32_bf16 v[48:51], a[224:227], a[8:11], v[36:39]
  v_cvt_pk_bf16_f32 v27, v62, v63
  v_mfma_f32_16x16x32_bf16 v[48:51], a[228:231], a[20:23], v[48:51]
  v_exp_f32 v74, v74
  s_waitcnt lgkmcnt(4)
  v_mfma_f32_16x16x32_bf16 v[48:51], a[232:235], a[32:35], v[48:51]
  ds_read_b128 a[224:227], v3 offset:34688
  v_mfma_f32_16x16x32_bf16 v[48:51], a[236:239], a[44:47], v[48:51]
  v_exp_f32 v75, v75
  v_mfma_f32_16x16x32_bf16 v[44:47], a[236:239], a[40:43], v[44:47]
  s_waitcnt vmcnt(5)
  s_add_u32 m0, s33, 2112
  s_add_u32 s34, s34, 0x1000
  v_mfma_f32_16x16x32_bf16 v[44:47], a[232:235], a[28:31], v[44:47]
  buffer_load_dwordx4 v1, s[8:11], s34 offen nt lds
  ds_read_b128 a[228:231], v3 offset:34752
  v_mfma_f32_16x16x32_bf16 v[40:43], a[232:235], a[24:27], v[40:43]
  v_exp_f32 v76, v76
  v_mfma_f32_16x16x32_bf16 v[40:43], a[236:239], a[36:39], v[40:43]
  s_waitcnt lgkmcnt(4)
  v_mfma_f32_16x16x32_bf16 v[40:43], a[240:243], a[48:51], v[40:43]
  ds_read_b128 a[232:235], v3 offset:34560
  v_mfma_f32_16x16x32_bf16 v[40:43], a[244:247], a[60:63], v[40:43]
  v_exp_f32 v77, v77
  v_mfma_f32_16x16x32_bf16 v[44:47], a[244:247], a[64:67], v[44:47]
  v_exp_f32 v78, v78
  v_mfma_f32_16x16x32_bf16 v[44:47], a[240:243], a[52:55], v[44:47]
  ds_read_b128 a[236:239], v3 offset:34624
  v_exp_f32 v79, v79
  v_mfma_f32_16x16x32_bf16 v[48:51], a[240:243], a[56:59], v[48:51]
  v_exp_f32 v80, v80
  v_mfma_f32_16x16x32_bf16 v[48:51], a[244:247], a[68:71], v[48:51]
  s_waitcnt lgkmcnt(4)
  v_mfma_f32_16x16x32_bf16 v[48:51], a[248:251], a[80:83], v[48:51]
  ds_read_b128 a[240:243], v3 offset:34432
  v_exp_f32 v81, v81
  v_mfma_f32_16x16x32_bf16 v[48:51], a[252:255], a[92:95], v[48:51]
  v_exp_f32 v82, v82
  v_mfma_f32_16x16x32_bf16 v[44:47], a[252:255], a[88:91], v[44:47]
  s_waitcnt vmcnt(4)
  s_add_u32 m0, s33, 3168
  s_add_u32 s34, s34, 0x1000
  v_mfma_f32_16x16x32_bf16 v[44:47], a[248:251], a[76:79], v[44:47]
  buffer_load_dwordx4 v1, s[8:11], s34 offen nt lds
  ds_read_b128 a[244:247], v3 offset:34496
  v_mfma_f32_16x16x32_bf16 v[40:43], a[248:251], a[72:75], v[40:43]
  v_mfma_f32_16x16x32_bf16 v[40:43], a[252:255], a[84:87], v[40:43]
  v_exp_f32 v83, v83
  s_waitcnt lgkmcnt(4)
  v_mfma_f32_16x16x32_bf16 v[52:55], a[224:227], a[72:75], v[28:31]
  ds_read_b128 a[248:251], v3 offset:34304
  v_mfma_f32_16x16x32_bf16 v[52:55], a[228:231], a[84:87], v[52:55]
  v_exp_f32 v84, v84
  v_mfma_f32_16x16x32_bf16 v[56:59], a[228:231], a[88:91], v[32:35]
  v_exp_f32 v85, v85
  v_mfma_f32_16x16x32_bf16 v[56:59], a[224:227], a[76:79], v[56:59]
  ds_read_b128 a[252:255], v3 offset:34368
  v_exp_f32 v86, v86
  v_mfma_f32_16x16x32_bf16 v[60:63], a[224:227], a[80:83], v[36:39]
  v_exp_f32 v87, v87
  v_mfma_f32_16x16x32_bf16 v[60:63], a[228:231], a[92:95], v[60:63]
  v_cvt_pk_bf16_f32 v240, v64, v65
  s_waitcnt lgkmcnt(4)
  v_mfma_f32_16x16x32_bf16 v[60:63], a[232:235], a[56:59], v[60:63]
  s_waitcnt vmcnt(4)
  s_barrier
  v_mfma_f32_16x16x32_bf16 v[60:63], a[236:239], a[68:71], v[60:63]
  ds_read_b64_tr_b16 a[224:225], v5 offset:50688
  v_cvt_pk_bf16_f32 v241, v66, v67
  v_mfma_f32_16x16x32_bf16 v[56:59], a[236:239], a[64:67], v[56:59]
  s_waitcnt vmcnt(4)
  ds_read_b64_tr_b16 a[226:227], v5 offset:50944
  s_add_u32 m0, s33, 16896
  s_add_u32 s35, s35, 0xffffd100
  v_mfma_f32_16x16x32_bf16 v[56:59], a[232:235], a[52:55], v[56:59]
  buffer_load_dwordx4 v4, s[12:15], s35 offen nt lds
  ds_read_b64_tr_b16 a[228:229], v5 offset:51200
  v_mfma_f32_16x16x32_bf16 v[52:55], a[232:235], a[48:51], v[52:55]
  ds_read_b64_tr_b16 a[230:231], v5 offset:51456
  v_mfma_f32_16x16x32_bf16 v[52:55], a[236:239], a[60:63], v[52:55]
  v_cvt_pk_bf16_f32 v244, v68, v69
  s_waitcnt lgkmcnt(6)
  v_mfma_f32_16x16x32_bf16 v[52:55], a[240:243], a[24:27], v[52:55]
  ds_read_b64_tr_b16 a[232:233], v5 offset:50720
  v_mfma_f32_16x16x32_bf16 v[52:55], a[244:247], a[36:39], v[52:55]
  ds_read_b64_tr_b16 a[234:235], v5 offset:50976
  v_cvt_pk_bf16_f32 v245, v70, v71
  v_mfma_f32_16x16x32_bf16 v[56:59], a[244:247], a[40:43], v[56:59]
  v_cvt_pk_bf16_f32 v248, v72, v73
  v_cvt_pk_bf16_f32 v249, v74, v75
  v_mfma_f32_16x16x32_bf16 v[56:59], a[240:243], a[28:31], v[56:59]
  ds_read_b64_tr_b16 a[236:237], v5 offset:51232
  v_cvt_pk_bf16_f32 v242, v76, v77
  v_cvt_pk_bf16_f32 v243, v78, v79
  v_mfma_f32_16x16x32_bf16 v[60:63], a[240:243], a[32:35], v[60:63]
  ds_read_b64_tr_b16 a[238:239], v5 offset:51488
  v_cvt_pk_bf16_f32 v246, v80, v81
  v_mfma_f32_16x16x32_bf16 v[60:63], a[244:247], a[44:47], v[60:63]
  v_cvt_pk_bf16_f32 v247, v82, v83
  s_waitcnt lgkmcnt(8)
  v_mfma_f32_16x16x32_bf16 v[60:63], a[248:251], a[8:11], v[60:63]
  ds_read_b64_tr_b16 a[240:241], v5 offset:50752
  v_cvt_pk_bf16_f32 v250, v84, v85
  v_mfma_f32_16x16x32_bf16 v[60:63], a[252:255], a[20:23], v[60:63]
  ds_read_b64_tr_b16 a[242:243], v5 offset:51008
  v_cvt_pk_bf16_f32 v251, v86, v87
  v_mfma_f32_16x16x32_bf16 v[56:59], a[252:255], a[16:19], v[56:59]
  s_waitcnt vmcnt(4)
  s_add_u32 m0, s33, 17952
  s_add_u32 s35, s35, 0x1000
  v_mfma_f32_16x16x32_bf16 v[56:59], a[248:251], a[4:7], v[56:59]
  buffer_load_dwordx4 v4, s[12:15], s35 offen nt lds
  ds_read_b64_tr_b16 a[244:245], v5 offset:51264
  v_mfma_f32_16x16x32_bf16 v[52:55], a[248:251], a[0:3], v[52:55]
  ds_read_b64_tr_b16 a[246:247], v5 offset:51520
  v_mfma_f32_16x16x32_bf16 v[52:55], a[252:255], a[12:15], v[52:55]
  s_sub_u32 s39, s39, 1
  s_cmp_gt_u32 s39, 1
  s_cbranch_scc1 L_loop
L_loop_end:
  s_cmp_eq_u32 s39, 0
  s_cbranch_scc1 L_after_loop
  s_cmp_eq_u32 s32, 0
  s_cbranch_scc1 L_hop6
  s_cmp_eq_u32 s32, 1
  s_cbranch_scc1 L_hop7
  s_cmp_eq_u32 s32, 2
  s_cbranch_scc1 L_hop8
  s_cmp_eq_u32 s32, 3
  s_cbranch_scc1 L_hop9
L_walked1:
  s_branch L_loop
L_after_loop:
  s_mov_b32 s39, 200000
  v_mfma_f32_16x16x32_bf16 a[144:147], a[168:171], v[24:27], a[144:147]
  v_mfma_f32_16x16x32_bf16 a[140:143], a[168:171], v[20:23], a[140:143]
  v_exp_f32 v40, v40
  v_mfma_f32_16x16x32_bf16 a[136:139], a[168:171], v[16:19], a[136:139]
  s_waitcnt lgkmcnt(8)
  v_mfma_f32_16x16x32_bf16 v[88:91], a[224:227], v[16:19], v[88:91]
  ds_read_b64_tr_b16 a[248:249], v5 offset:50784
  v_mfma_f32_16x16x32_bf16 v[88:91], a[228:231], v[240:243], v[88:91]
  ds_read_b64_tr_b16 a[250:251], v5 offset:51040
  v_mfma_f32_16x16x32_bf16 v[96:99], a[228:231], v[244:247], v[96:99]
  v_exp_f32 v41, v41
  v_mfma_f32_16x16x32_bf16 v[96:99], a[224:227], v[20:23], v[96:99]
  ds_read_b64_tr_b16 a[252:253], v5 offset:51296
  v_mfma_f32_16x16x32_bf16 v[104:107], a[224:227], v[24:27], v[104:107]
  ds_read_b64_tr_b16 a[254:255], v5 offset:51552
  v_mfma_f32_16x16x32_bf16 v[104:107], a[228:231], v[248:251], v[104:107]
  s_waitcnt vmcnt(4)
  s_add_u32 m0, s33, 19008
  s_add_u32 s35, s35, 0x1000
  s_waitcnt lgkmcnt(8)
  v_mfma_f32_16x16x32_bf16 v[108:111], a[236:239], v[248:251], v[108:111]
  buffer_load_dwordx4 v4, s[12:15], s35 offen nt lds
  ds_read_b64_tr_b16 a[224:225], v5 offset:50816
  v_mfma_f32_16x16x32_bf16 v[108:111], a[232:235], v[24:27], v[108:111]
  ds_read_b64_tr_b16 a[226:227], v5 offset:51072
  v_mfma_f32_16x16x32_bf16 v[100:103], a[232:235], v[20:23], v[100:103]
  v_exp_f32 v42, v42
  v_mfma_f32_16x16x32_bf16 v[100:103], a[236:239], v[244:247], v[100:103]
  ds_read_b64_tr_b16 a[228:229], v5 offset:51328
  v_mfma_f32_16x16x32_bf16 v[92:95], a[236:239], v[240:243], v[92:95]
  ds_read_b64_tr_b16 a[230:231], v5 offset:51584
  v_mfma_f32_16x16x32_bf16 v[92:95], a[232:235], v[16:19], v[92:95]
  s_waitcnt lgkmcnt(8)
  v_mfma_f32_16x16x32_bf16 v[112:115], a[240:243], v[16:19], v[112:115]
  ds_read_b64_tr_b16 a[232:233], v5 offset:50848
  v_mfma_f32_16x16x32_bf16 v[112:115], a[244:247], v[240:243], v[112:115]
  ds_read_b64_tr_b16 a[234:235], v5 offset:51104
  v_mfma_f32_16x16x32_bf16 v[120:123], a[244:247], v[244:247], v[120:123]
  v_exp_f32 v43, v43
  v_mfma_f32_16x16x32_bf16 v[120:123], a[240:243], v[20:23], v[120:123]
  ds_read_b64_tr_b16 a[236:237], v5 offset:51360
  v_mfma_f32_16x16x32_bf16 v[128:131], a[240:243], v[24:27], v[128:131]
  ds_read_b64_tr_b16 a[238:239], v5 offset:51616
  v_mfma_f32_16x16x32_bf16 v[128:131], a[244:247], v[248:251], v[128:131]
  s_waitcnt vmcnt(4)
  s_add_u32 m0, s33, 20064
  s_add_u32 s35, s35, 0x1000
  s_waitcnt lgkmcnt(8)
  v_mfma_f32_16x16x32_bf16 v[132:135], a[252:255], v[248:251], v[132:135]
  buffer_load_dwordx4 v4, s[12:15], s35 offen nt lds
  ds_read_b64_tr_b16 a[240:241], v5 offset:50880
  v_mfma_f32_16x16x32_bf16 v[132:135], a[248:251], v[24:27], v[132:135]
  ds_read_b64_tr_b16 a[242:243], v5 offset:51136
  v_mfma_f32_16x16x32_bf16 v[124:127], a[248:251], v[20:23], v[124:127]
  v_exp_f32 v44, v44
  v_mfma_f32_16x16x32_bf16 v[124:127], a[252:255], v[244:247], v[124:127]
  ds_read_b64_tr_b16 a[244:245], v5 offset:51392
  v_mfma_f32_16x16x32_bf16 v[116:119], a[252:255], v[240:243], v[116:119]
  ds_read_b64_tr_b16 a[246:247], v5 offset:51648
  v_mfma_f32_16x16x32_bf16 v[116:119], a[248:251], v[16:19], v[116:119]
  s_waitcnt lgkmcnt(8)
  v_mfma_f32_16x16x32_bf16 v[136:139], a[224:227], v[16:19], v[136:139]
  ds_read_b64_tr_b16 a[248:249], v5 offset:50912
  v_mfma_f32_16x16x32_bf16 v[136:139], a[228:231], v[240:243], v[136:139]
  ds_read_b64_tr_b16 a[250:251], v5 offset:51168
  v_mfma_f32_16x16x32_bf16 v[144:147], a[228:231], v[244:247], v[144:147]
  v_exp_f32 v45, v45
  v_mfma_f32_16x16x32_bf16 v[144:147], a[224:227], v[20:23], v[144:147]
  ds_read_b64_tr_b16 a[252:253], v5 offset:51424
  v_mfma_f32_16x16x32_bf16 v[152:155], a[224:227], v[24:27], v[152:155]
  ds_read_b64_tr_b16 a[254:255], v5 offset:51680
  v_mfma_f32_16x16x32_bf16 v[152:155], a[228:231], v[248:251], v[152:155]
  s_waitcnt vmcnt(4)
  s_waitcnt lgkmcnt(8)
  v_mfma_f32_16x16x32_bf16 v[156:159], a[236:239], v[248:251], v[156:159]
  s_waitcnt vmcnt(4)
  s_barrier
  v_mfma_f32_16x16x32_bf16 v[156:159], a[232:235], v[24:27], v[156:159]
  ds_read_b128 a[224:227], v3 offset:0
  v_mfma_f32_16x16x32_bf16 v[148:151], a[232:235], v[20:23], v[148:151]
  s_add_u32 m0, s33, 33792
  s_add_u32 s35, s35, 0x4f00
  v_mfma_f32_16x16x32_bf16 v[148:151], a[236:239], v[244:247], v[148:151]
  buffer_load_dwordx4 v4, s[12:15], s35 offen nt lds
  ds_read_b128 a[228:231], v3 offset:64
  v_mfma_f32_16x16x32_bf16 v[140:143], a[236:239], v[240:243], v[140:143]
  v_exp_f32 v46, v46
  v_mfma_f32_16x16x32_bf16 v[140:143], a[232:235], v[16:19], v[140:143]
  s_waitcnt lgkmcnt(6)
  v_mfma_f32_16x16x32_bf16 v[160:163], a[240:243], v[16:19], v[160:163]
  ds_read_b128 a[232:235], v3 offset:128
  v_mfma_f32_16x16x32_bf16 v[160:163], a[244:247], v[240:243], v[160:163]
  v_exp_f32 v47, v47
  v_mfma_f32_16x16x32_bf16 v[168:171], a[244:247], v[244:247], v[168:171]
  s_add_u32 m0, s33, 34848
  s_add_u32 s35, s35, 0x1000
  v_mfma_f32_16x16x32_bf16 v[168:171], a[240:243], v[20:23], v[168:171]
  buffer_load_dwordx4 v4, s[12:15], s35 offen nt lds
  ds_read_b128 a[236:239], v3 offset:192
  v_mfma_f32_16x16x32_bf16 v[176:179], a[240:243], v[24:27], v[176:179]
  v_exp_f32 v48, v48
  v_mfma_f32_16x16x32_bf16 v[176:179], a[244:247], v[248:251], v[176:179]
  s_waitcnt lgkmcnt(4)
  v_mfma_f32_16x16x32_bf16 v[180:183], a[252:255], v[248:251], v[180:183]
  ds_read_b128 a[240:243], v3 offset:256
  v_mfma_f32_16x16x32_bf16 v[180:183], a[248:251], v[24:27], v[180:183]
  v_exp_f32 v49, v49
  v_mfma_f32_16x16x32_bf16 v[172:175], a[248:251], v[20:23], v[172:175]
  s_add_u32 m0, s33, 35904
  s_add_u32 s35, s35, 0x1000
  v_mfma_f32_16x16x32_bf16 v[172:175], a[252:255], v[244:247], v[172:175]
  buffer_load_dwordx4 v4, s[12:15], s35 offen nt lds
  ds_read_b128 a[244:247], v3 offset:320
  v_mfma_f32_16x16x32_bf16 v[164:167], a[252:255], v[240:243], v[164:167]
  v_mfma_f32_16x16x32_bf16 v[164:167], a[248:251], v[16:19], v[164:167]
  s_waitcnt lgkmcnt(4)
  v_mfma_f32_16x16x32_bf16 v[64:67], a[224:227], a[0:3], v[28:31]
  ds_read_b128 a[248:251], v3 offset:384
  v_mfma_f32_16x16x32_bf16 v[64:67], a[228:231], a[12:15], v[64:67]
  v_exp_f32 v50, v50
  v_mfma_f32_16x16x32_bf16 v[68:71], a[228:231], a[16:19], v[32:35]
  s_add_u32 m0, s33, 36960
  s_add_u32 s35, s35, 0x1000
  v_mfma_f32_16x16x32_bf16 v[68:71], a[224:227], a[4:7], v[68:71]
  buffer_load_dwordx4 v4, s[12:15], s35 offen nt lds
  ds_read_b128 a[252:255], v3 offset:448
  v_mfma_f32_16x16x32_bf16 v[72:75], a[224:227], a[8:11], v[36:39]
  buffer_load_dwordx2 v[14:15], off, s[48:51], 0 sc1
  v_mfma_f32_16x16x32_bf16 v[72:75], a[228:231], a[20:23], v[72:75]
  s_waitcnt lgkmcnt(4)
  v_mfma_f32_16x16x32_bf16 v[72:75], a[232:235], a[32:35], v[72:75]
  ds_read_b128 a[224:227], v3 offset:896
  v_mfma_f32_16x16x32_bf16 v[72:75], a[236:239], a[44:47], v[72:75]
  v_exp_f32 v51, v51
  v_mfma_f32_16x16x32_bf16 v[68:71], a[236:239], a[40:43], v[68:71]
  v_exp_f32 v52, v52
  v_mfma_f32_16x16x32_bf16 v[68:71], a[232:235], a[28:31], v[68:71]
  ds_read_b128 a[228:231], v3 offset:960
  v_mfma_f32_16x16x32_bf16 v[64:67], a[232:235], a[24:27], v[64:67]
  v_exp_f32 v53, v53
  v_mfma_f32_16x16x32_bf16 v[64:67], a[236:239], a[36:39], v[64:67]
  s_waitcnt lgkmcnt(4)
  v_mfma_f32_16x16x32_bf16 v[64:67], a[240:243], a[48:51], v[64:67]
  ds_read_b128 a[232:235], v3 offset:768
  v_mfma_f32_16x16x32_bf16 v[64:67], a[244:247], a[60:63], v[64:67]
  v_exp_f32 v54, v54
  v_mfma_f32_16x16x32_bf16 v[68:71], a[244:247], a[64:67], v[68:71]
  v_exp_f32 v55, v55
  v_mfma_f32_16x16x32_bf16 v[68:71], a[240:243], a[52:55], v[68:71]
  ds_read_b128 a[236:239], v3 offset:832
  v_mfma_f32_16x16x32_bf16 v[72:75], a[240:243], a[56:59], v[72:75]
  v_exp_f32 v56, v56
  v_mfma_f32_16x16x32_bf16 v[72:75], a[244:247], a[68:71], v[72:75]
  s_waitcnt lgkmcnt(4)
  v_mfma_f32_16x16x32_bf16 v[72:75], a[248:251], a[80:83], v[72:75]
  ds_read_b128 a[240:243], v3 offset:640
  v_mfma_f32_16x16x32_bf16 v[72:75], a[252:255], a[92:95], v[72:75]
  v_exp_f32 v57, v57
  v_mfma_f32_16x16x32_bf16 v[68:71], a[252:255], a[88:91], v[68:71]
  v_exp_f32 v58, v58
  v_mfma_f32_16x16x32_bf16 v[68:71], a[248:251], a[76:79], v[68:71]
  ds_read_b128 a[244:247], v3 offset:704
  v_mfma_f32_16x16x32_bf16 v[64:67], a[248:251], a[72:75], v[64:67]
  v_exp_f32 v59, v59
  v_mfma_f32_16x16x32_bf16 v[64:67], a[252:255], a[84:87], v[64:67]
  s_waitcnt lgkmcnt(4)
  v_mfma_f32_16x16x32_bf16 v[76:79], a[224:227], a[72:75], v[28:31]
  ds_read_b128 a[248:251], v3 offset:512
  v_mfma_f32_16x16x32_bf16 v[76:79], a[228:231], a[84:87], v[76:79]
  v_exp_f32 v60, v60
  v_mfma_f32_16x16x32_bf16 v[80:83], a[228:231], a[88:91], v[32:35]
  v_exp_f32 v61, v61
  v_mfma_f32_16x16x32_bf16 v[80:83], a[224:227], a[76:79], v[80:83]
  ds_read_b128 a[252:255], v3 offset:576
  v_exp_f32 v62, v62
  v_mfma_f32_16x16x32_bf16 v[84:87], a[224:227], a[80:83], v[36:39]
  v_exp_f32 v63, v63
  v_mfma_f32_16x16x32_bf16 v[84:87], a[228:231], a[92:95], v[84:87]
  s_waitcnt lgkmcnt(4)
  v_mfma_f32_16x16x32_bf16 v[84:87], a[232:235], a[56:59], v[84:87]
  s_branch L_page6
.p2align 12
L_hop6:
  s_branch L_hop10
  s_nop 0
L_page6:
  s_waitcnt vmcnt(5)
  s_barrier
  v_mfma_f32_16x16x32_bf16 v[84:87], a[236:239], a[68:71], v[84:87]
  ds_read_b64_tr_b16 a[224:225], v5 offset:16896
  v_mfma_f32_16x16x32_bf16 v[80:83], a[236:239], a[64:67], v[80:83]
  ds_read_b64_tr_b16 a[226:227], v5 offset:17152
  s_add_u32 m0, s33, 50688
  s_add_u32 s35, s35, 0xffffd100
  v_mfma_f32_16x16x32_bf16 v[80:83], a[232:235], a[52:55], v[80:83]
  buffer_load_dwordx4 v4, s[12:15], s35 offen nt lds
  ds_read_b64_tr_b16 a[228:229], v5 offset:17408
  v_mfma_f32_16x16x32_bf16 v[76:79], a[232:235], a[48:51], v[76:79]
  ds_read_b64_tr_b16 a[230:231], v5 offset:17664
  v_cvt_pk_bf16_f32 v28, v40, v41
  v_mfma_f32_16x16x32_bf16 v[76:79], a[236:239], a[60:63], v[76:79]
  v_cvt_pk_bf16_f32 v29, v42, v43
  s_waitcnt lgkmcnt(6)
  v_mfma_f32_16x16x32_bf16 v[76:79], a[240:243], a[24:27], v[76:79]
  ds_read_b64_tr_b16 a[232:233], v5 offset:16928
  v_cvt_pk_bf16_f32 v32, v44, v45
  v_mfma_f32_16x16x32_bf16 v[76:79], a[244:247], a[36:39], v[76:79]
  ds_read_b64_tr_b16 a[234:235], v5 offset:17184
  v_cvt_pk_bf16_f32 v33, v46, v47
  v_mfma_f32_16x16x32_bf16 v[80:83], a[244:247], a[40:43], v[80:83]
  s_add_u32 m0, s33, 51744
  s_add_u32 s35, s35, 0x1000
  v_cvt_pk_bf16_f32 v36, v48, v49
  v_mfma_f32_16x16x32_bf16 v[80:83], a[240:243], a[28:31], v[80:83]
  buffer_load_dwordx4 v4, s[12:15], s35 offen nt lds
  ds_read_b64_tr_b16 a[236:237], v5 offset:17440
  v_mfma_f32_16x16x32_bf16 v[84:87], a[240:243], a[32:35], v[84:87]
  ds_read_b64_tr_b16 a[238:239], v5 offset:17696
  v_cvt_pk_bf16_f32 v37, v50, v51
  v_mfma_f32_16x16x32_bf16 v[84:87], a[244:247], a[44:47], v[84:87]
  v_cvt_pk_bf16_f32 v30, v52, v53
  s_waitcnt lgkmcnt(8)
  v_mfma_f32_16x16x32_bf16 v[84:87], a[248:251], a[8:11], v[84:87]
  ds_read_b64_tr_b16 a[240:241], v5 offset:16960
  v_cvt_pk_bf16_f32 v31, v54, v55
  v_mfma_f32_16x16x32_bf16 v[84:87], a[252:255], a[20:23], v[84:87]
  ds_read_b64_tr_b16 a[242:243], v5 offset:17216
  v_cvt_pk_bf16_f32 v34, v56, v57
  v_mfma_f32_16x16x32_bf16 v[80:83], a[252:255], a[16:19], v[80:83]
  s_add_u32 m0, s33, 52800
  s_add_u32 s35, s35, 0x1000
  v_cvt_pk_bf16_f32 v35, v58, v59
  v_mfma_f32_16x16x32_bf16 v[80:83], a[248:251], a[4:7], v[80:83]
  buffer_load_dwordx4 v4, s[12:15], s35 offen nt lds
  ds_read_b64_tr_b16 a[244:245], v5 offset:17472
  v_mfma_f32_16x16x32_bf16 v[76:79], a[248:251], a[0:3], v[76:79]
  ds_read_b64_tr_b16 a[246:247], v5 offset:17728
  v_cvt_pk_bf16_f32 v38, v60, v61
  v_mfma_f32_16x16x32_bf16 v[76:79], a[252:255], a[12:15], v[76:79]
  v_cvt_pk_bf16_f32 v39, v62, v63
  v_mfma_f32_16x16x32_bf16 a[144:147], a[168:171], v[248:251], a[144:147]
  v_exp_f32 v64, v64
  v_mfma_f32_16x16x32_bf16 a[140:143], a[168:171], v[244:247], a[140:143]
  v_exp_f32 v65, v65
  v_mfma_f32_16x16x32_bf16 a[136:139], a[168:171], v[240:243], a[136:139]
  s_add_u32 m0, s33, 53856
  s_add_u32 s35, s35, 0x1000
  s_waitcnt lgkmcnt(8)
  v_mfma_f32_16x16x32_bf16 v[184:187], a[224:227], v[16:19], v[184:187]
  buffer_load_dwordx4 v4, s[12:15], s35 offen nt lds
  ds_read_b64_tr_b16 a[248:249], v5 offset:16992
  v_mfma_f32_16x16x32_bf16 v[184:187], a[228:231], v[240:243], v[184:187]
  ds_read_b64_tr_b16 a[250:251], v5 offset:17248
  v_mfma_f32_16x16x32_bf16 v[192:195], a[228:231], v[244:247], v[192:195]
  v_exp_f32 v66, v66
  v_mfma_f32_16x16x32_bf16 v[192:195], a[224:227], v[20:23], v[192:195]
  ds_read_b64_tr_b16 a[252:253], v5 offset:17504
  v_exp_f32 v67, v67
  v_mfma_f32_16x16x32_bf16 v[200:203], a[224:227], v[24:27], v[200:203]
  ds_read_b64_tr_b16 a[254:255], v5 offset:17760
  v_mfma_f32_16x16x32_bf16 v[200:203], a[228:231], v[248:251], v[200:203]
  v_exp_f32 v68, v68
  s_waitcnt lgkmcnt(8)
  v_mfma_f32_16x16x32_bf16 v[204:207], a[236:239], v[248:251], v[204:207]
  ds_read_b64_tr_b16 a[224:225], v5 offset:17024
  v_mfma_f32_16x16x32_bf16 v[204:207], a[232:235], v[24:27], v[204:207]
  ds_read_b64_tr_b16 a[226:227], v5 offset:17280
  v_exp_f32 v69, v69
  v_mfma_f32_16x16x32_bf16 v[196:199], a[232:235], v[20:23], v[196:199]
  v_exp_f32 v70, v70
  v_mfma_f32_16x16x32_bf16 v[196:199], a[236:239], v[244:247], v[196:199]
  ds_read_b64_tr_b16 a[228:229], v5 offset:17536
  v_mfma_f32_16x16x32_bf16 v[188:191], a[236:239], v[240:243], v[188:191]
  ds_read_b64_tr_b16 a[230:231], v5 offset:17792
  v_exp_f32 v71, v71
  v_mfma_f32_16x16x32_bf16 v[188:191], a[232:235], v[16:19], v[188:191]
  s_waitcnt lgkmcnt(8)
  v_mfma_f32_16x16x32_bf16 v[208:211], a[240:243], v[16:19], v[208:211]
  ds_read_b64_tr_b16 a[232:233], v5 offset:17056
  v_exp_f32 v72, v72
  v_mfma_f32_16x16x32_bf16 v[208:211], a[244:247], v[240:243], v[208:211]
  ds_read_b64_tr_b16 a[234:235], v5 offset:17312
  v_mfma_f32_16x16x32_bf16 v[216:219], a[244:247], v[244:247], v[216:219]
  v_exp_f32 v73, v73
  v_mfma_f32_16x16x32_bf16 v[216:219], a[240:243], v[20:23], v[216:219]
  ds_read_b64_tr_b16 a[236:237], v5 offset:17568
  v_exp_f32 v74, v74
  v_mfma_f32_16x16x32_bf16 v[224:227], a[240:243], v[24:27], v[224:227]
  ds_read_b64_tr_b16 a[238:239], v5 offset:17824
  v_mfma_f32_16x16x32_bf16 v[224:227], a[244:247], v[248:251], v[224:227]
  v_exp_f32 v75, v75
  s_waitcnt lgkmcnt(8)
  v_mfma_f32_16x16x32_bf16 v[228:231], a[252:255], v[248:251], v[228:231]
  ds_read_b64_tr_b16 a[240:241], v5 offset:17088
  v_mfma_f32_16x16x32_bf16 v[228:231], a[248:251], v[24:27], v[228:231]
  ds_read_b64_tr_b16 a[242:243], v5 offset:17344
  v_exp_f32 v76, v76
  v_mfma_f32_16x16x32_bf16 v[220:223], a[248:251], v[20:23], v[220:223]
  v_exp_f32 v77, v77
  v_mfma_f32_16x16x32_bf16 v[220:223], a[252:255], v[244:247], v[220:223]
  ds_read_b64_tr_b16 a[244:245], v5 offset:17600
  v_exp_f32 v78, v78
  v_mfma_f32_16x16x32_bf16 v[212:215], a[252:255], v[240:243], v[212:215]
  ds_read_b64_tr_b16 a[246:247], v5 offset:17856
  v_mfma_f32_16x16x32_bf16 v[212:215], a[248:251], v[16:19], v[212:215]
  v_exp_f32 v79, v79
  s_waitcnt lgkmcnt(8)
  v_mfma_f32_16x16x32_bf16 v[232:235], a[224:227], v[16:19], v[232:235]
  ds_read_b64_tr_b16 a[248:249], v5 offset:17120
  v_exp_f32 v80, v80
  v_mfma_f32_16x16x32_bf16 v[232:235], a[228:231], v[240:243], v[232:235]
  ds_read_b64_tr_b16 a[250:251], v5 offset:17376
  v_mfma_f32_16x16x32_bf16 a[96:99], a[228:231], v[244:247], a[96:99]
  v_exp_f32 v81, v81
  v_mfma_f32_16x16x32_bf16 a[96:99], a[224:227], v[20:23], a[96:99]
  ds_read_b64_tr_b16 a[252:253], v5 offset:17632
  v_exp_f32 v82, v82
  v_mfma_f32_16x16x32_bf16 a[104:107], a[224:227], v[24:27], a[104:107]
  ds_read_b64_tr_b16 a[254:255], v5 offset:17888
  v_exp_f32 v83, v83
  v_mfma_f32_16x16x32_bf16 a[104:107], a[228:231], v[248:251], a[104:107]
  s_waitcnt lgkmcnt(8)
  v_mfma_f32_16x16x32_bf16 a[108:111], a[236:239], v[248:251], a[108:111]
  s_waitcnt vmcnt(5)
  s_barrier
  v_mfma_f32_16x16x32_bf16 a[108:111], a[232:235], v[24:27], a[108:111]
  ds_read_b64_tr_b16 a[224:225], v5 offset:33792
  v_exp_f32 v84, v84
  v_mfma_f32_16x16x32_bf16 a[100:103], a[232:235], v[20:23], a[100:103]
  ds_read_b64_tr_b16 a[226:227], v5 offset:34048
  s_add_u32 m0, s33, 0
  s_mov_b32 s71, 114944
  v_mfma_f32_16x16x32_bf16 a[100:103], a[236:239], v[244:247], a[100:103]
  buffer_load_dwordx4 v2, s[20:23], s71 offen offset:0 lds
  ds_read_b64_tr_b16 a[228:229], v5 offset:34304
  v_mfma_f32_16x16x32_bf16 v[236:239], a[236:239], v[240:243], v[236:239]
  ds_read_b64_tr_b16 a[230:231], v5 offset:34560
  v_exp_f32 v85, v85
  v_mfma_f32_16x16x32_bf16 v[236:239], a[232:235], v[16:19], v[236:239]
  v_exp_f32 v86, v86
  s_waitcnt lgkmcnt(8)
  v_mfma_f32_16x16x32_bf16 a[112:115], a[240:243], v[16:19], a[112:115]
  ds_read_b64_tr_b16 a[232:233], v5 offset:33824
  v_mfma_f32_16x16x32_bf16 a[112:115], a[244:247], v[240:243], a[112:115]
  ds_read_b64_tr_b16 a[234:235], v5 offset:34080
  v_exp_f32 v87, v87
  v_mfma_f32_16x16x32_bf16 a[120:123], a[244:247], v[244:247], a[120:123]
  s_add_u32 m0, s33, 160
  v_cvt_pk_bf16_f32 v40, v64, v65
  v_cvt_pk_bf16_f32 v41, v66, v67
  v_mfma_f32_16x16x32_bf16 a[120:123], a[240:243], v[20:23], a[120:123]
  buffer_load_dwordx4 v2, s[20:23], s71 offen offset:896 lds
  ds_read_b64_tr_b16 a[236:237], v5 offset:34336
  v_cvt_pk_bf16_f32 v44, v68, v69
  v_mfma_f32_16x16x32_bf16 a[128:131], a[240:243], v[24:27], a[128:131]
  ds_read_b64_tr_b16 a[238:239], v5 offset:34592
  v_cvt_pk_bf16_f32 v45, v70, v71
  v_mfma_f32_16x16x32_bf16 a[128:131], a[244:247], v[248:251], a[128:131]
  v_cvt_pk_bf16_f32 v48, v72, v73
  v_cvt_pk_bf16_f32 v49, v74, v75
  s_waitcnt lgkmcnt(8)
  v_mfma_f32_16x16x32_bf16 a[132:135], a[252:255], v[248:251], a[132:135]
  ds_read_b64_tr_b16 a[240:241], v5 offset:33856
  v_cvt_pk_bf16_f32 v42, v76, v77
  v_cvt_pk_bf16_f32 v43, v78, v79
  v_mfma_f32_16x16x32_bf16 a[132:135], a[248:251], v[24:27], a[132:135]
  ds_read_b64_tr_b16 a[242:243], v5 offset:34112
  v_cvt_pk_bf16_f32 v46, v80, v81
  v_cvt_pk_bf16_f32 v47, v82, v83
  v_mfma_f32_16x16x32_bf16 a[124:127], a[248:251], v[20:23], a[124:127]
  s_add_u32 m0, s33, 320
  v_cvt_pk_bf16_f32 v50, v84, v85
  v_mfma_f32_16x16x32_bf16 a[124:127], a[252:255], v[244:247], a[124:127]
  buffer_load_dwordx4 v2, s[20:23], s71 offen offset:1792 lds
  ds_read_b64_tr_b16 a[244:245], v5 offset:34368
  v_cvt_pk_bf16_f32 v51, v86, v87
  v_mfma_f32_16x16x32_bf16 a[116:119], a[252:255], v[240:243], a[116:119]
  ds_read_b64_tr_b16 a[246:247], v5 offset:34624
  v_mfma_f32_16x16x32_bf16 a[116:119], a[248:251], v[16:19], a[116:119]
  v_mfma_f32_16x16x32_bf16 a[144:147], a[168:171], v[36:39], a[144:147]
  s_waitcnt vmcnt(7)
  v_readfirstlane_b32 s60, v14
  v_mfma_f32_16x16x32_bf16 a[144:147], a[168:171], v[48:51], a[144:147]
  v_readfirstlane_b32 s61, v15
  v_mfma_f32_16x16x32_bf16 a[140:143], a[168:171], v[32:35], a[140:143]
  s_add_u32 m0, s33, 480
  v_mfma_f32_16x16x32_bf16 a[140:143], a[168:171], v[44:47], a[140:143]
  buffer_load_dwordx4 v2, s[20:23], s71 offen offset:2688 lds
  v_mfma_f32_16x16x32_bf16 a[136:139], a[168:171], v[28:31], a[136:139]
  v_mfma_f32_16x16x32_bf16 a[136:139], a[168:171], v[40:43], a[136:139]
  s_waitcnt lgkmcnt(8)
  v_mfma_f32_16x16x32_bf16 v[88:91], a[224:227], v[28:31], v[88:91]
  ds_read_b64_tr_b16 a[248:249], v5 offset:33888
  v_mfma_f32_16x16x32_bf16 v[88:91], a[228:231], v[40:43], v[88:91]
  ds_read_b64_tr_b16 a[250:251], v5 offset:34144
  v_mfma_f32_16x16x32_bf16 v[96:99], a[228:231], v[44:47], v[96:99]
  v_mfma_f32_16x16x32_bf16 v[96:99], a[224:227], v[32:35], v[96:99]
  ds_read_b64_tr_b16 a[252:253], v5 offset:34400
  v_mfma_f32_16x16x32_bf16 v[104:107], a[224:227], v[36:39], v[104:107]
  ds_read_b64_tr_b16 a[254:255], v5 offset:34656
  v_accvgpr_read_b32 v10, a136
  v_accvgpr_read_b32 v11, a140
  v_mfma_f32_16x16x32_bf16 v[104:107], a[228:231], v[48:51], v[104:107]
  v_accvgpr_read_b32 v12, a144
  s_waitcnt lgkmcnt(8)
  v_mfma_f32_16x16x32_bf16 v[108:111], a[236:239], v[48:51], v[108:111]
  ds_read_b64_tr_b16 a[224:225], v5 offset:33920
  v_max3_f32 v3, v10, v11, v12
  v_mfma_f32_16x16x32_bf16 v[108:111], a[232:235], v[36:39], v[108:111]
  ds_read_b64_tr_b16 a[226:227], v5 offset:34176
  v_mfma_f32_16x16x32_bf16 v[100:103], a[232:235], v[32:35], v[100:103]
  v_rcp_f32 v13, v10
  v_mfma_f32_16x16x32_bf16 v[100:103], a[236:239], v[44:47], v[100:103]
  ds_read_b64_tr_b16 a[228:229], v5 offset:34432
  v_rcp_f32 v14, v11
  v_mfma_f32_16x16x32_bf16 v[92:95], a[236:239], v[40:43], v[92:95]
  ds_read_b64_tr_b16 a[230:231], v5 offset:34688
  v_mfma_f32_16x16x32_bf16 v[92:95], a[232:235], v[28:31], v[92:95]
  v_rcp_f32 v15, v12
  s_waitcnt lgkmcnt(8)
  v_mfma_f32_16x16x32_bf16 v[112:115], a[240:243], v[28:31], v[112:115]
  ds_read_b64_tr_b16 a[232:233], v5 offset:33952
  v_cmp_nge_f32 vcc, s38, v3
  v_mfma_f32_16x16x32_bf16 v[112:115], a[244:247], v[40:43], v[112:115]
  ds_read_b64_tr_b16 a[234:235], v5 offset:34208
  s_cbranch_vccnz L_unsafe
L_unsafe_back:
  v_mfma_f32_16x16x32_bf16 v[120:123], a[244:247], v[44:47], v[120:123]
  v_mfma_f32_16x16x32_bf16 v[120:123], a[240:243], v[32:35], v[120:123]
  ds_read_b64_tr_b16 a[236:237], v5 offset:34464
  v_mul_f32 v88, v88, v13
  v_mul_f32 v89, v89, v13
  v_mfma_f32_16x16x32_bf16 v[128:131], a[240:243], v[36:39], v[128:131]
  ds_read_b64_tr_b16 a[238:239], v5 offset:34720
  v_mul_f32 v90, v90, v13
  v_mfma_f32_16x16x32_bf16 v[128:131], a[244:247], v[48:51], v[128:131]
  v_mul_f32 v91, v91, v13
  s_waitcnt lgkmcnt(8)
  v_mfma_f32_16x16x32_bf16 v[132:135], a[252:255], v[48:51], v[132:135]
  ds_read_b64_tr_b16 a[240:241], v5 offset:33984
  v_mul_f32 v92, v92, v13
  v_mfma_f32_16x16x32_bf16 v[132:135], a[248:251], v[36:39], v[132:135]
  ds_read_b64_tr_b16 a[242:243], v5 offset:34240
  v_mul_f32 v93, v93, v13
  v_mul_f32 v94, v94, v13
  v_mfma_f32_16x16x32_bf16 v[124:127], a[248:251], v[32:35], v[124:127]
  v_mul_f32 v95, v95, v13
  v_cvt_pk_bf16_f32 v88, v88, v89
  v_mfma_f32_16x16x32_bf16 v[124:127], a[252:255], v[44:47], v[124:127]
  ds_read_b64_tr_b16 a[244:245], v5 offset:34496
  v_cvt_pk_bf16_f32 v89, v90, v91
  v_mfma_f32_16x16x32_bf16 v[116:119], a[252:255], v[40:43], v[116:119]
  ds_read_b64_tr_b16 a[246:247], v5 offset:34752
  v_cvt_pk_bf16_f32 v90, v92, v93
  v_mfma_f32_16x16x32_bf16 v[116:119], a[248:251], v[28:31], v[116:119]
  v_cvt_pk_bf16_f32 v91, v94, v95
  s_waitcnt lgkmcnt(8)
  v_mfma_f32_16x16x32_bf16 v[136:139], a[224:227], v[28:31], v[136:139]
  ds_read_b64_tr_b16 a[248:249], v5 offset:34016
  v_mul_f32 v96, v96, v14
  v_mfma_f32_16x16x32_bf16 v[136:139], a[228:231], v[40:43], v[136:139]
  ds_read_b64_tr_b16 a[250:251], v5 offset:34272
  v_mul_f32 v97, v97, v14
  v_mul_f32 v98, v98, v14
  v_mfma_f32_16x16x32_bf16 v[144:147], a[228:231], v[44:47], v[144:147]
  v_mul_f32 v99, v99, v14
  v_mul_f32 v100, v100, v14
  v_mfma_f32_16x16x32_bf16 v[144:147], a[224:227], v[32:35], v[144:147]
  ds_read_b64_tr_b16 a[252:253], v5 offset:34528
  v_mul_f32 v101, v101, v14
  v_mfma_f32_16x16x32_bf16 v[152:155], a[224:227], v[36:39], v[152:155]
  ds_read_b64_tr_b16 a[254:255], v5 offset:34784
  v_mul_f32 v102, v102, v14
  v_mfma_f32_16x16x32_bf16 v[152:155], a[228:231], v[48:51], v[152:155]
  v_mul_f32 v103, v103, v14
  s_waitcnt lgkmcnt(8)
  v_mfma_f32_16x16x32_bf16 v[156:159], a[236:239], v[48:51], v[156:159]
  s_waitcnt vmcnt(4)
  s_barrier
  v_cvt_pk_bf16_f32 v92, v96, v97
  v_mfma_f32_16x16x32_bf16 v[156:159], a[232:235], v[36:39], v[156:159]
  ds_read_b64_tr_b16 a[224:225], v5 offset:50688
  v_cvt_pk_bf16_f32 v93, v98, v99
  v_mfma_f32_16x16x32_bf16 v[148:151], a[232:235], v[32:35], v[148:151]
  ds_read_b64_tr_b16 a[226:227], v5 offset:50944
  s_add_u32 m0, s33, 16896
  s_mov_b32 s71, 384
  v_mfma_f32_16x16x32_bf16 v[148:151], a[236:239], v[44:47], v[148:151]
  buffer_load_dwordx4 v2, s[20:23], s71 offen offset:0 lds
  ds_read_b64_tr_b16 a[228:229], v5 offset:51200
  v_mfma_f32_16x16x32_bf16 v[140:143], a[236:239], v[40:43], v[140:143]
  ds_read_b64_tr_b16 a[230:231], v5 offset:51456
  v_mfma_f32_16x16x32_bf16 v[140:143], a[232:235], v[28:31], v[140:143]
  v_cvt_pk_bf16_f32 v94, v100, v101
  v_cvt_pk_bf16_f32 v95, v102, v103
  s_waitcnt lgkmcnt(8)
  v_mfma_f32_16x16x32_bf16 v[160:163], a[240:243], v[28:31], v[160:163]
  ds_read_b64_tr_b16 a[232:233], v5 offset:50720
  v_mul_f32 v104, v104, v15
  v_mfma_f32_16x16x32_bf16 v[160:163], a[244:247], v[40:43], v[160:163]
  ds_read_b64_tr_b16 a[234:235], v5 offset:50976
  v_mul_f32 v105, v105, v15
  v_mfma_f32_16x16x32_bf16 v[168:171], a[244:247], v[44:47], v[168:171]
  s_add_u32 m0, s33, 17056
  v_mul_f32 v106, v106, v15
  v_mfma_f32_16x16x32_bf16 v[168:171], a[240:243], v[32:35], v[168:171]
  buffer_load_dwordx4 v2, s[20:23], s71 offen offset:896 lds
  ds_read_b64_tr_b16 a[236:237], v5 offset:51232
  v_mfma_f32_16x16x32_bf16 v[176:179], a[240:243], v[36:39], v[176:179]
  ds_read_b64_tr_b16 a[238:239], v5 offset:51488
  v_mul_f32 v107, v107, v15
  v_mul_f32 v108, v108, v15
  v_mfma_f32_16x16x32_bf16 v[176:179], a[244:247], v[48:51], v[176:179]
  v_mul_f32 v109, v109, v15
  s_waitcnt lgkmcnt(8)
  v_mfma_f32_16x16x32_bf16 v[180:183], a[252:255], v[48:51], v[180:183]
  ds_read_b64_tr_b16 a[240:241], v5 offset:50752
  v_mul_f32 v110, v110, v15
  v_mfma_f32_16x16x32_bf16 v[180:183], a[248:251], v[36:39], v[180:183]
  ds_read_b64_tr_b16 a[242:243], v5 offset:51008
  v_mul_f32 v111, v111, v15
  v_mfma_f32_16x16x32_bf16 v[172:175], a[248:251], v[32:35], v[172:175]
  s_add_u32 m0, s33, 17216
  v_cvt_pk_bf16_f32 v96, v104, v105
  v_mfma_f32_16x16x32_bf16 v[172:175], a[252:255], v[44:47], v[172:175]
  buffer_load_dwordx4 v2, s[20:23], s71 offen offset:1792 lds
  ds_read_b64_tr_b16 a[244:245], v5 offset:51264
  v_cvt_pk_bf16_f32 v97, v106, v107
  v_mfma_f32_16x16x32_bf16 v[164:167], a[252:255], v[40:43], v[164:167]
  ds_read_b64_tr_b16 a[246:247], v5 offset:51520
  v_cvt_pk_bf16_f32 v98, v108, v109
  v_mfma_f32_16x16x32_bf16 v[164:167], a[248:251], v[28:31], v[164:167]
  v_cvt_pk_bf16_f32 v99, v110, v111
  s_waitcnt lgkmcnt(8)
  v_mfma_f32_16x16x32_bf16 v[184:187], a[224:227], v[28:31], v[184:187]
  ds_read_b64_tr_b16 a[248:249], v5 offset:50784
  v_mfma_f32_16x16x32_bf16 v[184:187], a[228:231], v[40:43], v[184:187]
  ds_read_b64_tr_b16 a[250:251], v5 offset:51040
  v_mfma_f32_16x16x32_bf16 v[192:195], a[228:231], v[44:47], v[192:195]
  s_add_u32 m0, s33, 17376
  v_mfma_f32_16x16x32_bf16 v[192:195], a[224:227], v[32:35], v[192:195]
  buffer_load_dwordx4 v2, s[20:23], s71 offen offset:2688 lds
  ds_read_b64_tr_b16 a[252:253], v5 offset:51296
  v_mfma_f32_16x16x32_bf16 v[200:203], a[224:227], v[36:39], v[200:203]
  ds_read_b64_tr_b16 a[254:255], v5 offset:51552
  v_mul_f32 v112, v112, v13
  v_mul_f32 v113, v113, v13
  v_mfma_f32_16x16x32_bf16 v[200:203], a[228:231], v[48:51], v[200:203]
  v_mul_f32 v114, v114, v13
  v_mul_f32 v115, v115, v13
  s_waitcnt lgkmcnt(8)
  v_mfma_f32_16x16x32_bf16 v[204:207], a[236:239], v[48:51], v[204:207]
  ds_read_b64_tr_b16 a[224:225], v5 offset:50816
  v_mul_f32 v116, v116, v13
  v_mul_f32 v117, v117, v13
  v_mfma_f32_16x16x32_bf16 v[204:207], a[232:235], v[36:39], v[204:207]
  ds_read_b64_tr_b16 a[226:227], v5 offset:51072
  v_mul_f32 v118, v118, v13
  v_mul_f32 v119, v119, v13
  v_mfma_f32_16x16x32_bf16 v[196:199], a[232:235], v[32:35], v[196:199]
  s_add_u32 s58, s69, 0
  buffer_load_dword a182, v9, s[40:43], s58 offen
  v_cvt_pk_bf16_f32 v100, v112, v113
  v_mfma_f32_16x16x32_bf16 v[196:199], a[236:239], v[44:47], v[196:199]
  ds_read_b64_tr_b16 a[228:229], v5 offset:51328
  buffer_load_dword a182, v9, s[44:47], 0 offen sc1
  v_cvt_pk_bf16_f32 v101, v114, v115
  v_mfma_f32_16x16x32_bf16 v[188:191], a[236:239], v[40:43], v[188:191]
  ds_read_b64_tr_b16 a[230:231], v5 offset:51584
  v_cvt_pk_bf16_f32 v102, v116, v117
  v_cvt_pk_bf16_f32 v103, v118, v119
  v_mfma_f32_16x16x32_bf16 v[188:191], a[232:235], v[28:31], v[188:191]
  v_mul_f32 v120, v120, v14
  v_mul_f32 v121, v121, v14
  s_waitcnt lgkmcnt(8)
  v_mfma_f32_16x16x32_bf16 v[208:211], a[240:243], v[28:31], v[208:211]
  ds_read_b64_tr_b16 a[232:233], v5 offset:50848
  v_mul_f32 v122, v122, v14
  v_mul_f32 v123, v123, v14
  v_mfma_f32_16x16x32_bf16 v[208:211], a[244:247], v[40:43], v[208:211]
  ds_read_b64_tr_b16 a[234:235], v5 offset:51104
  v_mul_f32 v124, v124, v14
  v_mfma_f32_16x16x32_bf16 v[216:219], a[244:247], v[44:47], v[216:219]
  v_mul_f32 v125, v125, v14
  v_mul_f32 v126, v126, v14
  v_mul_f32 v127, v127, v14
  v_mfma_f32_16x16x32_bf16 v[216:219], a[240:243], v[32:35], v[216:219]
  ds_read_b64_tr_b16 a[236:237], v5 offset:51360
  v_cvt_pk_bf16_f32 v104, v120, v121
  v_cvt_pk_bf16_f32 v105, v122, v123
  v_mfma_f32_16x16x32_bf16 v[224:227], a[240:243], v[36:39], v[224:227]
  ds_read_b64_tr_b16 a[238:239], v5 offset:51616
  v_cvt_pk_bf16_f32 v106, v124, v125
  v_cvt_pk_bf16_f32 v107, v126, v127
  v_mfma_f32_16x16x32_bf16 v[224:227], a[244:247], v[48:51], v[224:227]
  v_mul_f32 v128, v128, v15
  v_mul_f32 v129, v129, v15
  s_waitcnt lgkmcnt(8)
  v_mfma_f32_16x16x32_bf16 v[228:231], a[252:255], v[48:51], v[228:231]
  ds_read_b64_tr_b16 a[240:241], v5 offset:50880
  v_mul_f32 v130, v130, v15
  v_mul_f32 v131, v131, v15
  v_mfma_f32_16x16x32_bf16 v[228:231], a[248:251], v[36:39], v[228:231]
  ds_read_b64_tr_b16 a[242:243], v5 offset:51136
  v_mul_f32 v132, v132, v15
  v_mul_f32 v133, v133, v15
  v_mfma_f32_16x16x32_bf16 v[220:223], a[248:251], v[32:35], v[220:223]
  v_mul_f32 v134, v134, v15
  v_mul_f32 v135, v135, v15
  v_cvt_pk_bf16_f32 v108, v128, v129
  v_mfma_f32_16x16x32_bf16 v[220:223], a[252:255], v[44:47], v[220:223]
  ds_read_b64_tr_b16 a[244:245], v5 offset:51392
  v_cvt_pk_bf16_f32 v109, v130, v131
  v_cvt_pk_bf16_f32 v110, v132, v133
  v_mfma_f32_16x16x32_bf16 v[212:215], a[252:255], v[40:43], v[212:215]
  ds_read_b64_tr_b16 a[246:247], v5 offset:51648
  v_cvt_pk_bf16_f32 v111, v134, v135
  v_mfma_f32_16x16x32_bf16 v[212:215], a[248:251], v[28:31], v[212:215]
  v_mul_f32 v136, v136, v13
  v_mul_f32 v137, v137, v13
  s_waitcnt lgkmcnt(8)
  v_mfma_f32_16x16x32_bf16 v[232:235], a[224:227], v[28:31], v[232:235]
  ds_read_b64_tr_b16 a[248:249], v5 offset:50912
  v_mul_f32 v138, v138, v13
  v_mul_f32 v139, v139, v13
  v_mfma_f32_16x16x32_bf16 v[232:235], a[228:231], v[40:43], v[232:235]
  ds_read_b64_tr_b16 a[250:251], v5 offset:51168
  v_mul_f32 v140, v140, v13
  v_mul_f32 v141, v141, v13
  v_mfma_f32_16x16x32_bf16 a[96:99], a[228:231], v[44:47], a[96:99]
  v_mul_f32 v142, v142, v13
  v_mul_f32 v143, v143, v13
  v_cvt_pk_bf16_f32 v112, v136, v137
  v_mfma_f32_16x16x32_bf16 a[96:99], a[224:227], v[32:35], a[96:99]
  ds_read_b64_tr_b16 a[252:253], v5 offset:51424
  v_cvt_pk_bf16_f32 v113, v138, v139
  v_cvt_pk_bf16_f32 v114, v140, v141
  v_mfma_f32_16x16x32_bf16 a[104:107], a[224:227], v[36:39], a[104:107]
  ds_read_b64_tr_b16 a[254:255], v5 offset:51680
  v_cvt_pk_bf16_f32 v115, v142, v143
  v_mul_f32 v144, v144, v14
  v_mfma_f32_16x16x32_bf16 a[104:107], a[228:231], v[48:51], a[104:107]
  v_mul_f32 v145, v145, v14
  v_mul_f32 v146, v146, v14
  s_waitcnt lgkmcnt(8)
  v_mfma_f32_16x16x32_bf16 a[108:111], a[236:239], v[48:51], a[108:111]
  s_waitcnt vmcnt(63)
  s_barrier
  v_mov_b32 v0, 152064
  ds_read_b32 v0, v0
  v_mfma_f32_16x16x32_bf16 a[108:111], a[232:235], v[36:39], a[108:111]
  v_add_u32 v6, 67584, v5
  ds_read_b64_tr_b16 a[224:225], v6 offset:0
  v_mfma_f32_16x16x32_bf16 a[100:103], a[232:235], v[32:35], a[100:103]
  ds_read_b64_tr_b16 a[226:227], v6 offset:128
  s_add_u32 m0, s33, 33792
  s_mov_b32 s71, 115072
  v_mfma_f32_16x16x32_bf16 a[100:103], a[236:239], v[44:47], a[100:103]
  buffer_load_dwordx4 v2, s[20:23], s71 offen offset:0 lds
  ds_read_b64_tr_b16 a[228:229], v6 offset:256
  v_mfma_f32_16x16x32_bf16 v[236:239], a[236:239], v[40:43], v[236:239]
  ds_read_b64_tr_b16 a[230:231], v6 offset:384
  v_mul_f32 v147, v147, v14
  v_mul_f32 v148, v148, v14
  v_mfma_f32_16x16x32_bf16 v[236:239], a[232:235], v[28:31], v[236:239]
  v_mul_f32 v149, v149, v14
  v_mul_f32 v150, v150, v14
  s_waitcnt lgkmcnt(9)
  v_mfma_f32_16x16x32_bf16 a[112:115], a[240:243], v[28:31], a[112:115]
  ds_read_b64_tr_b16 a[232:233], v6 offset:32
  v_mul_f32 v151, v151, v14
  v_cvt_pk_bf16_f32 v116, v144, v145
  v_mfma_f32_16x16x32_bf16 a[112:115], a[244:247], v[40:43], a[112:115]
  ds_read_b64_tr_b16 a[234:235], v6 offset:160
  v_cvt_pk_bf16_f32 v117, v146, v147
  v_cvt_pk_bf16_f32 v118, v148, v149
  v_mfma_f32_16x16x32_bf16 a[120:123], a[244:247], v[44:47], a[120:123]
  s_add_u32 m0, s33, 33952
  v_cvt_pk_bf16_f32 v119, v150, v151
  v_mul_f32 v152, v152, v15
  v_mfma_f32_16x16x32_bf16 a[120:123], a[240:243], v[32:35], a[120:123]
  buffer_load_dwordx4 v2, s[20:23], s71 offen offset:896 lds
  ds_read_b64_tr_b16 a[236:237], v6 offset:288
  v_mfma_f32_16x16x32_bf16 a[128:131], a[240:243], v[36:39], a[128:131]
  ds_read_b64_tr_b16 a[238:239], v6 offset:416
  v_mul_f32 v153, v153, v15
  v_mul_f32 v154, v154, v15
  v_mfma_f32_16x16x32_bf16 a[128:131], a[244:247], v[48:51], a[128:131]
  v_mul_f32 v155, v155, v15
  v_mul_f32 v156, v156, v15
  s_waitcnt lgkmcnt(9)
  v_mfma_f32_16x16x32_bf16 a[132:135], a[252:255], v[48:51], a[132:135]
  ds_read_b64_tr_b16 a[240:241], v6 offset:64
  v_mul_f32 v157, v157, v15
  v_mul_f32 v158, v158, v15
  v_mfma_f32_16x16x32_bf16 a[132:135], a[248:251], v[36:39], a[132:135]
  ds_read_b64_tr_b16 a[242:243], v6 offset:192
  v_mul_f32 v159, v159, v15
  v_cvt_pk_bf16_f32 v120, v152, v153
  v_mfma_f32_16x16x32_bf16 a[124:127], a[248:251], v[32:35], a[124:127]
  s_add_u32 m0, s33, 34112
  v_cvt_pk_bf16_f32 v121, v154, v155
  v_cvt_pk_bf16_f32 v122, v156, v157
  v_mfma_f32_16x16x32_bf16 a[124:127], a[252:255], v[44:47], a[124:127]
  buffer_load_dwordx4 v2, s[20:23], s71 offen offset:1792 lds
  ds_read_b64_tr_b16 a[244:245], v6 offset:320
  v_cvt_pk_bf16_f32 v123, v158, v159
  v_mfma_f32_16x16x32_bf16 a[116:119], a[252:255], v[40:43], a[116:119]
  ds_read_b64_tr_b16 a[246:247], v6 offset:448
  v_mfma_f32_16x16x32_bf16 a[116:119], a[248:251], v[28:31], a[116:119]
  s_waitcnt lgkmcnt(12)
  v_cmp_lt_u32 vcc, s53, v0
  s_cbranch_vccnz L_fallback
  s_waitcnt lgkmcnt(8)
  v_mfma_f32_16x16x32_bf16 v[40:43], a[224:227], v[88:91], 0
  ds_read_b64_tr_b16 a[248:249], v6 offset:96
  v_accvgpr_read_b32 v28, a192
  v_accvgpr_read_b32 v29, a193
  v_mfma_f32_16x16x32_bf16 v[40:43], a[228:231], v[100:103], v[40:43]
  ds_read_b64_tr_b16 a[250:251], v6 offset:224
  v_accvgpr_read_b32 v30, a194
  v_accvgpr_read_b32 v31, a195
  v_accvgpr_read_b32 v32, a196
  v_mfma_f32_16x16x32_bf16 v[44:47], a[228:231], v[104:107], 0
  s_add_u32 m0, s33, 34272
  v_mfma_f32_16x16x32_bf16 v[44:47], a[224:227], v[92:95], v[44:47]
  buffer_load_dwordx4 v2, s[20:23], s71 offen offset:2688 lds
  ds_read_b64_tr_b16 a[252:253], v6 offset:352
  v_mfma_f32_16x16x32_bf16 v[48:51], a[224:227], v[96:99], 0
  ds_read_b64_tr_b16 a[254:255], v6 offset:480
  v_mul_f32 v160, v160, v13
  v_mul_f32 v161, v161, v13
  v_mul_f32 v162, v162, v13
  v_mfma_f32_16x16x32_bf16 v[48:51], a[228:231], v[108:111], v[48:51]
  v_mul_f32 v163, v163, v13
  v_mul_f32 v164, v164, v13
  v_mul_f32 v165, v165, v13
  s_waitcnt lgkmcnt(8)
  v_mfma_f32_16x16x32_bf16 v[60:63], a[236:239], v[108:111], 0
  ds_read_b64_tr_b16 a[224:225], v6 offset:512
  v_mul_f32 v166, v166, v13
  v_mul_f32 v167, v167, v13
  v_mfma_f32_16x16x32_bf16 v[60:63], a[232:235], v[96:99], v[60:63]
  ds_read_b64_tr_b16 a[226:227], v6 offset:640
  v_cvt_pk_bf16_f32 v124, v160, v161
  v_cvt_pk_bf16_f32 v125, v162, v163
  v_cvt_pk_bf16_f32 v126, v164, v165
  v_mfma_f32_16x16x32_bf16 v[56:59], a[232:235], v[92:95], 0
  v_cvt_pk_bf16_f32 v127, v166, v167
  v_mul_f32 v168, v168, v14
  v_mul_f32 v169, v169, v14
  v_mul_f32 v170, v170, v14
  v_mfma_f32_16x16x32_bf16 v[56:59], a[236:239], v[104:107], v[56:59]
  ds_read_b64_tr_b16 a[228:229], v6 offset:768
  v_mul_f32 v171, v171, v14
  v_mul_f32 v172, v172, v14
  v_mfma_f32_16x16x32_bf16 v[52:55], a[236:239], v[100:103], 0
  ds_read_b64_tr_b16 a[230:231], v6 offset:896
  v_mul_f32 v173, v173, v14
  v_mul_f32 v174, v174, v14
  v_mul_f32 v175, v175, v14
  v_mfma_f32_16x16x32_bf16 v[52:55], a[232:235], v[88:91], v[52:55]
  v_cvt_pk_bf16_f32 v128, v168, v169
  v_cvt_pk_bf16_f32 v129, v170, v171
  v_cvt_pk_bf16_f32 v130, v172, v173
  s_waitcnt lgkmcnt(8)
  v_mfma_f32_16x16x32_bf16 v[64:67], a[240:243], v[88:91], 0
  ds_read_b64_tr_b16 a[232:233], v6 offset:544
  v_cvt_pk_bf16_f32 v131, v174, v175
  v_mul_f32 v176, v176, v15
  v_mfma_f32_16x16x32_bf16 v[64:67], a[244:247], v[100:103], v[64:67]
  ds_read_b64_tr_b16 a[234:235], v6 offset:672
  v_mul_f32 v177, v177, v15
  v_mul_f32 v178, v178, v15
  v_mul_f32 v179, v179, v15
  v_mfma_f32_16x16x32_bf16 v[68:71], a[244:247], v[104:107], 0
  v_mul_f32 v180, v180, v15
  v_mul_f32 v181, v181, v15
  v_mul_f32 v182, v182, v15
  v_mfma_f32_16x16x32_bf16 v[68:71], a[240:243], v[92:95], v[68:71]
  s_branch L_page7
.p2align 12
L_hop7:
  s_branch L_walked1
  s_nop 0
L_page7:
  ds_read_b64_tr_b16 a[236:237], v6 offset:800
  v_mul_f32 v183, v183, v15
  v_cvt_pk_bf16_f32 v132, v176, v177
  v_cvt_pk_bf16_f32 v133, v178, v179
  v_mfma_f32_16x16x32_bf16 v[72:75], a[240:243], v[96:99], 0
  ds_read_b64_tr_b16 a[238:239], v6 offset:928
  v_cvt_pk_bf16_f32 v134, v180, v181
  v_cvt_pk_bf16_f32 v135, v182, v183
  v_mul_f32 v184, v184, v13
  v_mfma_f32_16x16x32_bf16 v[72:75], a[244:247], v[108:111], v[72:75]
  v_mul_f32 v185, v185, v13
  v_mul_f32 v186, v186, v13
  s_waitcnt lgkmcnt(8)
  v_mfma_f32_16x16x32_bf16 v[84:87], a[252:255], v[108:111], 0
  ds_read_b64_tr_b16 a[240:241], v6 offset:576
  v_mul_f32 v187, v187, v13
  v_mul_f32 v188, v188, v13
  v_mul_f32 v189, v189, v13
  v_mfma_f32_16x16x32_bf16 v[84:87], a[248:251], v[96:99], v[84:87]
  ds_read_b64_tr_b16 a[242:243], v6 offset:704
  v_mul_f32 v190, v190, v13
  v_mul_f32 v191, v191, v13
  v_cvt_pk_bf16_f32 v136, v184, v185
  v_mfma_f32_16x16x32_bf16 v[80:83], a[248:251], v[92:95], 0
  v_cvt_pk_bf16_f32 v137, v186, v187
  v_cvt_pk_bf16_f32 v138, v188, v189
  v_cvt_pk_bf16_f32 v139, v190, v191
  v_mfma_f32_16x16x32_bf16 v[80:83], a[252:255], v[104:107], v[80:83]
  ds_read_b64_tr_b16 a[244:245], v6 offset:832
  v_mul_f32 v192, v192, v14
  v_mul_f32 v193, v193, v14
  v_mul_f32 v194, v194, v14
  v_mfma_f32_16x16x32_bf16 v[76:79], a[252:255], v[100:103], 0
  ds_read_b64_tr_b16 a[246:247], v6 offset:960
  v_mul_f32 v195, v195, v14
  v_mul_f32 v196, v196, v14
  v_mfma_f32_16x16x32_bf16 v[76:79], a[248:251], v[88:91], v[76:79]
  v_mul_f32 v197, v197, v14
  v_mul_f32 v198, v198, v14
  v_mul_f32 v199, v199, v14
  s_waitcnt lgkmcnt(8)
  v_mfma_f32_16x16x32_bf16 v[40:43], a[224:227], v[112:115], v[40:43]
  ds_read_b64_tr_b16 a[248:249], v6 offset:608
  v_cvt_pk_bf16_f32 v140, v192, v193
  v_cvt_pk_bf16_f32 v141, v194, v195
  v_cvt_pk_bf16_f32 v142, v196, v197
  v_mfma_f32_16x16x32_bf16 v[40:43], a[228:231], v[124:127], v[40:43]
  ds_read_b64_tr_b16 a[250:251], v6 offset:736
  v_cvt_pk_bf16_f32 v143, v198, v199
  v_mul_f32 v200, v200, v15
  v_mfma_f32_16x16x32_bf16 v[44:47], a[228:231], v[128:131], v[44:47]
  v_mul_f32 v201, v201, v15
  v_mul_f32 v202, v202, v15
  v_mul_f32 v203, v203, v15
  v_mul_f32 v204, v204, v15
  v_mfma_f32_16x16x32_bf16 v[44:47], a[224:227], v[116:119], v[44:47]
  ds_read_b64_tr_b16 a[252:253], v6 offset:864
  v_mul_f32 v205, v205, v15
  v_mul_f32 v206, v206, v15
  v_mul_f32 v207, v207, v15
  v_mfma_f32_16x16x32_bf16 v[48:51], a[224:227], v[120:123], v[48:51]
  ds_read_b64_tr_b16 a[254:255], v6 offset:992
  v_cvt_pk_bf16_f32 v144, v200, v201
  v_cvt_pk_bf16_f32 v145, v202, v203
  v_mfma_f32_16x16x32_bf16 v[48:51], a[228:231], v[132:135], v[48:51]
  v_cvt_pk_bf16_f32 v146, v204, v205
  v_cvt_pk_bf16_f32 v147, v206, v207
  v_mul_f32 v208, v208, v13
  s_waitcnt lgkmcnt(8)
  v_mfma_f32_16x16x32_bf16 v[60:63], a[236:239], v[132:135], v[60:63]
  s_waitcnt vmcnt(63)
  s_barrier
  v_mul_f32 v209, v209, v13
  v_mul_f32 v210, v210, v13
  v_mfma_f32_16x16x32_bf16 v[60:63], a[232:235], v[120:123], v[60:63]
  v_add_u32 v6, 135168, v5
  ds_read_b64_tr_b16 a[224:225], v6 offset:0
  v_mul_f32 v211, v211, v13
  v_mfma_f32_16x16x32_bf16 v[56:59], a[232:235], v[116:119], v[56:59]
  ds_read_b64_tr_b16 a[226:227], v6 offset:128
  s_add_u32 m0, s33, 50688
  s_mov_b32 s71, 512
  v_mul_f32 v212, v212, v13
  v_mfma_f32_16x16x32_bf16 v[56:59], a[236:239], v[128:131], v[56:59]
  buffer_load_dwordx4 v2, s[20:23], s71 offen offset:0 lds
  ds_read_b64_tr_b16 a[228:229], v6 offset:256
  v_mul_f32 v213, v213, v13
  v_mfma_f32_16x16x32_bf16 v[52:55], a[236:239], v[124:127], v[52:55]
  ds_read_b64_tr_b16 a[230:231], v6 offset:384
  v_mul_f32 v214, v214, v13
  v_mul_f32 v215, v215, v13
  v_cvt_pk_bf16_f32 v148, v208, v209
  v_mfma_f32_16x16x32_bf16 v[52:55], a[232:235], v[112:115], v[52:55]
  v_cvt_pk_bf16_f32 v149, v210, v211
  v_cvt_pk_bf16_f32 v150, v212, v213
  v_cvt_pk_bf16_f32 v151, v214, v215
  s_waitcnt lgkmcnt(8)
  v_mfma_f32_16x16x32_bf16 v[64:67], a[240:243], v[112:115], v[64:67]
  ds_read_b64_tr_b16 a[232:233], v6 offset:32
  v_mul_f32 v216, v216, v14
  v_mul_f32 v217, v217, v14
  v_mfma_f32_16x16x32_bf16 v[64:67], a[244:247], v[124:127], v[64:67]
  ds_read_b64_tr_b16 a[234:235], v6 offset:160
  v_mul_f32 v218, v218, v14
  v_mul_f32 v219, v219, v14
  v_mul_f32 v220, v220, v14
  v_mfma_f32_16x16x32_bf16 v[68:71], a[244:247], v[128:131], v[68:71]
  s_add_u32 m0, s33, 50848
  v_mul_f32 v221, v221, v14
  v_mul_f32 v222, v222, v14
  v_mul_f32 v223, v223, v14
  v_mfma_f32_16x16x32_bf16 v[68:71], a[240:243], v[116:119], v[68:71]
  buffer_load_dwordx4 v2, s[20:23], s71 offen offset:896 lds
  ds_read_b64_tr_b16 a[236:237], v6 offset:288
  v_cvt_pk_bf16_f32 v152, v216, v217
  v_mfma_f32_16x16x32_bf16 v[72:75], a[240:243], v[120:123], v[72:75]
  ds_read_b64_tr_b16 a[238:239], v6 offset:416
  v_cvt_pk_bf16_f32 v153, v218, v219
  v_cvt_pk_bf16_f32 v154, v220, v221
  v_cvt_pk_bf16_f32 v155, v222, v223
  v_mfma_f32_16x16x32_bf16 v[72:75], a[244:247], v[132:135], v[72:75]
  v_mul_f32 v224, v224, v15
  v_mul_f32 v225, v225, v15
  s_waitcnt lgkmcnt(8)
  v_mfma_f32_16x16x32_bf16 v[84:87], a[252:255], v[132:135], v[84:87]
  ds_read_b64_tr_b16 a[240:241], v6 offset:64
  v_mul_f32 v226, v226, v15
  v_mul_f32 v227, v227, v15
  v_mul_f32 v228, v228, v15
  v_mfma_f32_16x16x32_bf16 v[84:87], a[248:251], v[120:123], v[84:87]
  ds_read_b64_tr_b16 a[242:243], v6 offset:192
  v_mul_f32 v229, v229, v15
  v_mul_f32 v230, v230, v15
  v_mul_f32 v231, v231, v15
  v_mfma_f32_16x16x32_bf16 v[80:83], a[248:251], v[116:119], v[80:83]
  s_add_u32 m0, s33, 51008
  v_cvt_pk_bf16_f32 v156, v224, v225
  v_cvt_pk_bf16_f32 v157, v226, v227
  v_mfma_f32_16x16x32_bf16 v[80:83], a[252:255], v[128:131], v[80:83]
  buffer_load_dwordx4 v2, s[20:23], s71 offen offset:1792 lds
  ds_read_b64_tr_b16 a[244:245], v6 offset:320
  v_cvt_pk_bf16_f32 v158, v228, v229
  v_cvt_pk_bf16_f32 v159, v230, v231
  v_mfma_f32_16x16x32_bf16 v[76:79], a[252:255], v[124:127], v[76:79]
  ds_read_b64_tr_b16 a[246:247], v6 offset:448
  v_mfma_f32_16x16x32_bf16 v[76:79], a[248:251], v[112:115], v[76:79]
L_regchk:
  s_lshr_b64 s[62:63], s[60:61], s59
  s_and_b32 s62, s62, 0xff
  s_cmp_ge_u32 s62, 16
  s_cbranch_scc0 L_notlocal
  s_waitcnt lgkmcnt(8)
  v_mfma_f32_16x16x32_bf16 v[40:43], a[224:227], v[136:139], v[40:43]
  ds_read_b64_tr_b16 a[248:249], v6 offset:96
  v_mul_f32 v232, v232, v13
  v_mul_f32 v233, v233, v13
  v_mul_f32 v234, v234, v13
  v_mul_f32 v235, v235, v13
  v_mul_f32 v236, v236, v13
  v_mfma_f32_16x16x32_bf16 v[40:43], a[228:231], v[148:151], v[40:43]
  ds_read_b64_tr_b16 a[250:251], v6 offset:224
  v_mul_f32 v237, v237, v13
  v_mul_f32 v238, v238, v13
  v_mul_f32 v239, v239, v13
  v_cvt_pk_bf16_f32 v160, v232, v233
  v_cvt_pk_bf16_f32 v161, v234, v235
  v_mfma_f32_16x16x32_bf16 v[44:47], a[228:231], v[152:155], v[44:47]
  s_add_u32 m0, s33, 51168
  v_cvt_pk_bf16_f32 v162, v236, v237
  v_cvt_pk_bf16_f32 v163, v238, v239
  v_accvgpr_read_b32 v240, a96
  v_accvgpr_read_b32 v241, a97
  v_accvgpr_read_b32 v242, a98
  v_mfma_f32_16x16x32_bf16 v[44:47], a[224:227], v[140:143], v[44:47]
  buffer_load_dwordx4 v2, s[20:23], s71 offen offset:2688 lds
  ds_read_b64_tr_b16 a[252:253], v6 offset:352
  v_accvgpr_read_b32 v243, a99
  v_mul_f32 v240, v240, v14
  v_mul_f32 v241, v241, v14
  v_mul_f32 v242, v242, v14
  v_mfma_f32_16x16x32_bf16 v[48:51], a[224:227], v[144:147], v[48:51]
  ds_read_b64_tr_b16 a[254:255], v6 offset:480
  v_mul_f32 v243, v243, v14
  v_accvgpr_read_b32 v244, a100
  v_accvgpr_read_b32 v245, a101
  v_accvgpr_read_b32 v246, a102
  v_accvgpr_read_b32 v247, a103
  v_mfma_f32_16x16x32_bf16 v[48:51], a[228:231], v[156:159], v[48:51]
  v_mul_f32 v244, v244, v14
  v_mul_f32 v245, v245, v14
  v_mul_f32 v246, v246, v14
  v_mul_f32 v247, v247, v14
  v_cvt_pk_bf16_f32 v164, v240, v241
  s_waitcnt lgkmcnt(8)
  v_mfma_f32_16x16x32_bf16 v[60:63], a[236:239], v[156:159], v[60:63]
  ds_read_b64_tr_b16 a[224:225], v6 offset:512
  v_cvt_pk_bf16_f32 v165, v242, v243
  v_cvt_pk_bf16_f32 v166, v244, v245
  v_cvt_pk_bf16_f32 v167, v246, v247
  v_accvgpr_read_b32 v248, a104
  v_accvgpr_read_b32 v249, a105
  v_mfma_f32_16x16x32_bf16 v[60:63], a[232:235], v[144:147], v[60:63]
  ds_read_b64_tr_b16 a[226:227], v6 offset:640
  v_accvgpr_read_b32 v250, a106
  v_accvgpr_read_b32 v251, a107
  v_mul_f32 v248, v248, v15
  v_mul_f32 v249, v249, v15
  v_mul_f32 v250, v250, v15
  v_mfma_f32_16x16x32_bf16 v[56:59], a[232:235], v[140:143], v[56:59]
  s_add_u32 s58, s69, 393216
  buffer_load_dword a182, v9, s[40:43], s58 offen
  v_mul_f32 v251, v251, v15
  v_accvgpr_read_b32 v252, a108
  v_accvgpr_read_b32 v253, a109
  v_accvgpr_read_b32 v254, a110
  v_accvgpr_read_b32 v255, a111
  v_mfma_f32_16x16x32_bf16 v[56:59], a[236:239], v[152:155], v[56:59]
  ds_read_b64_tr_b16 a[228:229], v6 offset:768
  v_mul_f32 v252, v252, v15
  v_mul_f32 v253, v253, v15
  v_mul_f32 v254, v254, v15
  v_mul_f32 v255, v255, v15
  v_cvt_pk_bf16_f32 v168, v248, v249
  v_mfma_f32_16x16x32_bf16 v[52:55], a[236:239], v[148:151], v[52:55]
  ds_read_b64_tr_b16 a[230:231], v6 offset:896
  v_cvt_pk_bf16_f32 v169, v250, v251
  v_cvt_pk_bf16_f32 v170, v252, v253
  v_cvt_pk_bf16_f32 v171, v254, v255
  v_accvgpr_read_b32 v232, a112
  v_accvgpr_read_b32 v233, a113
  v_mfma_f32_16x16x32_bf16 v[52:55], a[232:235], v[136:139], v[52:55]
  v_accvgpr_read_b32 v234, a114
  v_accvgpr_read_b32 v235, a115
  v_mul_f32 v232, v232, v13
  v_mul_f32 v233, v233, v13
  v_mul_f32 v234, v234, v13
  s_waitcnt lgkmcnt(8)
  v_mfma_f32_16x16x32_bf16 v[64:67], a[240:243], v[136:139], v[64:67]
  ds_read_b64_tr_b16 a[232:233], v6 offset:544
  v_mul_f32 v235, v235, v13
  v_accvgpr_read_b32 v236, a116
  v_accvgpr_read_b32 v237, a117
  v_accvgpr_read_b32 v238, a118
  v_accvgpr_read_b32 v239, a119
  v_mfma_f32_16x16x32_bf16 v[64:67], a[244:247], v[148:151], v[64:67]
  ds_read_b64_tr_b16 a[234:235], v6 offset:672
  v_mul_f32 v236, v236, v13
  v_mul_f32 v237, v237, v13
  v_mul_f32 v238, v238, v13
  v_mul_f32 v239, v239, v13
  v_cvt_pk_bf16_f32 v172, v232, v233
  v_mfma_f32_16x16x32_bf16 v[68:71], a[244:247], v[152:155], v[68:71]
  v_cvt_pk_bf16_f32 v173, v234, v235
  v_cvt_pk_bf16_f32 v174, v236, v237
  v_cvt_pk_bf16_f32 v175, v238, v239
  v_accvgpr_read_b32 v240, a120
  v_accvgpr_read_b32 v241, a121
  v_accvgpr_read_b32 v242, a122
  v_mfma_f32_16x16x32_bf16 v[68:71], a[240:243], v[140:143], v[68:71]
  ds_read_b64_tr_b16 a[236:237], v6 offset:800
  v_accvgpr_read_b32 v243, a123
  v_mul_f32 v240, v240, v14
  v_mul_f32 v241, v241, v14
  v_mul_f32 v242, v242, v14
  v_mul_f32 v243, v243, v14
  v_mfma_f32_16x16x32_bf16 v[72:75], a[240:243], v[144:147], v[72:75]
  ds_read_b64_tr_b16 a[238:239], v6 offset:928
  v_accvgpr_read_b32 v244, a124
  v_accvgpr_read_b32 v245, a125
  v_accvgpr_read_b32 v246, a126
  v_accvgpr_read_b32 v247, a127
  v_mul_f32 v244, v244, v14
  v_mfma_f32_16x16x32_bf16 v[72:75], a[244:247], v[156:159], v[72:75]
  v_mul_f32 v245, v245, v14
  v_mul_f32 v246, v246, v14
  v_mul_f32 v247, v247, v14
  v_cvt_pk_bf16_f32 v176, v240, v241
  v_cvt_pk_bf16_f32 v177, v242, v243
  v_cvt_pk_bf16_f32 v178, v244, v245
  s_waitcnt lgkmcnt(8)
  v_mfma_f32_16x16x32_bf16 v[84:87], a[252:255], v[156:159], v[84:87]
  ds_read_b64_tr_b16 a[240:241], v6 offset:576
  v_cvt_pk_bf16_f32 v179, v246, v247
  v_accvgpr_read_b32 v248, a128
  v_accvgpr_read_b32 v249, a129
  v_accvgpr_read_b32 v250, a130
  v_accvgpr_read_b32 v251, a131
  v_mfma_f32_16x16x32_bf16 v[84:87], a[248:251], v[144:147], v[84:87]
  ds_read_b64_tr_b16 a[242:243], v6 offset:704
  v_mul_f32 v248, v248, v15
  v_mul_f32 v249, v249, v15
  v_mul_f32 v250, v250, v15
  v_mul_f32 v251, v251, v15
  v_accvgpr_read_b32 v252, a132
  v_mfma_f32_16x16x32_bf16 v[80:83], a[248:251], v[140:143], v[80:83]
  v_accvgpr_read_b32 v253, a133
  v_accvgpr_read_b32 v254, a134
  v_accvgpr_read_b32 v255, a135
  v_mul_f32 v252, v252, v15
  v_mul_f32 v253, v253, v15
  v_mul_f32 v254, v254, v15
  v_mfma_f32_16x16x32_bf16 v[80:83], a[252:255], v[152:155], v[80:83]
  ds_read_b64_tr_b16 a[244:245], v6 offset:832
  v_mul_f32 v255, v255, v15
  v_cvt_pk_bf16_f32 v180, v248, v249
  v_cvt_pk_bf16_f32 v181, v250, v251
  v_cvt_pk_bf16_f32 v182, v252, v253
  v_cvt_pk_bf16_f32 v183, v254, v255
  v_mfma_f32_16x16x32_bf16 v[76:79], a[252:255], v[148:151], v[76:79]
  ds_read_b64_tr_b16 a[246:247], v6 offset:960
  v_mfma_f32_16x16x32_bf16 v[76:79], a[248:251], v[136:139], v[76:79]
  s_waitcnt lgkmcnt(8)
  v_mfma_f32_16x16x32_bf16 v[40:43], a[224:227], v[160:163], v[40:43]
  ds_read_b64_tr_b16 a[248:249], v6 offset:608
  v_mfma_f32_16x16x32_bf16 v[40:43], a[228:231], v[172:175], v[40:43]
  ds_read_b64_tr_b16 a[250:251], v6 offset:736
  v_mfma_f32_16x16x32_bf16 v[44:47], a[228:231], v[176:179], v[44:47]
  v_mfma_f32_16x16x32_bf16 v[44:47], a[224:227], v[164:167], v[44:47]
  ds_read_b64_tr_b16 a[252:253], v6 offset:864
  v_mfma_f32_16x16x32_bf16 v[48:51], a[224:227], v[168:171], v[48:51]
  ds_read_b64_tr_b16 a[254:255], v6 offset:992
  v_mfma_f32_16x16x32_bf16 v[48:51], a[228:231], v[180:183], v[48:51]
  s_waitcnt lgkmcnt(8)
  v_mfma_f32_16x16x32_bf16 v[60:63], a[236:239], v[180:183], v[60:63]
  s_waitcnt vmcnt(63)
  s_barrier
  v_mfma_f32_16x16x32_bf16 v[60:63], a[232:235], v[168:171], v[60:63]
  v_add_u32 v6, 101376, v5
  ds_read_b64_tr_b16 a[224:225], v6 offset:0
  v_mfma_f32_16x16x32_bf16 v[56:59], a[232:235], v[164:167], v[56:59]
  ds_read_b64_tr_b16 a[226:227], v6 offset:128
  s_add_u32 m0, s33, 67584
  s_mov_b32 s71, 115200
  v_mfma_f32_16x16x32_bf16 v[56:59], a[236:239], v[176:179], v[56:59]
  buffer_load_dwordx4 v2, s[20:23], s71 offen offset:0 lds
  ds_read_b64_tr_b16 a[228:229], v6 offset:256
  v_mfma_f32_16x16x32_bf16 v[52:55], a[236:239], v[172:175], v[52:55]
  ds_read_b64_tr_b16 a[230:231], v6 offset:384
  v_mfma_f32_16x16x32_bf16 v[52:55], a[232:235], v[160:163], v[52:55]
  s_waitcnt lgkmcnt(8)
  v_mfma_f32_16x16x32_bf16 v[64:67], a[240:243], v[160:163], v[64:67]
  ds_read_b64_tr_b16 a[232:233], v6 offset:512
  v_mfma_f32_16x16x32_bf16 v[64:67], a[244:247], v[172:175], v[64:67]
  ds_read_b64_tr_b16 a[234:235], v6 offset:640
  v_mfma_f32_16x16x32_bf16 v[68:71], a[244:247], v[176:179], v[68:71]
  s_add_u32 m0, s33, 67744
  v_mfma_f32_16x16x32_bf16 v[68:71], a[240:243], v[164:167], v[68:71]
  buffer_load_dwordx4 v2, s[20:23], s71 offen offset:896 lds
  ds_read_b64_tr_b16 a[236:237], v6 offset:768
  v_mfma_f32_16x16x32_bf16 v[72:75], a[240:243], v[168:171], v[72:75]
  ds_read_b64_tr_b16 a[238:239], v6 offset:896
  v_cvt_pk_bf16_f32 v232, v40, v41
  v_cvt_pk_bf16_f32 v233, v42, v43
  v_mfma_f32_16x16x32_bf16 v[72:75], a[244:247], v[180:183], v[72:75]
  s_waitcnt lgkmcnt(8)
  v_mfma_f32_16x16x32_bf16 v[84:87], a[252:255], v[180:183], v[84:87]
  ds_read_b64_tr_b16 a[240:241], v6 offset:544
  v_cvt_pk_bf16_f32 v234, v52, v53
  v_cvt_pk_bf16_f32 v235, v54, v55
  v_mfma_f32_16x16x32_bf16 v[84:87], a[248:251], v[168:171], v[84:87]
  ds_read_b64_tr_b16 a[242:243], v6 offset:672
  v_mfma_f32_16x16x32_bf16 v[80:83], a[248:251], v[164:167], v[80:83]
  s_add_u32 m0, s33, 67904
  buffer_store_dwordx4 v[232:235], v7, s[24:27], 0 offen
  v_cvt_pk_bf16_f32 v236, v44, v45
  v_cvt_pk_bf16_f32 v237, v46, v47
  v_mfma_f32_16x16x32_bf16 v[80:83], a[252:255], v[176:179], v[80:83]
  buffer_load_dwordx4 v2, s[20:23], s71 offen offset:1792 lds
  ds_read_b64_tr_b16 a[244:245], v6 offset:800
  v_mfma_f32_16x16x32_bf16 v[76:79], a[252:255], v[172:175], v[76:79]
  ds_read_b64_tr_b16 a[246:247], v6 offset:928
  v_cvt_pk_bf16_f32 v238, v56, v57
  v_mfma_f32_16x16x32_bf16 v[76:79], a[248:251], v[160:163], v[76:79]
  v_cvt_pk_bf16_f32 v239, v58, v59
  s_waitcnt lgkmcnt(8)
  v_mfma_f32_16x16x32_bf16 v[184:187], a[224:227], v[88:91], 0
  ds_read_b64_tr_b16 a[248:249], v6 offset:32
  buffer_store_dwordx4 v[236:239], v7, s[24:27], s77 offen
  v_mfma_f32_16x16x32_bf16 v[184:187], a[228:231], v[100:103], v[184:187]
  ds_read_b64_tr_b16 a[250:251], v6 offset:160
  v_cvt_pk_bf16_f32 v240, v48, v49
  v_cvt_pk_bf16_f32 v241, v50, v51
  v_mfma_f32_16x16x32_bf16 v[188:191], a[228:231], v[104:107], 0
  s_add_u32 m0, s33, 68064
  v_cvt_pk_bf16_f32 v242, v60, v61
  v_cvt_pk_bf16_f32 v243, v62, v63
  v_mfma_f32_16x16x32_bf16 v[188:191], a[224:227], v[92:95], v[188:191]
  buffer_load_dwordx4 v2, s[20:23], s71 offen offset:2688 lds
  ds_read_b64_tr_b16 a[252:253], v6 offset:288
  v_mfma_f32_16x16x32_bf16 v[192:195], a[224:227], v[96:99], 0
  ds_read_b64_tr_b16 a[254:255], v6 offset:416
  buffer_store_dwordx4 v[240:243], v7, s[24:27], s79 offen
  v_mfma_f32_16x16x32_bf16 v[192:195], a[228:231], v[108:111], v[192:195]
  v_cvt_pk_bf16_f32 v244, v64, v65
  v_cvt_pk_bf16_f32 v245, v66, v67
  s_waitcnt lgkmcnt(8)
  v_mfma_f32_16x16x32_bf16 v[192:195], a[236:239], v[132:135], v[192:195]
  ds_read_b64_tr_b16 a[224:225], v6 offset:64
  v_cvt_pk_bf16_f32 v246, v76, v77
  v_mfma_f32_16x16x32_bf16 v[192:195], a[232:235], v[120:123], v[192:195]
  ds_read_b64_tr_b16 a[226:227], v6 offset:192
  v_cvt_pk_bf16_f32 v247, v78, v79
  v_mfma_f32_16x16x32_bf16 v[188:191], a[232:235], v[116:119], v[188:191]
  buffer_store_dwordx4 v[244:247], v7, s[24:27], s76 offen
  v_cvt_pk_bf16_f32 v248, v68, v69
  v_cvt_pk_bf16_f32 v249, v70, v71
  v_mfma_f32_16x16x32_bf16 v[188:191], a[236:239], v[128:131], v[188:191]
  ds_read_b64_tr_b16 a[228:229], v6 offset:320
  v_mfma_f32_16x16x32_bf16 v[184:187], a[236:239], v[124:127], v[184:187]
  ds_read_b64_tr_b16 a[230:231], v6 offset:448
  v_cvt_pk_bf16_f32 v250, v80, v81
  v_mfma_f32_16x16x32_bf16 v[184:187], a[232:235], v[112:115], v[184:187]
  v_cvt_pk_bf16_f32 v251, v82, v83
  s_waitcnt lgkmcnt(8)
  v_mfma_f32_16x16x32_bf16 v[196:199], a[240:243], v[112:115], 0
  ds_read_b64_tr_b16 a[232:233], v6 offset:576
  buffer_store_dwordx4 v[248:251], v7, s[24:27], s78 offen
  v_cvt_pk_bf16_f32 v252, v72, v73
  v_mfma_f32_16x16x32_bf16 v[196:199], a[244:247], v[124:127], v[196:199]
  ds_read_b64_tr_b16 a[234:235], v6 offset:704
  v_cvt_pk_bf16_f32 v253, v74, v75
  v_mfma_f32_16x16x32_bf16 v[200:203], a[244:247], v[128:131], 0
  v_cvt_pk_bf16_f32 v254, v84, v85
  v_cvt_pk_bf16_f32 v255, v86, v87
  v_mfma_f32_16x16x32_bf16 v[200:203], a[240:243], v[116:119], v[200:203]
  ds_read_b64_tr_b16 a[236:237], v6 offset:832
  v_mfma_f32_16x16x32_bf16 v[204:207], a[240:243], v[120:123], 0
  ds_read_b64_tr_b16 a[238:239], v6 offset:960
  buffer_store_dwordx4 v[252:255], v7, s[24:27], s80 offen
  v_mfma_f32_16x16x32_bf16 v[204:207], a[244:247], v[132:135], v[204:207]
  v_add_u32 v7, 0x60000, v7
  s_waitcnt lgkmcnt(8)
  v_mfma_f32_16x16x32_bf16 v[204:207], a[252:255], v[108:111], v[204:207]
  ds_read_b64_tr_b16 a[240:241], v6 offset:608
  v_mfma_f32_16x16x32_bf16 v[204:207], a[248:251], v[96:99], v[204:207]
  ds_read_b64_tr_b16 a[242:243], v6 offset:736
  v_mfma_f32_16x16x32_bf16 v[200:203], a[248:251], v[92:95], v[200:203]
  v_mfma_f32_16x16x32_bf16 v[200:203], a[252:255], v[104:107], v[200:203]
  ds_read_b64_tr_b16 a[244:245], v6 offset:864
  v_mfma_f32_16x16x32_bf16 v[196:199], a[252:255], v[100:103], v[196:199]
  ds_read_b64_tr_b16 a[246:247], v6 offset:992
  v_mfma_f32_16x16x32_bf16 v[196:199], a[248:251], v[88:91], v[196:199]
  s_waitcnt lgkmcnt(8)
  v_mfma_f32_16x16x32_bf16 v[208:211], a[224:227], v[88:91], 0
  ds_read_b64_tr_b16 a[248:249], v6 offset:96
  v_mfma_f32_16x16x32_bf16 v[208:211], a[228:231], v[100:103], v[208:211]
  ds_read_b64_tr_b16 a[250:251], v6 offset:224
  v_mfma_f32_16x16x32_bf16 v[212:215], a[228:231], v[104:107], 0
  v_mfma_f32_16x16x32_bf16 v[212:215], a[224:227], v[92:95], v[212:215]
  ds_read_b64_tr_b16 a[252:253], v6 offset:352
  v_mfma_f32_16x16x32_bf16 v[216:219], a[224:227], v[96:99], 0
  ds_read_b64_tr_b16 a[254:255], v6 offset:480
  v_mfma_f32_16x16x32_bf16 v[216:219], a[228:231], v[108:111], v[216:219]
  s_waitcnt lgkmcnt(8)
  v_mfma_f32_16x16x32_bf16 v[216:219], a[236:239], v[132:135], v[216:219]
  s_waitcnt vmcnt(63)
  s_barrier
  v_mfma_f32_16x16x32_bf16 v[216:219], a[232:235], v[120:123], v[216:219]
  v_add_u32 v6, 118272, v5
  ds_read_b64_tr_b16 a[224:225], v6 offset:0
  v_mfma_f32_16x16x32_bf16 v[212:215], a[232:235], v[116:119], v[212:215]
  ds_read_b64_tr_b16 a[226:227], v6 offset:128
  s_add_u32 m0, s33, 135168
  s_mov_b32 s71, 640
  v_mfma_f32_16x16x32_bf16 v[212:215], a[236:239], v[128:131], v[212:215]
  buffer_load_dwordx4 v2, s[20:23], s71 offen offset:0 lds
  ds_read_b64_tr_b16 a[228:229], v6 offset:256
  v_mfma_f32_16x16x32_bf16 v[208:211], a[236:239], v[124:127], v[208:211]
  ds_read_b64_tr_b16 a[230:231], v6 offset:384
  v_mfma_f32_16x16x32_bf16 v[208:211], a[232:235], v[112:115], v[208:211]
  s_waitcnt lgkmcnt(8)
  v_mfma_f32_16x16x32_bf16 v[220:223], a[240:243], v[112:115], 0
  ds_read_b64_tr_b16 a[232:233], v6 offset:512
  v_mfma_f32_16x16x32_bf16 v[220:223], a[244:247], v[124:127], v[220:223]
  ds_read_b64_tr_b16 a[234:235], v6 offset:640
  v_mfma_f32_16x16x32_bf16 v[224:227], a[244:247], v[128:131], 0
  s_add_u32 m0, s33, 135328
  v_mfma_f32_16x16x32_bf16 v[224:227], a[240:243], v[116:119], v[224:227]
  buffer_load_dwordx4 v2, s[20:23], s71 offen offset:896 lds
  ds_read_b64_tr_b16 a[236:237], v6 offset:768
  v_mfma_f32_16x16x32_bf16 v[228:231], a[240:243], v[120:123], 0
  ds_read_b64_tr_b16 a[238:239], v6 offset:896
  v_mfma_f32_16x16x32_bf16 v[228:231], a[244:247], v[132:135], v[228:231]
  s_waitcnt lgkmcnt(8)
  v_mfma_f32_16x16x32_bf16 v[228:231], a[252:255], v[108:111], v[228:231]
  ds_read_b64_tr_b16 a[240:241], v6 offset:544
  v_mfma_f32_16x16x32_bf16 v[228:231], a[248:251], v[96:99], v[228:231]
  ds_read_b64_tr_b16 a[242:243], v6 offset:672
  v_mfma_f32_16x16x32_bf16 v[224:227], a[248:251], v[92:95], v[224:227]
  s_add_u32 m0, s33, 135488
  v_mfma_f32_16x16x32_bf16 v[224:227], a[252:255], v[104:107], v[224:227]
  buffer_load_dwordx4 v2, s[20:23], s71 offen offset:1792 lds
  ds_read_b64_tr_b16 a[244:245], v6 offset:800
  v_mfma_f32_16x16x32_bf16 v[220:223], a[252:255], v[100:103], v[220:223]
  ds_read_b64_tr_b16 a[246:247], v6 offset:928
  s_waitcnt vmcnt(3)
  v_mfma_f32_16x16x32_bf16 v[220:223], a[248:251], v[88:91], v[220:223]
  v_mov_b32 v8, 1
  buffer_store_dword v8, v28, s[44:47], 0 offen
  s_waitcnt lgkmcnt(8)
  v_mfma_f32_16x16x32_bf16 v[184:187], a[224:227], v[136:139], v[184:187]
  ds_read_b64_tr_b16 a[248:249], v6 offset:32
  v_mfma_f32_16x16x32_bf16 v[184:187], a[228:231], v[148:151], v[184:187]
  ds_read_b64_tr_b16 a[250:251], v6 offset:160
  v_mfma_f32_16x16x32_bf16 v[188:191], a[228:231], v[152:155], v[188:191]
  s_add_u32 m0, s33, 135648
  v_mfma_f32_16x16x32_bf16 v[188:191], a[224:227], v[140:143], v[188:191]
  buffer_load_dwordx4 v2, s[20:23], s71 offen offset:2688 lds
  ds_read_b64_tr_b16 a[252:253], v6 offset:288
  v_mfma_f32_16x16x32_bf16 v[192:195], a[224:227], v[144:147], v[192:195]
  ds_read_b64_tr_b16 a[254:255], v6 offset:416
  v_mfma_f32_16x16x32_bf16 v[192:195], a[228:231], v[156:159], v[192:195]
  s_waitcnt lgkmcnt(8)
  v_mfma_f32_16x16x32_bf16 v[192:195], a[236:239], v[180:183], v[192:195]
  ds_read_b64_tr_b16 a[224:225], v6 offset:64
  v_mfma_f32_16x16x32_bf16 v[192:195], a[232:235], v[168:171], v[192:195]
  ds_read_b64_tr_b16 a[226:227], v6 offset:192
  v_mfma_f32_16x16x32_bf16 v[188:191], a[232:235], v[164:167], v[188:191]
  v_mfma_f32_16x16x32_bf16 v[188:191], a[236:239], v[176:179], v[188:191]
  ds_read_b64_tr_b16 a[228:229], v6 offset:320
  v_mfma_f32_16x16x32_bf16 v[184:187], a[236:239], v[172:175], v[184:187]
  ds_read_b64_tr_b16 a[230:231], v6 offset:448
  v_mfma_f32_16x16x32_bf16 v[184:187], a[232:235], v[160:163], v[184:187]
  s_waitcnt lgkmcnt(8)
  v_mfma_f32_16x16x32_bf16 v[196:199], a[240:243], v[160:163], v[196:199]
  ds_read_b64_tr_b16 a[232:233], v6 offset:576
  v_mfma_f32_16x16x32_bf16 v[196:199], a[244:247], v[172:175], v[196:199]
  ds_read_b64_tr_b16 a[234:235], v6 offset:704
  v_mfma_f32_16x16x32_bf16 v[200:203], a[244:247], v[176:179], v[200:203]
  buffer_load_dword v24, v29, s[44:47], 0 offen sc1
  v_mfma_f32_16x16x32_bf16 v[200:203], a[240:243], v[164:167], v[200:203]
  ds_read_b64_tr_b16 a[236:237], v6 offset:832
  v_mfma_f32_16x16x32_bf16 v[204:207], a[240:243], v[168:171], v[204:207]
  ds_read_b64_tr_b16 a[238:239], v6 offset:960
  v_mfma_f32_16x16x32_bf16 v[204:207], a[244:247], v[180:183], v[204:207]
  s_waitcnt lgkmcnt(8)
  v_mfma_f32_16x16x32_bf16 v[204:207], a[252:255], v[156:159], v[204:207]
  ds_read_b64_tr_b16 a[240:241], v6 offset:608
  v_mfma_f32_16x16x32_bf16 v[204:207], a[248:251], v[144:147], v[204:207]
  ds_read_b64_tr_b16 a[242:243], v6 offset:736
  v_mfma_f32_16x16x32_bf16 v[200:203], a[248:251], v[140:143], v[200:203]
  v_mfma_f32_16x16x32_bf16 v[200:203], a[252:255], v[152:155], v[200:203]
  ds_read_b64_tr_b16 a[244:245], v6 offset:864
  v_mfma_f32_16x16x32_bf16 v[196:199], a[252:255], v[148:151], v[196:199]
  ds_read_b64_tr_b16 a[246:247], v6 offset:992
  v_mfma_f32_16x16x32_bf16 v[196:199], a[248:251], v[136:139], v[196:199]
  s_waitcnt lgkmcnt(8)
  v_mfma_f32_16x16x32_bf16 v[208:211], a[224:227], v[136:139], v[208:211]
  ds_read_b64_tr_b16 a[248:249], v6 offset:96
  v_mfma_f32_16x16x32_bf16 v[208:211], a[228:231], v[148:151], v[208:211]
  ds_read_b64_tr_b16 a[250:251], v6 offset:224
  v_mfma_f32_16x16x32_bf16 v[212:215], a[228:231], v[152:155], v[212:215]
  v_mfma_f32_16x16x32_bf16 v[212:215], a[224:227], v[140:143], v[212:215]
  ds_read_b64_tr_b16 a[252:253], v6 offset:352
  v_mfma_f32_16x16x32_bf16 v[216:219], a[224:227], v[144:147], v[216:219]
  ds_read_b64_tr_b16 a[254:255], v6 offset:480
  v_cvt_pk_bf16_f32 v232, v184, v185
  v_cvt_pk_bf16_f32 v233, v186, v187
  v_mfma_f32_16x16x32_bf16 v[216:219], a[228:231], v[156:159], v[216:219]
  s_waitcnt lgkmcnt(8)
  v_mfma_f32_16x16x32_bf16 v[216:219], a[236:239], v[180:183], v[216:219]
  v_cvt_pk_bf16_f32 v234, v196, v197
  v_cvt_pk_bf16_f32 v235, v198, v199
  v_mfma_f32_16x16x32_bf16 v[216:219], a[232:235], v[168:171], v[216:219]
  v_add_u32 v6, 84480, v5
  ds_read_b64_tr_b16 a[224:225], v6 offset:0
  v_mfma_f32_16x16x32_bf16 v[212:215], a[232:235], v[164:167], v[212:215]
  ds_read_b64_tr_b16 a[226:227], v6 offset:128
  s_waitcnt vmcnt(0)
  v_cmp_gt_u32 vcc, 1, v24
  s_cbranch_vccz L_go0
L_poll0:
  buffer_load_dword v24, v29, s[44:47], 0 offen sc1
  s_sub_u32 s39, s39, 1
  s_waitcnt vmcnt(0)
  v_cmp_gt_u32 vcc, 1, v24
  s_cbranch_scc1 L_giveup
  s_cbranch_vccnz L_poll0
L_go0:
  v_mfma_f32_16x16x32_bf16 v[212:215], a[236:239], v[176:179], v[212:215]
  ds_read_b64_tr_b16 a[228:229], v6 offset:256
  v_cvt_pk_bf16_f32 v236, v188, v189
  v_cvt_pk_bf16_f32 v237, v190, v191
  v_mfma_f32_16x16x32_bf16 v[208:211], a[236:239], v[172:175], v[208:211]
  s_branch L_page8
.p2align 12
L_hop8:
  s_branch L_walked1
  s_nop 0
L_page8:
  ds_read_b64_tr_b16 a[230:231], v6 offset:384
  v_cvt_pk_bf16_f32 v238, v200, v201
  v_cvt_pk_bf16_f32 v239, v202, v203
  v_mfma_f32_16x16x32_bf16 v[208:211], a[232:235], v[160:163], v[208:211]
  buffer_load_dwordx4 a[0:3], v30, s[40:43], 0 offen sc1
  s_waitcnt lgkmcnt(8)
  v_mfma_f32_16x16x32_bf16 v[220:223], a[240:243], v[160:163], v[220:223]
  ds_read_b64_tr_b16 a[232:233], v6 offset:512
  buffer_store_dwordx4 v[232:235], v7, s[24:27], 0 offen
  v_mfma_f32_16x16x32_bf16 v[220:223], a[244:247], v[172:175], v[220:223]
  ds_read_b64_tr_b16 a[234:235], v6 offset:640
  v_cvt_pk_bf16_f32 v240, v192, v193
  v_cvt_pk_bf16_f32 v241, v194, v195
  v_mfma_f32_16x16x32_bf16 v[224:227], a[244:247], v[176:179], v[224:227]
  v_cvt_pk_bf16_f32 v242, v204, v205
  v_cvt_pk_bf16_f32 v243, v206, v207
  v_mfma_f32_16x16x32_bf16 v[224:227], a[240:243], v[164:167], v[224:227]
  ds_read_b64_tr_b16 a[236:237], v6 offset:768
  v_mfma_f32_16x16x32_bf16 v[228:231], a[240:243], v[168:171], v[228:231]
  ds_read_b64_tr_b16 a[238:239], v6 offset:896
  v_mfma_f32_16x16x32_bf16 v[228:231], a[244:247], v[180:183], v[228:231]
  buffer_load_dwordx4 a[4:7], v30, s[40:43], s81 offen sc1
  s_waitcnt lgkmcnt(8)
  v_mfma_f32_16x16x32_bf16 v[228:231], a[252:255], v[156:159], v[228:231]
  ds_read_b64_tr_b16 a[240:241], v6 offset:544
  buffer_store_dwordx4 v[236:239], v7, s[24:27], s77 offen
  v_mfma_f32_16x16x32_bf16 v[228:231], a[248:251], v[144:147], v[228:231]
  ds_read_b64_tr_b16 a[242:243], v6 offset:672
  v_mfma_f32_16x16x32_bf16 v[224:227], a[248:251], v[140:143], v[224:227]
  v_mfma_f32_16x16x32_bf16 v[224:227], a[252:255], v[152:155], v[224:227]
  ds_read_b64_tr_b16 a[244:245], v6 offset:800
  v_mfma_f32_16x16x32_bf16 v[220:223], a[252:255], v[148:151], v[220:223]
  ds_read_b64_tr_b16 a[246:247], v6 offset:928
  v_mfma_f32_16x16x32_bf16 v[220:223], a[248:251], v[136:139], v[220:223]
  buffer_load_dwordx4 a[8:11], v30, s[40:43], s82 offen sc1
  s_waitcnt lgkmcnt(8)
  v_mfma_f32_16x16x32_bf16 v[40:43], a[224:227], v[88:91], 0
  ds_read_b64_tr_b16 a[248:249], v6 offset:32
  buffer_store_dwordx4 v[240:243], v7, s[24:27], s79 offen
  v_mfma_f32_16x16x32_bf16 v[40:43], a[228:231], v[100:103], v[40:43]
  ds_read_b64_tr_b16 a[250:251], v6 offset:160
  v_mfma_f32_16x16x32_bf16 v[44:47], a[228:231], v[104:107], 0
  v_cvt_pk_bf16_f32 v244, v208, v209
  v_cvt_pk_bf16_f32 v245, v210, v211
  v_mfma_f32_16x16x32_bf16 v[44:47], a[224:227], v[92:95], v[44:47]
  ds_read_b64_tr_b16 a[252:253], v6 offset:288
  v_mfma_f32_16x16x32_bf16 v[48:51], a[224:227], v[96:99], 0
  ds_read_b64_tr_b16 a[254:255], v6 offset:416
  v_cvt_pk_bf16_f32 v246, v220, v221
  v_cvt_pk_bf16_f32 v247, v222, v223
  v_mfma_f32_16x16x32_bf16 v[48:51], a[228:231], v[108:111], v[48:51]
  buffer_load_dwordx4 a[12:15], v30, s[40:43], s83 offen sc1
  s_waitcnt lgkmcnt(8)
  v_mfma_f32_16x16x32_bf16 v[48:51], a[236:239], v[132:135], v[48:51]
  ds_read_b64_tr_b16 a[224:225], v6 offset:64
  buffer_store_dwordx4 v[244:247], v7, s[24:27], s76 offen
  v_cvt_pk_bf16_f32 v248, v212, v213
  v_mfma_f32_16x16x32_bf16 v[48:51], a[232:235], v[120:123], v[48:51]
  ds_read_b64_tr_b16 a[226:227], v6 offset:192
  v_cvt_pk_bf16_f32 v249, v214, v215
  v_mfma_f32_16x16x32_bf16 v[44:47], a[232:235], v[116:119], v[44:47]
  v_cvt_pk_bf16_f32 v250, v224, v225
  v_cvt_pk_bf16_f32 v251, v226, v227
  v_mfma_f32_16x16x32_bf16 v[44:47], a[236:239], v[128:131], v[44:47]
  ds_read_b64_tr_b16 a[228:229], v6 offset:320
  v_mfma_f32_16x16x32_bf16 v[40:43], a[236:239], v[124:127], v[40:43]
  ds_read_b64_tr_b16 a[230:231], v6 offset:448
  v_cvt_pk_bf16_f32 v252, v216, v217
  v_cvt_pk_bf16_f32 v253, v218, v219
  v_mfma_f32_16x16x32_bf16 v[40:43], a[232:235], v[112:115], v[40:43]
  buffer_load_dwordx4 a[16:19], v31, s[40:43], 0 offen sc1
  s_waitcnt lgkmcnt(8)
  v_mfma_f32_16x16x32_bf16 v[52:55], a[240:243], v[112:115], 0
  ds_read_b64_tr_b16 a[232:233], v6 offset:576
  buffer_store_dwordx4 v[248:251], v7, s[24:27], s78 offen
  v_cvt_pk_bf16_f32 v254, v228, v229
  v_mfma_f32_16x16x32_bf16 v[52:55], a[244:247], v[124:127], v[52:55]
  ds_read_b64_tr_b16 a[234:235], v6 offset:704
  v_cvt_pk_bf16_f32 v255, v230, v231
  v_mfma_f32_16x16x32_bf16 v[56:59], a[244:247], v[128:131], 0
  v_mfma_f32_16x16x32_bf16 v[56:59], a[240:243], v[116:119], v[56:59]
  ds_read_b64_tr_b16 a[236:237], v6 offset:832
  v_mfma_f32_16x16x32_bf16 v[60:63], a[240:243], v[120:123], 0
  ds_read_b64_tr_b16 a[238:239], v6 offset:960
  v_mfma_f32_16x16x32_bf16 v[60:63], a[244:247], v[132:135], v[60:63]
  buffer_load_dwordx4 a[20:23], v31, s[40:43], s82 offen sc1
  v_add_u32 v30, 0x60000, v30
  s_waitcnt lgkmcnt(8)
  v_mfma_f32_16x16x32_bf16 v[60:63], a[252:255], v[108:111], v[60:63]
  ds_read_b64_tr_b16 a[240:241], v6 offset:608
  v_add_u32 v31, 0x60000, v31
  buffer_store_dwordx4 v[252:255], v7, s[24:27], s80 offen
  v_mfma_f32_16x16x32_bf16 v[60:63], a[248:251], v[96:99], v[60:63]
  ds_read_b64_tr_b16 a[242:243], v6 offset:736
  v_add_u32 v7, 0xfffa0000, v7
  v_mfma_f32_16x16x32_bf16 v[56:59], a[248:251], v[92:95], v[56:59]
  v_mfma_f32_16x16x32_bf16 v[56:59], a[252:255], v[104:107], v[56:59]
  ds_read_b64_tr_b16 a[244:245], v6 offset:864
  v_mfma_f32_16x16x32_bf16 v[52:55], a[252:255], v[100:103], v[52:55]
  ds_read_b64_tr_b16 a[246:247], v6 offset:992
  v_mfma_f32_16x16x32_bf16 v[52:55], a[248:251], v[88:91], v[52:55]
  s_waitcnt lgkmcnt(8)
  v_mfma_f32_16x16x32_bf16 v[64:67], a[224:227], v[88:91], 0
  ds_read_b64_tr_b16 a[248:249], v6 offset:96
  v_mfma_f32_16x16x32_bf16 v[64:67], a[228:231], v[100:103], v[64:67]
  ds_read_b64_tr_b16 a[250:251], v6 offset:224
  v_mfma_f32_16x16x32_bf16 v[68:71], a[228:231], v[104:107], 0
  v_mfma_f32_16x16x32_bf16 v[68:71], a[224:227], v[92:95], v[68:71]
  ds_read_b64_tr_b16 a[252:253], v6 offset:352
  v_mfma_f32_16x16x32_bf16 v[72:75], a[224:227], v[96:99], 0
  ds_read_b64_tr_b16 a[254:255], v6 offset:480
  v_mfma_f32_16x16x32_bf16 v[72:75], a[228:231], v[108:111], v[72:75]
  s_waitcnt lgkmcnt(8)
  v_mfma_f32_16x16x32_bf16 v[72:75], a[236:239], v[132:135], v[72:75]
  s_waitcnt vmcnt(39)
  s_barrier
  v_mfma_f32_16x16x32_bf16 v[72:75], a[232:235], v[120:123], v[72:75]
  v_add_u32 v6, 0, v5
  ds_read_b64_tr_b16 a[224:225], v6 offset:0
  v_mfma_f32_16x16x32_bf16 v[68:71], a[232:235], v[116:119], v[68:71]
  ds_read_b64_tr_b16 a[226:227], v6 offset:128
  s_add_u32 m0, s33, 101376
  s_mov_b32 s71, 115328
  v_mfma_f32_16x16x32_bf16 v[68:71], a[236:239], v[128:131], v[68:71]
  buffer_load_dwordx4 v2, s[20:23], s71 offen offset:0 lds
  ds_read_b64_tr_b16 a[228:229], v6 offset:256
  v_mfma_f32_16x16x32_bf16 v[64:67], a[236:239], v[124:127], v[64:67]
  ds_read_b64_tr_b16 a[230:231], v6 offset:384
  v_mfma_f32_16x16x32_bf16 v[64:67], a[232:235], v[112:115], v[64:67]
  s_waitcnt lgkmcnt(8)
  v_mfma_f32_16x16x32_bf16 v[76:79], a[240:243], v[112:115], 0
  ds_read_b64_tr_b16 a[232:233], v6 offset:512
  v_mfma_f32_16x16x32_bf16 v[76:79], a[244:247], v[124:127], v[76:79]
  ds_read_b64_tr_b16 a[234:235], v6 offset:640
  v_mfma_f32_16x16x32_bf16 v[80:83], a[244:247], v[128:131], 0
  s_add_u32 m0, s33, 101536
  v_mfma_f32_16x16x32_bf16 v[80:83], a[240:243], v[116:119], v[80:83]
  buffer_load_dwordx4 v2, s[20:23], s71 offen offset:896 lds
  ds_read_b64_tr_b16 a[236:237], v6 offset:768
  v_mfma_f32_16x16x32_bf16 v[84:87], a[240:243], v[120:123], 0
  ds_read_b64_tr_b16 a[238:239], v6 offset:896
  v_mfma_f32_16x16x32_bf16 v[84:87], a[244:247], v[132:135], v[84:87]
  s_waitcnt lgkmcnt(8)
  v_mfma_f32_16x16x32_bf16 v[84:87], a[252:255], v[108:111], v[84:87]
  ds_read_b64_tr_b16 a[240:241], v6 offset:544
  v_mfma_f32_16x16x32_bf16 v[84:87], a[248:251], v[96:99], v[84:87]
  ds_read_b64_tr_b16 a[242:243], v6 offset:672
  v_mfma_f32_16x16x32_bf16 v[80:83], a[248:251], v[92:95], v[80:83]
  s_add_u32 m0, s33, 101696
  v_mfma_f32_16x16x32_bf16 v[80:83], a[252:255], v[104:107], v[80:83]
  buffer_load_dwordx4 v2, s[20:23], s71 offen offset:1792 lds
  ds_read_b64_tr_b16 a[244:245], v6 offset:800
  v_mfma_f32_16x16x32_bf16 v[76:79], a[252:255], v[100:103], v[76:79]
  ds_read_b64_tr_b16 a[246:247], v6 offset:928
  s_waitcnt vmcnt(3)
  v_mfma_f32_16x16x32_bf16 v[76:79], a[248:251], v[88:91], v[76:79]
  v_mov_b32 v8, 2
  buffer_store_dword v8, v28, s[44:47], 0 offen
  v_mfma_f32_16x16x32_bf16 v[20:23], a[172:175], a[0:3], 0
  v_mfma_f32_16x16x32_bf16 v[20:23], a[172:175], a[4:7], v[20:23]
  v_mfma_f32_16x16x32_bf16 v[20:23], a[172:175], a[8:11], v[20:23]
  v_mfma_f32_16x16x32_bf16 v[20:23], a[172:175], a[12:15], v[20:23]
  v_mfma_f32_16x16x32_bf16 v[20:23], a[176:179], a[16:19], v[20:23]
  v_mfma_f32_16x16x32_bf16 v[20:23], a[176:179], a[20:23], v[20:23]
  s_waitcnt lgkmcnt(8)
  v_mfma_f32_16x16x32_bf16 v[40:43], a[224:227], v[136:139], v[40:43]
  ds_read_b64_tr_b16 a[248:249], v6 offset:32
  v_mfma_f32_16x16x32_bf16 v[40:43], a[228:231], v[148:151], v[40:43]
  ds_read_b64_tr_b16 a[250:251], v6 offset:160
  v_mfma_f32_16x16x32_bf16 v[44:47], a[228:231], v[152:155], v[44:47]
  s_add_u32 m0, s33, 101856
  v_mfma_f32_16x16x32_bf16 v[44:47], a[224:227], v[140:143], v[44:47]
  buffer_load_dwordx4 v2, s[20:23], s71 offen offset:2688 lds
  ds_read_b64_tr_b16 a[252:253], v6 offset:288
  v_mfma_f32_16x16x32_bf16 v[48:51], a[224:227], v[144:147], v[48:51]
  ds_read_b64_tr_b16 a[254:255], v6 offset:416
  v_mfma_f32_16x16x32_bf16 v[48:51], a[228:231], v[156:159], v[48:51]
  s_waitcnt lgkmcnt(8)
  v_mfma_f32_16x16x32_bf16 v[48:51], a[236:239], v[180:183], v[48:51]
  ds_read_b64_tr_b16 a[224:225], v6 offset:64
  v_mfma_f32_16x16x32_bf16 v[48:51], a[232:235], v[168:171], v[48:51]
  ds_read_b64_tr_b16 a[226:227], v6 offset:192
  v_mfma_f32_16x16x32_bf16 v[44:47], a[232:235], v[164:167], v[44:47]
  v_mfma_f32_16x16x32_bf16 v[44:47], a[236:239], v[176:179], v[44:47]
  ds_read_b64_tr_b16 a[228:229], v6 offset:320
  v_mfma_f32_16x16x32_bf16 v[40:43], a[236:239], v[172:175], v[40:43]
  ds_read_b64_tr_b16 a[230:231], v6 offset:448
  v_mfma_f32_16x16x32_bf16 v[40:43], a[232:235], v[160:163], v[40:43]
  s_waitcnt lgkmcnt(8)
  v_mfma_f32_16x16x32_bf16 v[52:55], a[240:243], v[160:163], v[52:55]
  ds_read_b64_tr_b16 a[232:233], v6 offset:576
  v_mfma_f32_16x16x32_bf16 v[52:55], a[244:247], v[172:175], v[52:55]
  ds_read_b64_tr_b16 a[234:235], v6 offset:704
  v_mfma_f32_16x16x32_bf16 v[56:59], a[244:247], v[176:179], v[56:59]
  buffer_load_dword v24, v29, s[44:47], 0 offen sc1
  v_mfma_f32_16x16x32_bf16 v[56:59], a[240:243], v[164:167], v[56:59]
  ds_read_b64_tr_b16 a[236:237], v6 offset:832
  v_mfma_f32_16x16x32_bf16 v[60:63], a[240:243], v[168:171], v[60:63]
  ds_read_b64_tr_b16 a[238:239], v6 offset:960
  v_add_f32_dpp v20, v20, v20 row_ror:8 row_mask:0xc bank_mask:0xf
  v_mfma_f32_16x16x32_bf16 v[60:63], a[244:247], v[180:183], v[60:63]
  v_add_f32_dpp v21, v21, v21 row_ror:8 row_mask:0xc bank_mask:0xf
  s_waitcnt lgkmcnt(8)
  v_mfma_f32_16x16x32_bf16 v[60:63], a[252:255], v[156:159], v[60:63]
  ds_read_b64_tr_b16 a[240:241], v6 offset:608
  v_add_f32_dpp v22, v22, v22 row_ror:8 row_mask:0xc bank_mask:0xf
  v_mfma_f32_16x16x32_bf16 v[60:63], a[248:251], v[144:147], v[60:63]
  ds_read_b64_tr_b16 a[242:243], v6 offset:736
  v_add_f32_dpp v23, v23, v23 row_ror:8 row_mask:0xc bank_mask:0xf
  v_mfma_f32_16x16x32_bf16 v[56:59], a[248:251], v[140:143], v[56:59]
  v_cvt_pk_bf16_f32 v20, v20, v21
  v_cvt_pk_bf16_f32 v21, v22, v23
  v_mfma_f32_16x16x32_bf16 v[56:59], a[252:255], v[152:155], v[56:59]
  ds_read_b64_tr_b16 a[244:245], v6 offset:864
  buffer_store_dwordx2 v[20:21], v32, s[28:31], s57 offen offset:0
  v_mfma_f32_16x16x32_bf16 v[52:55], a[252:255], v[148:151], v[52:55]
  ds_read_b64_tr_b16 a[246:247], v6 offset:992
  v_mfma_f32_16x16x32_bf16 v[52:55], a[248:251], v[136:139], v[52:55]
  s_waitcnt lgkmcnt(8)
  v_mfma_f32_16x16x32_bf16 v[64:67], a[224:227], v[136:139], v[64:67]
  ds_read_b64_tr_b16 a[248:249], v6 offset:96
  v_mfma_f32_16x16x32_bf16 v[64:67], a[228:231], v[148:151], v[64:67]
  ds_read_b64_tr_b16 a[250:251], v6 offset:224
  v_mfma_f32_16x16x32_bf16 v[68:71], a[228:231], v[152:155], v[68:71]
  v_mfma_f32_16x16x32_bf16 v[68:71], a[224:227], v[140:143], v[68:71]
  ds_read_b64_tr_b16 a[252:253], v6 offset:352
  v_mfma_f32_16x16x32_bf16 v[72:75], a[224:227], v[144:147], v[72:75]
  ds_read_b64_tr_b16 a[254:255], v6 offset:480
  v_cvt_pk_bf16_f32 v232, v40, v41
  v_cvt_pk_bf16_f32 v233, v42, v43
  v_mfma_f32_16x16x32_bf16 v[72:75], a[228:231], v[156:159], v[72:75]
  s_waitcnt lgkmcnt(8)
  v_mfma_f32_16x16x32_bf16 v[72:75], a[236:239], v[180:183], v[72:75]
  v_cvt_pk_bf16_f32 v234, v52, v53
  v_cvt_pk_bf16_f32 v235, v54, v55
  v_mfma_f32_16x16x32_bf16 v[72:75], a[232:235], v[168:171], v[72:75]
  v_add_u32 v6, 16896, v5
  ds_read_b64_tr_b16 a[224:225], v6 offset:0
  v_mfma_f32_16x16x32_bf16 v[68:71], a[232:235], v[164:167], v[68:71]
  ds_read_b64_tr_b16 a[226:227], v6 offset:128
  s_waitcnt vmcnt(1)
  v_cmp_gt_u32 vcc, 2, v24
  s_cbranch_vccz L_go1
L_poll1:
  buffer_load_dword v24, v29, s[44:47], 0 offen sc1
  s_sub_u32 s39, s39, 1
  s_waitcnt vmcnt(0)
  v_cmp_gt_u32 vcc, 2, v24
  s_cbranch_scc1 L_giveup
  s_cbranch_vccnz L_poll1
L_go1:
  v_mfma_f32_16x16x32_bf16 v[68:71], a[236:239], v[176:179], v[68:71]
  ds_read_b64_tr_b16 a[228:229], v6 offset:256
  v_cvt_pk_bf16_f32 v236, v44, v45
  v_cvt_pk_bf16_f32 v237, v46, v47
  v_mfma_f32_16x16x32_bf16 v[64:67], a[236:239], v[172:175], v[64:67]
  ds_read_b64_tr_b16 a[230:231], v6 offset:384
  v_cvt_pk_bf16_f32 v238, v56, v57
  v_cvt_pk_bf16_f32 v239, v58, v59
  v_mfma_f32_16x16x32_bf16 v[64:67], a[232:235], v[160:163], v[64:67]
  buffer_load_dwordx4 a[32:35], v30, s[40:43], 0 offen sc1
  s_waitcnt lgkmcnt(8)
  v_mfma_f32_16x16x32_bf16 v[76:79], a[240:243], v[160:163], v[76:79]
  ds_read_b64_tr_b16 a[232:233], v6 offset:512
  buffer_store_dwordx4 v[232:235], v7, s[24:27], 0 offen
  v_mfma_f32_16x16x32_bf16 v[76:79], a[244:247], v[172:175], v[76:79]
  ds_read_b64_tr_b16 a[234:235], v6 offset:640
  v_cvt_pk_bf16_f32 v240, v48, v49
  v_cvt_pk_bf16_f32 v241, v50, v51
  v_mfma_f32_16x16x32_bf16 v[80:83], a[244:247], v[176:179], v[80:83]
  v_cvt_pk_bf16_f32 v242, v60, v61
  v_cvt_pk_bf16_f32 v243, v62, v63
  v_mfma_f32_16x16x32_bf16 v[80:83], a[240:243], v[164:167], v[80:83]
  ds_read_b64_tr_b16 a[236:237], v6 offset:768
  v_mfma_f32_16x16x32_bf16 v[84:87], a[240:243], v[168:171], v[84:87]
  ds_read_b64_tr_b16 a[238:239], v6 offset:896
  v_mfma_f32_16x16x32_bf16 v[84:87], a[244:247], v[180:183], v[84:87]
  buffer_load_dwordx4 a[36:39], v30, s[40:43], s81 offen sc1
  s_waitcnt lgkmcnt(8)
  v_mfma_f32_16x16x32_bf16 v[84:87], a[252:255], v[156:159], v[84:87]
  ds_read_b64_tr_b16 a[240:241], v6 offset:544
  buffer_store_dwordx4 v[236:239], v7, s[24:27], s77 offen
  v_mfma_f32_16x16x32_bf16 v[84:87], a[248:251], v[144:147], v[84:87]
  ds_read_b64_tr_b16 a[242:243], v6 offset:672
  v_mfma_f32_16x16x32_bf16 v[80:83], a[248:251], v[140:143], v[80:83]
  v_mfma_f32_16x16x32_bf16 v[80:83], a[252:255], v[152:155], v[80:83]
  ds_read_b64_tr_b16 a[244:245], v6 offset:800
  v_mfma_f32_16x16x32_bf16 v[76:79], a[252:255], v[148:151], v[76:79]
  ds_read_b64_tr_b16 a[246:247], v6 offset:928
  v_mfma_f32_16x16x32_bf16 v[76:79], a[248:251], v[136:139], v[76:79]
  buffer_load_dwordx4 a[40:43], v30, s[40:43], s82 offen sc1
  s_waitcnt lgkmcnt(8)
  v_mfma_f32_16x16x32_bf16 v[184:187], a[224:227], v[88:91], 0
  ds_read_b64_tr_b16 a[248:249], v6 offset:32
  buffer_store_dwordx4 v[240:243], v7, s[24:27], s79 offen
  v_mfma_f32_16x16x32_bf16 v[184:187], a[228:231], v[100:103], v[184:187]
  ds_read_b64_tr_b16 a[250:251], v6 offset:160
  v_mfma_f32_16x16x32_bf16 v[188:191], a[228:231], v[104:107], 0
  v_cvt_pk_bf16_f32 v244, v64, v65
  v_cvt_pk_bf16_f32 v245, v66, v67
  v_mfma_f32_16x16x32_bf16 v[188:191], a[224:227], v[92:95], v[188:191]
  ds_read_b64_tr_b16 a[252:253], v6 offset:288
  v_mfma_f32_16x16x32_bf16 v[192:195], a[224:227], v[96:99], 0
  ds_read_b64_tr_b16 a[254:255], v6 offset:416
  v_cvt_pk_bf16_f32 v246, v76, v77
  v_cvt_pk_bf16_f32 v247, v78, v79
  v_mfma_f32_16x16x32_bf16 v[192:195], a[228:231], v[108:111], v[192:195]
  buffer_load_dwordx4 a[44:47], v30, s[40:43], s83 offen sc1
  s_waitcnt lgkmcnt(8)
  v_mfma_f32_16x16x32_bf16 v[192:195], a[236:239], v[132:135], v[192:195]
  ds_read_b64_tr_b16 a[224:225], v6 offset:64
  buffer_store_dwordx4 v[244:247], v7, s[24:27], s76 offen
  v_cvt_pk_bf16_f32 v248, v68, v69
  v_mfma_f32_16x16x32_bf16 v[192:195], a[232:235], v[120:123], v[192:195]
  ds_read_b64_tr_b16 a[226:227], v6 offset:192
  v_cvt_pk_bf16_f32 v249, v70, v71
  v_mfma_f32_16x16x32_bf16 v[188:191], a[232:235], v[116:119], v[188:191]
  v_cvt_pk_bf16_f32 v250, v80, v81
  v_cvt_pk_bf16_f32 v251, v82, v83
  v_mfma_f32_16x16x32_bf16 v[188:191], a[236:239], v[128:131], v[188:191]
  ds_read_b64_tr_b16 a[228:229], v6 offset:320
  v_mfma_f32_16x16x32_bf16 v[184:187], a[236:239], v[124:127], v[184:187]
  ds_read_b64_tr_b16 a[230:231], v6 offset:448
  v_cvt_pk_bf16_f32 v252, v72, v73
  v_cvt_pk_bf16_f32 v253, v74, v75
  v_mfma_f32_16x16x32_bf16 v[184:187], a[232:235], v[112:115], v[184:187]
  buffer_load_dwordx4 a[48:51], v31, s[40:43], 0 offen sc1
  s_waitcnt lgkmcnt(8)
  v_mfma_f32_16x16x32_bf16 v[196:199], a[240:243], v[112:115], 0
  ds_read_b64_tr_b16 a[232:233], v6 offset:576
  buffer_store_dwordx4 v[248:251], v7, s[24:27], s78 offen
  v_cvt_pk_bf16_f32 v254, v84, v85
  v_mfma_f32_16x16x32_bf16 v[196:199], a[244:247], v[124:127], v[196:199]
  ds_read_b64_tr_b16 a[234:235], v6 offset:704
  v_cvt_pk_bf16_f32 v255, v86, v87
  v_mfma_f32_16x16x32_bf16 v[200:203], a[244:247], v[128:131], 0
  v_mfma_f32_16x16x32_bf16 v[200:203], a[240:243], v[116:119], v[200:203]
  ds_read_b64_tr_b16 a[236:237], v6 offset:832
  v_mfma_f32_16x16x32_bf16 v[204:207], a[240:243], v[120:123], 0
  ds_read_b64_tr_b16 a[238:239], v6 offset:960
  v_mfma_f32_16x16x32_bf16 v[204:207], a[244:247], v[132:135], v[204:207]
  buffer_load_dwordx4 a[52:55], v31, s[40:43], s82 offen sc1
  v_add_u32 v30, 0xfffa0000, v30
  s_waitcnt lgkmcnt(8)
  v_mfma_f32_16x16x32_bf16 v[204:207], a[252:255], v[108:111], v[204:207]
  ds_read_b64_tr_b16 a[240:241], v6 offset:608
  v_add_u32 v31, 0xfffa0000, v31
  buffer_store_dwordx4 v[252:255], v7, s[24:27], s80 offen
  v_mfma_f32_16x16x32_bf16 v[204:207], a[248:251], v[96:99], v[204:207]
  ds_read_b64_tr_b16 a[242:243], v6 offset:736
  v_add_u32 v7, 0x60000, v7
  v_mfma_f32_16x16x32_bf16 v[200:203], a[248:251], v[92:95], v[200:203]
  v_mfma_f32_16x16x32_bf16 v[200:203], a[252:255], v[104:107], v[200:203]
  ds_read_b64_tr_b16 a[244:245], v6 offset:864
  v_mfma_f32_16x16x32_bf16 v[196:199], a[252:255], v[100:103], v[196:199]
  ds_read_b64_tr_b16 a[246:247], v6 offset:992
  v_mfma_f32_16x16x32_bf16 v[196:199], a[248:251], v[88:91], v[196:199]
  s_waitcnt lgkmcnt(8)
  v_mfma_f32_16x16x32_bf16 v[208:211], a[224:227], v[88:91], 0
  ds_read_b64_tr_b16 a[248:249], v6 offset:96
  v_mfma_f32_16x16x32_bf16 v[208:211], a[228:231], v[100:103], v[208:211]
  ds_read_b64_tr_b16 a[250:251], v6 offset:224
  v_mfma_f32_16x16x32_bf16 v[212:215], a[228:231], v[104:107], 0
  v_mfma_f32_16x16x32_bf16 v[212:215], a[224:227], v[92:95], v[212:215]
  ds_read_b64_tr_b16 a[252:253], v6 offset:352
  v_mfma_f32_16x16x32_bf16 v[216:219], a[224:227], v[96:99], 0
  ds_read_b64_tr_b16 a[254:255], v6 offset:480
  v_mfma_f32_16x16x32_bf16 v[216:219], a[228:231], v[108:111], v[216:219]
  s_waitcnt lgkmcnt(8)
  v_mfma_f32_16x16x32_bf16 v[216:219], a[236:239], v[132:135], v[216:219]
  s_waitcnt vmcnt(48)
  s_barrier
  v_mfma_f32_16x16x32_bf16 v[216:219], a[232:235], v[120:123], v[216:219]
  v_add_u32 v6, 33792, v5
  ds_read_b64_tr_b16 a[224:225], v6 offset:0
  v_mfma_f32_16x16x32_bf16 v[212:215], a[232:235], v[116:119], v[212:215]
  ds_read_b64_tr_b16 a[226:227], v6 offset:128
  s_add_u32 m0, s33, 118272
  s_mov_b32 s71, 768
  v_mfma_f32_16x16x32_bf16 v[212:215], a[236:239], v[128:131], v[212:215]
  buffer_load_dwordx4 v2, s[20:23], s71 offen offset:0 lds
  ds_read_b64_tr_b16 a[228:229], v6 offset:256
  v_mfma_f32_16x16x32_bf16 v[208:211], a[236:239], v[124:127], v[208:211]
  ds_read_b64_tr_b16 a[230:231], v6 offset:384
  v_mfma_f32_16x16x32_bf16 v[208:211], a[232:235], v[112:115], v[208:211]
  s_waitcnt lgkmcnt(8)
  v_mfma_f32_16x16x32_bf16 v[220:223], a[240:243], v[112:115], 0
  ds_read_b64_tr_b16 a[232:233], v6 offset:512
  v_mfma_f32_16x16x32_bf16 v[220:223], a[244:247], v[124:127], v[220:223]
  ds_read_b64_tr_b16 a[234:235], v6 offset:640
  v_mfma_f32_16x16x32_bf16 v[224:227], a[244:247], v[128:131], 0
  s_add_u32 m0, s33, 118432
  v_mfma_f32_16x16x32_bf16 v[224:227], a[240:243], v[116:119], v[224:227]
  buffer_load_dwordx4 v2, s[20:23], s71 offen offset:896 lds
  ds_read_b64_tr_b16 a[236:237], v6 offset:768
  v_mfma_f32_16x16x32_bf16 v[228:231], a[240:243], v[120:123], 0
  ds_read_b64_tr_b16 a[238:239], v6 offset:896
  v_mfma_f32_16x16x32_bf16 v[228:231], a[244:247], v[132:135], v[228:231]
  s_waitcnt lgkmcnt(8)
  v_mfma_f32_16x16x32_bf16 v[228:231], a[252:255], v[108:111], v[228:231]
  ds_read_b64_tr_b16 a[240:241], v6 offset:544
  v_mfma_f32_16x16x32_bf16 v[228:231], a[248:251], v[96:99], v[228:231]
  ds_read_b64_tr_b16 a[242:243], v6 offset:672
  v_mfma_f32_16x16x32_bf16 v[224:227], a[248:251], v[92:95], v[224:227]
  s_add_u32 m0, s33, 118592
  v_mfma_f32_16x16x32_bf16 v[224:227], a[252:255], v[104:107], v[224:227]
  buffer_load_dwordx4 v2, s[20:23], s71 offen offset:1792 lds
  ds_read_b64_tr_b16 a[244:245], v6 offset:800
  v_mfma_f32_16x16x32_bf16 v[220:223], a[252:255], v[100:103], v[220:223]
  ds_read_b64_tr_b16 a[246:247], v6 offset:928
  s_waitcnt vmcnt(3)
  v_mfma_f32_16x16x32_bf16 v[220:223], a[248:251], v[88:91], v[220:223]
  v_mov_b32 v8, 3
  buffer_store_dword v8, v28, s[44:47], 0 offen
  v_mfma_f32_16x16x32_bf16 v[20:23], a[172:175], a[32:35], 0
  v_mfma_f32_16x16x32_bf16 v[20:23], a[172:175], a[36:39], v[20:23]
  v_mfma_f32_16x16x32_bf16 v[20:23], a[172:175], a[40:43], v[20:23]
  v_mfma_f32_16x16x32_bf16 v[20:23], a[172:175], a[44:47], v[20:23]
  v_mfma_f32_16x16x32_bf16 v[20:23], a[176:179], a[48:51], v[20:23]
  v_mfma_f32_16x16x32_bf16 v[20:23], a[176:179], a[52:55], v[20:23]
  s_waitcnt lgkmcnt(8)
  v_mfma_f32_16x16x32_bf16 v[184:187], a[224:227], v[136:139], v[184:187]
  ds_read_b64_tr_b16 a[248:249], v6 offset:32
  v_mfma_f32_16x16x32_bf16 v[184:187], a[228:231], v[148:151], v[184:187]
  ds_read_b64_tr_b16 a[250:251], v6 offset:160
  v_mfma_f32_16x16x32_bf16 v[188:191], a[228:231], v[152:155], v[188:191]
  s_add_u32 m0, s33, 118752
  v_mfma_f32_16x16x32_bf16 v[188:191], a[224:227], v[140:143], v[188:191]
  buffer_load_dwordx4 v2, s[20:23], s71 offen offset:2688 lds
  ds_read_b64_tr_b16 a[252:253], v6 offset:288
  v_mfma_f32_16x16x32_bf16 v[192:195], a[224:227], v[144:147], v[192:195]
  ds_read_b64_tr_b16 a[254:255], v6 offset:416
  v_mfma_f32_16x16x32_bf16 v[192:195], a[228:231], v[156:159], v[192:195]
  s_waitcnt lgkmcnt(8)
  v_mfma_f32_16x16x32_bf16 v[192:195], a[236:239], v[180:183], v[192:195]
  ds_read_b64_tr_b16 a[224:225], v6 offset:64
  v_mfma_f32_16x16x32_bf16 v[192:195], a[232:235], v[168:171], v[192:195]
  ds_read_b64_tr_b16 a[226:227], v6 offset:192
  v_mfma_f32_16x16x32_bf16 v[188:191], a[232:235], v[164:167], v[188:191]
  v_mfma_f32_16x16x32_bf16 v[188:191], a[236:239], v[176:179], v[188:191]
  ds_read_b64_tr_b16 a[228:229], v6 offset:320
  v_mfma_f32_16x16x32_bf16 v[184:187], a[236:239], v[172:175], v[184:187]
  ds_read_b64_tr_b16 a[230:231], v6 offset:448
  v_mfma_f32_16x16x32_bf16 v[184:187], a[232:235], v[160:163], v[184:187]
  s_waitcnt lgkmcnt(8)
  v_mfma_f32_16x16x32_bf16 v[196:199], a[240:243], v[160:163], v[196:199]
  ds_read_b64_tr_b16 a[232:233], v6 offset:576
  v_mfma_f32_16x16x32_bf16 v[196:199], a[244:247], v[172:175], v[196:199]
  ds_read_b64_tr_b16 a[234:235], v6 offset:704
  v_mfma_f32_16x16x32_bf16 v[200:203], a[244:247], v[176:179], v[200:203]
  buffer_load_dword v24, v29, s[44:47], 0 offen sc1
  v_mfma_f32_16x16x32_bf16 v[200:203], a[240:243], v[164:167], v[200:203]
  ds_read_b64_tr_b16 a[236:237], v6 offset:832
  v_mfma_f32_16x16x32_bf16 v[204:207], a[240:243], v[168:171], v[204:207]
  ds_read_b64_tr_b16 a[238:239], v6 offset:960
  v_add_f32_dpp v20, v20, v20 row_ror:8 row_mask:0xc bank_mask:0xf
  v_mfma_f32_16x16x32_bf16 v[204:207], a[244:247], v[180:183], v[204:207]
  v_add_f32_dpp v21, v21, v21 row_ror:8 row_mask:0xc bank_mask:0xf
  s_waitcnt lgkmcnt(8)
  v_mfma_f32_16x16x32_bf16 v[204:207], a[252:255], v[156:159], v[204:207]
  ds_read_b64_tr_b16 a[240:241], v6 offset:608
  v_add_f32_dpp v22, v22, v22 row_ror:8 row_mask:0xc bank_mask:0xf
  v_mfma_f32_16x16x32_bf16 v[204:207], a[248:251], v[144:147], v[204:207]
  ds_read_b64_tr_b16 a[242:243], v6 offset:736
  v_add_f32_dpp v23, v23, v23 row_ror:8 row_mask:0xc bank_mask:0xf
  v_mfma_f32_16x16x32_bf16 v[200:203], a[248:251], v[140:143], v[200:203]
  v_cvt_pk_bf16_f32 v20, v20, v21
  v_cvt_pk_bf16_f32 v21, v22, v23
  v_mfma_f32_16x16x32_bf16 v[200:203], a[252:255], v[152:155], v[200:203]
  ds_read_b64_tr_b16 a[244:245], v6 offset:864
  buffer_store_dwordx2 v[20:21], v32, s[28:31], s57 offen offset:128
  v_mfma_f32_16x16x32_bf16 v[196:199], a[252:255], v[148:151], v[196:199]
  ds_read_b64_tr_b16 a[246:247], v6 offset:992
  v_mfma_f32_16x16x32_bf16 v[196:199], a[248:251], v[136:139], v[196:199]
  s_waitcnt lgkmcnt(8)
  v_mfma_f32_16x16x32_bf16 v[208:211], a[224:227], v[136:139], v[208:211]
  ds_read_b64_tr_b16 a[248:249], v6 offset:96
  v_mfma_f32_16x16x32_bf16 v[208:211], a[228:231], v[148:151], v[208:211]
  ds_read_b64_tr_b16 a[250:251], v6 offset:224
  v_mfma_f32_16x16x32_bf16 v[212:215], a[228:231], v[152:155], v[212:215]
  v_mfma_f32_16x16x32_bf16 v[212:215], a[224:227], v[140:143], v[212:215]
  ds_read_b64_tr_b16 a[252:253], v6 offset:352
  v_mfma_f32_16x16x32_bf16 v[216:219], a[224:227], v[144:147], v[216:219]
  ds_read_b64_tr_b16 a[254:255], v6 offset:480
  v_cvt_pk_bf16_f32 v232, v184, v185
  v_cvt_pk_bf16_f32 v233, v186, v187
  v_mfma_f32_16x16x32_bf16 v[216:219], a[228:231], v[156:159], v[216:219]
  s_waitcnt lgkmcnt(8)
  v_mfma_f32_16x16x32_bf16 v[216:219], a[236:239], v[180:183], v[216:219]
  v_cvt_pk_bf16_f32 v234, v196, v197
  v_cvt_pk_bf16_f32 v235, v198, v199
  v_mfma_f32_16x16x32_bf16 v[216:219], a[232:235], v[168:171], v[216:219]
  v_add_u32 v6, 50688, v5
  ds_read_b64_tr_b16 a[224:225], v6 offset:0
  v_mfma_f32_16x16x32_bf16 v[212:215], a[232:235], v[164:167], v[212:215]
  ds_read_b64_tr_b16 a[226:227], v6 offset:128
  s_waitcnt vmcnt(1)
  v_cmp_gt_u32 vcc, 3, v24
  s_cbranch_vccz L_go2
L_poll2:
  buffer_load_dword v24, v29, s[44:47], 0 offen sc1
  s_sub_u32 s39, s39, 1
  s_waitcnt vmcnt(0)
  v_cmp_gt_u32 vcc, 3, v24
  s_cbranch_scc1 L_giveup
  s_cbranch_vccnz L_poll2
L_go2:
  v_mfma_f32_16x16x32_bf16 v[212:215], a[236:239], v[176:179], v[212:215]
  ds_read_b64_tr_b16 a[228:229], v6 offset:256
  v_cvt_pk_bf16_f32 v236, v188, v189
  v_cvt_pk_bf16_f32 v237, v190, v191
  v_mfma_f32_16x16x32_bf16 v[208:211], a[236:239], v[172:175], v[208:211]
  ds_read_b64_tr_b16 a[230:231], v6 offset:384
  v_cvt_pk_bf16_f32 v238, v200, v201
  v_cvt_pk_bf16_f32 v239, v202, v203
  v_mfma_f32_16x16x32_bf16 v[208:211], a[232:235], v[160:163], v[208:211]
  buffer_load_dwordx4 a[0:3], v30, s[40:43], 0 offen sc1
  s_waitcnt lgkmcnt(8)
  v_mfma_f32_16x16x32_bf16 v[220:223], a[240:243], v[160:163], v[220:223]
  ds_read_b64_tr_b16 a[232:233], v6 offset:512
  buffer_store_dwordx4 v[232:235], v7, s[24:27], 0 offen
  v_mfma_f32_16x16x32_bf16 v[220:223], a[244:247], v[172:175], v[220:223]
  ds_read_b64_tr_b16 a[234:235], v6 offset:640
  v_cvt_pk_bf16_f32 v240, v192, v193
  v_cvt_pk_bf16_f32 v241, v194, v195
  v_mfma_f32_16x16x32_bf16 v[224:227], a[244:247], v[176:179], v[224:227]
  v_cvt_pk_bf16_f32 v242, v204, v205
  v_cvt_pk_bf16_f32 v243, v206, v207
  v_mfma_f32_16x16x32_bf16 v[224:227], a[240:243], v[164:167], v[224:227]
  ds_read_b64_tr_b16 a[236:237], v6 offset:768
  v_mfma_f32_16x16x32_bf16 v[228:231], a[240:243], v[168:171], v[228:231]
  ds_read_b64_tr_b16 a[238:239], v6 offset:896
  v_mfma_f32_16x16x32_bf16 v[228:231], a[244:247], v[180:183], v[228:231]
  buffer_load_dwordx4 a[4:7], v30, s[40:43], s81 offen sc1
  s_waitcnt lgkmcnt(8)
  v_mfma_f32_16x16x32_bf16 v[228:231], a[252:255], v[156:159], v[228:231]
  ds_read_b64_tr_b16 a[240:241], v6 offset:544
  buffer_store_dwordx4 v[236:239], v7, s[24:27], s77 offen
  v_mfma_f32_16x16x32_bf16 v[228:231], a[248:251], v[144:147], v[228:231]
  ds_read_b64_tr_b16 a[242:243], v6 offset:672
  v_mfma_f32_16x16x32_bf16 v[224:227], a[248:251], v[140:143], v[224:227]
  v_mfma_f32_16x16x32_bf16 v[224:227], a[252:255], v[152:155], v[224:227]
  ds_read_b64_tr_b16 a[244:245], v6 offset:800
  v_mfma_f32_16x16x32_bf16 v[220:223], a[252:255], v[148:151], v[220:223]
  s_branch L_page9
.p2align 12
L_hop9:
  s_branch L_walked1
  s_nop 0
L_page9:
  ds_read_b64_tr_b16 a[246:247], v6 offset:928
  v_mfma_f32_16x16x32_bf16 v[220:223], a[248:251], v[136:139], v[220:223]
  buffer_load_dwordx4 a[8:11], v30, s[40:43], s82 offen sc1
  s_waitcnt lgkmcnt(8)
  v_mfma_f32_16x16x32_bf16 v[40:43], a[224:227], v[88:91], 0
  ds_read_b64_tr_b16 a[248:249], v6 offset:32
  buffer_store_dwordx4 v[240:243], v7, s[24:27], s79 offen
  v_mfma_f32_16x16x32_bf16 v[40:43], a[228:231], v[100:103], v[40:43]
  ds_read_b64_tr_b16 a[250:251], v6 offset:160
  v_mfma_f32_16x16x32_bf16 v[44:47], a[228:231], v[104:107], 0
  v_cvt_pk_bf16_f32 v244, v208, v209
  v_cvt_pk_bf16_f32 v245, v210, v211
  v_mfma_f32_16x16x32_bf16 v[44:47], a[224:227], v[92:95], v[44:47]
  ds_read_b64_tr_b16 a[252:253], v6 offset:288
  v_mfma_f32_16x16x32_bf16 v[48:51], a[224:227], v[96:99], 0
  ds_read_b64_tr_b16 a[254:255], v6 offset:416
  v_cvt_pk_bf16_f32 v246, v220, v221
  v_cvt_pk_bf16_f32 v247, v222, v223
  v_mfma_f32_16x16x32_bf16 v[48:51], a[228:231], v[108:111], v[48:51]
  buffer_load_dwordx4 a[12:15], v30, s[40:43], s83 offen sc1
  s_waitcnt lgkmcnt(8)
  v_mfma_f32_16x16x32_bf16 v[48:51], a[236:239], v[132:135], v[48:51]
  ds_read_b64_tr_b16 a[224:225], v6 offset:64
  buffer_store_dwordx4 v[244:247], v7, s[24:27], s76 offen
  v_cvt_pk_bf16_f32 v248, v212, v213
  v_mfma_f32_16x16x32_bf16 v[48:51], a[232:235], v[120:123], v[48:51]
  ds_read_b64_tr_b16 a[226:227], v6 offset:192
  v_cvt_pk_bf16_f32 v249, v214, v215
  v_mfma_f32_16x16x32_bf16 v[44:47], a[232:235], v[116:119], v[44:47]
  v_cvt_pk_bf16_f32 v250, v224, v225
  v_cvt_pk_bf16_f32 v251, v226, v227
  v_mfma_f32_16x16x32_bf16 v[44:47], a[236:239], v[128:131], v[44:47]
  ds_read_b64_tr_b16 a[228:229], v6 offset:320
  v_mfma_f32_16x16x32_bf16 v[40:43], a[236:239], v[124:127], v[40:43]
  ds_read_b64_tr_b16 a[230:231], v6 offset:448
  v_cvt_pk_bf16_f32 v252, v216, v217
  v_cvt_pk_bf16_f32 v253, v218, v219
  v_mfma_f32_16x16x32_bf16 v[40:43], a[232:235], v[112:115], v[40:43]
  buffer_load_dwordx4 a[16:19], v31, s[40:43], 0 offen sc1
  s_waitcnt lgkmcnt(8)
  v_mfma_f32_16x16x32_bf16 v[52:55], a[240:243], v[112:115], 0
  ds_read_b64_tr_b16 a[232:233], v6 offset:576
  buffer_store_dwordx4 v[248:251], v7, s[24:27], s78 offen
  v_cvt_pk_bf16_f32 v254, v228, v229
  v_mfma_f32_16x16x32_bf16 v[52:55], a[244:247], v[124:127], v[52:55]
  ds_read_b64_tr_b16 a[234:235], v6 offset:704
  v_cvt_pk_bf16_f32 v255, v230, v231
  v_mfma_f32_16x16x32_bf16 v[56:59], a[244:247], v[128:131], 0
  v_mfma_f32_16x16x32_bf16 v[56:59], a[240:243], v[116:119], v[56:59]
  ds_read_b64_tr_b16 a[236:237], v6 offset:832
  v_mfma_f32_16x16x32_bf16 v[60:63], a[240:243], v[120:123], 0
  ds_read_b64_tr_b16 a[238:239], v6 offset:960
  v_mfma_f32_16x16x32_bf16 v[60:63], a[244:247], v[132:135], v[60:63]
  buffer_load_dwordx4 a[20:23], v31, s[40:43], s82 offen sc1
  v_add_u32 v30, 0x60000, v30
  s_waitcnt lgkmcnt(8)
  v_mfma_f32_16x16x32_bf16 v[60:63], a[252:255], v[108:111], v[60:63]
  ds_read_b64_tr_b16 a[240:241], v6 offset:608
  v_add_u32 v31, 0x60000, v31
  buffer_store_dwordx4 v[252:255], v7, s[24:27], s80 offen
  v_mfma_f32_16x16x32_bf16 v[60:63], a[248:251], v[96:99], v[60:63]
  ds_read_b64_tr_b16 a[242:243], v6 offset:736
  v_add_u32 v7, 0xfffa0000, v7
  v_mfma_f32_16x16x32_bf16 v[56:59], a[248:251], v[92:95], v[56:59]
  v_mfma_f32_16x16x32_bf16 v[56:59], a[252:255], v[104:107], v[56:59]
  ds_read_b64_tr_b16 a[244:245], v6 offset:864
  v_mfma_f32_16x16x32_bf16 v[52:55], a[252:255], v[100:103], v[52:55]
  ds_read_b64_tr_b16 a[246:247], v6 offset:992
  v_mfma_f32_16x16x32_bf16 v[52:55], a[248:251], v[88:91], v[52:55]
  s_waitcnt lgkmcnt(8)
  v_mfma_f32_16x16x32_bf16 v[64:67], a[224:227], v[88:91], 0
  ds_read_b64_tr_b16 a[248:249], v6 offset:96
  v_mfma_f32_16x16x32_bf16 v[64:67], a[228:231], v[100:103], v[64:67]
  ds_read_b64_tr_b16 a[250:251], v6 offset:224
  v_mfma_f32_16x16x32_bf16 v[68:71], a[228:231], v[104:107], 0
  v_mfma_f32_16x16x32_bf16 v[68:71], a[224:227], v[92:95], v[68:71]
  ds_read_b64_tr_b16 a[252:253], v6 offset:352
  v_mfma_f32_16x16x32_bf16 v[72:75], a[224:227], v[96:99], 0
  ds_read_b64_tr_b16 a[254:255], v6 offset:480
  v_mfma_f32_16x16x32_bf16 v[72:75], a[228:231], v[108:111], v[72:75]
  s_waitcnt lgkmcnt(8)
  v_mfma_f32_16x16x32_bf16 v[72:75], a[236:239], v[132:135], v[72:75]
  s_waitcnt vmcnt(14)
  s_barrier
  v_mfma_f32_16x16x32_bf16 v[72:75], a[232:235], v[120:123], v[72:75]
  v_add_u32 v6, 67584, v5
  ds_read_b64_tr_b16 a[224:225], v6 offset:0
  v_mfma_f32_16x16x32_bf16 v[68:71], a[232:235], v[116:119], v[68:71]
  ds_read_b64_tr_b16 a[226:227], v6 offset:128
  s_add_u32 m0, s33, 84480
  s_mov_b32 s71, 115456
  v_mfma_f32_16x16x32_bf16 v[68:71], a[236:239], v[128:131], v[68:71]
  buffer_load_dwordx4 v2, s[20:23], s71 offen offset:0 lds
  ds_read_b64_tr_b16 a[228:229], v6 offset:256
  v_mfma_f32_16x16x32_bf16 v[64:67], a[236:239], v[124:127], v[64:67]
  ds_read_b64_tr_b16 a[230:231], v6 offset:384
  v_mfma_f32_16x16x32_bf16 v[64:67], a[232:235], v[112:115], v[64:67]
  s_waitcnt lgkmcnt(8)
  v_mfma_f32_16x16x32_bf16 v[76:79], a[240:243], v[112:115], 0
  ds_read_b64_tr_b16 a[232:233], v6 offset:512
  v_mfma_f32_16x16x32_bf16 v[76:79], a[244:247], v[124:127], v[76:79]
  ds_read_b64_tr_b16 a[234:235], v6 offset:640
  v_mfma_f32_16x16x32_bf16 v[80:83], a[244:247], v[128:131], 0
  s_add_u32 m0, s33, 84640
  v_mfma_f32_16x16x32_bf16 v[80:83], a[240:243], v[116:119], v[80:83]
  buffer_load_dwordx4 v2, s[20:23], s71 offen offset:896 lds
  ds_read_b64_tr_b16 a[236:237], v6 offset:768
  v_mfma_f32_16x16x32_bf16 v[84:87], a[240:243], v[120:123], 0
  ds_read_b64_tr_b16 a[238:239], v6 offset:896
  v_mfma_f32_16x16x32_bf16 v[84:87], a[244:247], v[132:135], v[84:87]
  s_waitcnt lgkmcnt(8)
  v_mfma_f32_16x16x32_bf16 v[84:87], a[252:255], v[108:111], v[84:87]
  ds_read_b64_tr_b16 a[240:241], v6 offset:544
  v_mfma_f32_16x16x32_bf16 v[84:87], a[248:251], v[96:99], v[84:87]
  ds_read_b64_tr_b16 a[242:243], v6 offset:672
  v_mfma_f32_16x16x32_bf16 v[80:83], a[248:251], v[92:95], v[80:83]
  s_add_u32 m0, s33, 84800
  v_mfma_f32_16x16x32_bf16 v[80:83], a[252:255], v[104:107], v[80:83]
  buffer_load_dwordx4 v2, s[20:23], s71 offen offset:1792 lds
  ds_read_b64_tr_b16 a[244:245], v6 offset:800
  v_mfma_f32_16x16x32_bf16 v[76:79], a[252:255], v[100:103], v[76:79]
  ds_read_b64_tr_b16 a[246:247], v6 offset:928
  s_waitcnt vmcnt(3)
  v_mfma_f32_16x16x32_bf16 v[76:79], a[248:251], v[88:91], v[76:79]
  v_mov_b32 v8, 4
  buffer_store_dword v8, v28, s[44:47], 0 offen
  v_mfma_f32_16x16x32_bf16 v[20:23], a[172:175], a[0:3], 0
  v_mfma_f32_16x16x32_bf16 v[20:23], a[172:175], a[4:7], v[20:23]
  v_mfma_f32_16x16x32_bf16 v[20:23], a[172:175], a[8:11], v[20:23]
  v_mfma_f32_16x16x32_bf16 v[20:23], a[172:175], a[12:15], v[20:23]
  v_mfma_f32_16x16x32_bf16 v[20:23], a[176:179], a[16:19], v[20:23]
  v_mfma_f32_16x16x32_bf16 v[20:23], a[176:179], a[20:23], v[20:23]
  s_waitcnt lgkmcnt(8)
  v_mfma_f32_16x16x32_bf16 v[40:43], a[224:227], v[136:139], v[40:43]
  ds_read_b64_tr_b16 a[248:249], v6 offset:32
  v_mfma_f32_16x16x32_bf16 v[40:43], a[228:231], v[148:151], v[40:43]
  ds_read_b64_tr_b16 a[250:251], v6 offset:160
  v_mfma_f32_16x16x32_bf16 v[44:47], a[228:231], v[152:155], v[44:47]
  s_add_u32 m0, s33, 84960
  v_mfma_f32_16x16x32_bf16 v[44:47], a[224:227], v[140:143], v[44:47]
  buffer_load_dwordx4 v2, s[20:23], s71 offen offset:2688 lds
  ds_read_b64_tr_b16 a[252:253], v6 offset:288
  v_mfma_f32_16x16x32_bf16 v[48:51], a[224:227], v[144:147], v[48:51]
  ds_read_b64_tr_b16 a[254:255], v6 offset:416
  v_mfma_f32_16x16x32_bf16 v[48:51], a[228:231], v[156:159], v[48:51]
  s_waitcnt lgkmcnt(8)
  v_mfma_f32_16x16x32_bf16 v[48:51], a[236:239], v[180:183], v[48:51]
  ds_read_b64_tr_b16 a[224:225], v6 offset:64
  v_mfma_f32_16x16x32_bf16 v[48:51], a[232:235], v[168:171], v[48:51]
  ds_read_b64_tr_b16 a[226:227], v6 offset:192
  v_mfma_f32_16x16x32_bf16 v[44:47], a[232:235], v[164:167], v[44:47]
  v_mfma_f32_16x16x32_bf16 v[44:47], a[236:239], v[176:179], v[44:47]
  ds_read_b64_tr_b16 a[228:229], v6 offset:320
  v_mfma_f32_16x16x32_bf16 v[40:43], a[236:239], v[172:175], v[40:43]
  ds_read_b64_tr_b16 a[230:231], v6 offset:448
  v_mfma_f32_16x16x32_bf16 v[40:43], a[232:235], v[160:163], v[40:43]
  s_waitcnt lgkmcnt(8)
  v_mfma_f32_16x16x32_bf16 v[52:55], a[240:243], v[160:163], v[52:55]
  ds_read_b64_tr_b16 a[232:233], v6 offset:576
  v_mfma_f32_16x16x32_bf16 v[52:55], a[244:247], v[172:175], v[52:55]
  ds_read_b64_tr_b16 a[234:235], v6 offset:704
  v_mfma_f32_16x16x32_bf16 v[56:59], a[244:247], v[176:179], v[56:59]
  buffer_load_dword v24, v29, s[44:47], 0 offen sc1
  v_mfma_f32_16x16x32_bf16 v[56:59], a[240:243], v[164:167], v[56:59]
  ds_read_b64_tr_b16 a[236:237], v6 offset:832
  v_mfma_f32_16x16x32_bf16 v[60:63], a[240:243], v[168:171], v[60:63]
  ds_read_b64_tr_b16 a[238:239], v6 offset:960
  v_add_f32_dpp v20, v20, v20 row_ror:8 row_mask:0xc bank_mask:0xf
  v_mfma_f32_16x16x32_bf16 v[60:63], a[244:247], v[180:183], v[60:63]
  v_add_f32_dpp v21, v21, v21 row_ror:8 row_mask:0xc bank_mask:0xf
  s_waitcnt lgkmcnt(8)
  v_mfma_f32_16x16x32_bf16 v[60:63], a[252:255], v[156:159], v[60:63]
  ds_read_b64_tr_b16 a[240:241], v6 offset:608
  v_add_f32_dpp v22, v22, v22 row_ror:8 row_mask:0xc bank_mask:0xf
  v_mfma_f32_16x16x32_bf16 v[60:63], a[248:251], v[144:147], v[60:63]
  ds_read_b64_tr_b16 a[242:243], v6 offset:736
  v_add_f32_dpp v23, v23, v23 row_ror:8 row_mask:0xc bank_mask:0xf
  v_mfma_f32_16x16x32_bf16 v[56:59], a[248:251], v[140:143], v[56:59]
  v_cvt_pk_bf16_f32 v20, v20, v21
  v_cvt_pk_bf16_f32 v21, v22, v23
  v_mfma_f32_16x16x32_bf16 v[56:59], a[252:255], v[152:155], v[56:59]
  ds_read_b64_tr_b16 a[244:245], v6 offset:864
  buffer_store_dwordx2 v[20:21], v32, s[28:31], s57 offen offset:256
  v_mfma_f32_16x16x32_bf16 v[52:55], a[252:255], v[148:151], v[52:55]
  ds_read_b64_tr_b16 a[246:247], v6 offset:992
  v_mfma_f32_16x16x32_bf16 v[52:55], a[248:251], v[136:139], v[52:55]
  s_waitcnt lgkmcnt(8)
  v_mfma_f32_16x16x32_bf16 v[64:67], a[224:227], v[136:139], v[64:67]
  ds_read_b64_tr_b16 a[248:249], v6 offset:96
  v_mfma_f32_16x16x32_bf16 v[64:67], a[228:231], v[148:151], v[64:67]
  ds_read_b64_tr_b16 a[250:251], v6 offset:224
  v_mfma_f32_16x16x32_bf16 v[68:71], a[228:231], v[152:155], v[68:71]
  v_mfma_f32_16x16x32_bf16 v[68:71], a[224:227], v[140:143], v[68:71]
  ds_read_b64_tr_b16 a[252:253], v6 offset:352
  v_mfma_f32_16x16x32_bf16 v[72:75], a[224:227], v[144:147], v[72:75]
  ds_read_b64_tr_b16 a[254:255], v6 offset:480
  v_cvt_pk_bf16_f32 v232, v40, v41
  v_cvt_pk_bf16_f32 v233, v42, v43
  v_mfma_f32_16x16x32_bf16 v[72:75], a[228:231], v[156:159], v[72:75]
  s_waitcnt lgkmcnt(8)
  v_mfma_f32_16x16x32_bf16 v[72:75], a[236:239], v[180:183], v[72:75]
  v_cvt_pk_bf16_f32 v234, v52, v53
  v_cvt_pk_bf16_f32 v235, v54, v55
  v_mfma_f32_16x16x32_bf16 v[72:75], a[232:235], v[168:171], v[72:75]
  v_add_u32 v6, 135168, v5
  ds_read_b64_tr_b16 a[224:225], v6 offset:0
  v_mfma_f32_16x16x32_bf16 v[68:71], a[232:235], v[164:167], v[68:71]
  ds_read_b64_tr_b16 a[226:227], v6 offset:128
  s_waitcnt vmcnt(1)
  v_cmp_gt_u32 vcc, 4, v24
  s_cbranch_vccz L_go3
L_poll3:
  buffer_load_dword v24, v29, s[44:47], 0 offen sc1
  s_sub_u32 s39, s39, 1
  s_waitcnt vmcnt(0)
  v_cmp_gt_u32 vcc, 4, v24
  s_cbranch_scc1 L_giveup
  s_cbranch_vccnz L_poll3
L_go3:
  v_mfma_f32_16x16x32_bf16 v[68:71], a[236:239], v[176:179], v[68:71]
  ds_read_b64_tr_b16 a[228:229], v6 offset:256
  v_cvt_pk_bf16_f32 v236, v44, v45
  v_cvt_pk_bf16_f32 v237, v46, v47
  v_mfma_f32_16x16x32_bf16 v[64:67], a[236:239], v[172:175], v[64:67]
  ds_read_b64_tr_b16 a[230:231], v6 offset:384
  v_cvt_pk_bf16_f32 v238, v56, v57
  v_cvt_pk_bf16_f32 v239, v58, v59
  v_mfma_f32_16x16x32_bf16 v[64:67], a[232:235], v[160:163], v[64:67]
  buffer_load_dwordx4 a[32:35], v30, s[40:43], 0 offen sc1
  s_waitcnt lgkmcnt(8)
  v_mfma_f32_16x16x32_bf16 v[76:79], a[240:243], v[160:163], v[76:79]
  ds_read_b64_tr_b16 a[232:233], v6 offset:512
  buffer_store_dwordx4 v[232:235], v7, s[24:27], 0 offen
  v_mfma_f32_16x16x32_bf16 v[76:79], a[244:247], v[172:175], v[76:79]
  ds_read_b64_tr_b16 a[234:235], v6 offset:640
  v_cvt_pk_bf16_f32 v240, v48, v49
  v_cvt_pk_bf16_f32 v241, v50, v51
  v_mfma_f32_16x16x32_bf16 v[80:83], a[244:247], v[176:179], v[80:83]
  v_cvt_pk_bf16_f32 v242, v60, v61
  v_cvt_pk_bf16_f32 v243, v62, v63
  v_mfma_f32_16x16x32_bf16 v[80:83], a[240:243], v[164:167], v[80:83]
  ds_read_b64_tr_b16 a[236:237], v6 offset:768
  v_mfma_f32_16x16x32_bf16 v[84:87], a[240:243], v[168:171], v[84:87]
  ds_read_b64_tr_b16 a[238:239], v6 offset:896
  v_mfma_f32_16x16x32_bf16 v[84:87], a[244:247], v[180:183], v[84:87]
  buffer_load_dwordx4 a[36:39], v30, s[40:43], s81 offen sc1
  s_waitcnt lgkmcnt(8)
  v_mfma_f32_16x16x32_bf16 v[84:87], a[252:255], v[156:159], v[84:87]
  ds_read_b64_tr_b16 a[240:241], v6 offset:544
  buffer_store_dwordx4 v[236:239], v7, s[24:27], s77 offen
  v_mfma_f32_16x16x32_bf16 v[84:87], a[248:251], v[144:147], v[84:87]
  ds_read_b64_tr_b16 a[242:243], v6 offset:672
  v_mfma_f32_16x16x32_bf16 v[80:83], a[248:251], v[140:143], v[80:83]
  v_mfma_f32_16x16x32_bf16 v[80:83], a[252:255], v[152:155], v[80:83]
  ds_read_b64_tr_b16 a[244:245], v6 offset:800
  v_mfma_f32_16x16x32_bf16 v[76:79], a[252:255], v[148:151], v[76:79]
  ds_read_b64_tr_b16 a[246:247], v6 offset:928
  v_mfma_f32_16x16x32_bf16 v[76:79], a[248:251], v[136:139], v[76:79]
  buffer_load_dwordx4 a[40:43], v30, s[40:43], s82 offen sc1
  s_waitcnt lgkmcnt(8)
  v_mfma_f32_16x16x32_bf16 v[184:187], a[224:227], v[88:91], 0
  ds_read_b64_tr_b16 a[248:249], v6 offset:32
  buffer_store_dwordx4 v[240:243], v7, s[24:27], s79 offen
  v_mfma_f32_16x16x32_bf16 v[184:187], a[228:231], v[100:103], v[184:187]
  ds_read_b64_tr_b16 a[250:251], v6 offset:160
  v_mfma_f32_16x16x32_bf16 v[188:191], a[228:231], v[104:107], 0
  v_cvt_pk_bf16_f32 v244, v64, v65
  v_cvt_pk_bf16_f32 v245, v66, v67
  v_mfma_f32_16x16x32_bf16 v[188:191], a[224:227], v[92:95], v[188:191]
  ds_read_b64_tr_b16 a[252:253], v6 offset:288
  v_mfma_f32_16x16x32_bf16 v[192:195], a[224:227], v[96:99], 0
  ds_read_b64_tr_b16 a[254:255], v6 offset:416
  v_cvt_pk_bf16_f32 v246, v76, v77
  v_cvt_pk_bf16_f32 v247, v78, v79
  v_mfma_f32_16x16x32_bf16 v[192:195], a[228:231], v[108:111], v[192:195]
  buffer_load_dwordx4 a[44:47], v30, s[40:43], s83 offen sc1
  s_waitcnt lgkmcnt(8)
  v_mfma_f32_16x16x32_bf16 v[192:195], a[236:239], v[132:135], v[192:195]
  ds_read_b64_tr_b16 a[224:225], v6 offset:64
  buffer_store_dwordx4 v[244:247], v7, s[24:27], s76 offen
  v_cvt_pk_bf16_f32 v248, v68, v69
  v_mfma_f32_16x16x32_bf16 v[192:195], a[232:235], v[120:123], v[192:195]
  ds_read_b64_tr_b16 a[226:227], v6 offset:192
  v_cvt_pk_bf16_f32 v249, v70, v71
  v_mfma_f32_16x16x32_bf16 v[188:191], a[232:235], v[116:119], v[188:191]
  v_cvt_pk_bf16_f32 v250, v80, v81
  v_cvt_pk_bf16_f32 v251, v82, v83
  v_mfma_f32_16x16x32_bf16 v[188:191], a[236:239], v[128:131], v[188:191]
  ds_read_b64_tr_b16 a[228:229], v6 offset:320
  v_mfma_f32_16x16x32_bf16 v[184:187], a[236:239], v[124:127], v[184:187]
  ds_read_b64_tr_b16 a[230:231], v6 offset:448
  v_cvt_pk_bf16_f32 v252, v72, v73
  v_cvt_pk_bf16_f32 v253, v74, v75
  v_mfma_f32_16x16x32_bf16 v[184:187], a[232:235], v[112:115], v[184:187]
  buffer_load_dwordx4 a[48:51], v31, s[40:43], 0 offen sc1
  s_waitcnt lgkmcnt(8)
  v_mfma_f32_16x16x32_bf16 v[196:199], a[240:243], v[112:115], 0
  ds_read_b64_tr_b16 a[232:233], v6 offset:576
  buffer_store_dwordx4 v[248:251], v7, s[24:27], s78 offen
  v_cvt_pk_bf16_f32 v254, v84, v85
  v_mfma_f32_16x16x32_bf16 v[196:199], a[244:247], v[124:127], v[196:199]
  ds_read_b64_tr_b16 a[234:235], v6 offset:704
  v_cvt_pk_bf16_f32 v255, v86, v87
  v_mfma_f32_16x16x32_bf16 v[200:203], a[244:247], v[128:131], 0
  v_mfma_f32_16x16x32_bf16 v[200:203], a[240:243], v[116:119], v[200:203]
  ds_read_b64_tr_b16 a[236:237], v6 offset:832
  v_mfma_f32_16x16x32_bf16 v[204:207], a[240:243], v[120:123], 0
  ds_read_b64_tr_b16 a[238:239], v6 offset:960
  v_mfma_f32_16x16x32_bf16 v[204:207], a[244:247], v[132:135], v[204:207]
  buffer_load_dwordx4 a[52:55], v31, s[40:43], s82 offen sc1
  v_add_u32 v30, 0xfffa0000, v30
  s_waitcnt lgkmcnt(8)
  v_mfma_f32_16x16x32_bf16 v[204:207], a[252:255], v[108:111], v[204:207]
  ds_read_b64_tr_b16 a[240:241], v6 offset:608
  v_add_u32 v31, 0xfffa0000, v31
  buffer_store_dwordx4 v[252:255], v7, s[24:27], s80 offen
  v_mfma_f32_16x16x32_bf16 v[204:207], a[248:251], v[96:99], v[204:207]
  ds_read_b64_tr_b16 a[242:243], v6 offset:736
  v_add_u32 v7, 0x60000, v7
  v_mfma_f32_16x16x32_bf16 v[200:203], a[248:251], v[92:95], v[200:203]
  v_mfma_f32_16x16x32_bf16 v[200:203], a[252:255], v[104:107], v[200:203]
  ds_read_b64_tr_b16 a[244:245], v6 offset:864
  v_mfma_f32_16x16x32_bf16 v[196:199], a[252:255], v[100:103], v[196:199]
  ds_read_b64_tr_b16 a[246:247], v6 offset:992
  v_mfma_f32_16x16x32_bf16 v[196:199], a[248:251], v[88:91], v[196:199]
  s_waitcnt lgkmcnt(8)
  v_mfma_f32_16x16x32_bf16 v[208:211], a[224:227], v[88:91], 0
  ds_read_b64_tr_b16 a[248:249], v6 offset:96
  v_mfma_f32_16x16x32_bf16 v[208:211], a[228:231], v[100:103], v[208:211]
  ds_read_b64_tr_b16 a[250:251], v6 offset:224
  v_mfma_f32_16x16x32_bf16 v[212:215], a[228:231], v[104:107], 0
  v_mfma_f32_16x16x32_bf16 v[212:215], a[224:227], v[92:95], v[212:215]
  ds_read_b64_tr_b16 a[252:253], v6 offset:352
  v_mfma_f32_16x16x32_bf16 v[216:219], a[224:227], v[96:99], 0
  ds_read_b64_tr_b16 a[254:255], v6 offset:480
  v_mfma_f32_16x16x32_bf16 v[216:219], a[228:231], v[108:111], v[216:219]
  s_waitcnt lgkmcnt(8)
  v_mfma_f32_16x16x32_bf16 v[216:219], a[236:239], v[132:135], v[216:219]
  v_mfma_f32_16x16x32_bf16 v[216:219], a[232:235], v[120:123], v[216:219]
  v_add_u32 v6, 101376, v5
  ds_read_b64_tr_b16 a[224:225], v6 offset:0
  v_mfma_f32_16x16x32_bf16 v[212:215], a[232:235], v[116:119], v[212:215]
  ds_read_b64_tr_b16 a[226:227], v6 offset:128
  v_mfma_f32_16x16x32_bf16 v[212:215], a[236:239], v[128:131], v[212:215]
  ds_read_b64_tr_b16 a[228:229], v6 offset:256
  v_mfma_f32_16x16x32_bf16 v[208:211], a[236:239], v[124:127], v[208:211]
  ds_read_b64_tr_b16 a[230:231], v6 offset:384
  v_mfma_f32_16x16x32_bf16 v[208:211], a[232:235], v[112:115], v[208:211]
  s_waitcnt lgkmcnt(8)
  v_mfma_f32_16x16x32_bf16 v[220:223], a[240:243], v[112:115], 0
  ds_read_b64_tr_b16 a[232:233], v6 offset:512
  v_mfma_f32_16x16x32_bf16 v[220:223], a[244:247], v[124:127], v[220:223]
  ds_read_b64_tr_b16 a[234:235], v6 offset:640
  v_mfma_f32_16x16x32_bf16 v[224:227], a[244:247], v[128:131], 0
  v_mfma_f32_16x16x32_bf16 v[224:227], a[240:243], v[116:119], v[224:227]
  ds_read_b64_tr_b16 a[236:237], v6 offset:768
  v_mfma_f32_16x16x32_bf16 v[228:231], a[240:243], v[120:123], 0
  ds_read_b64_tr_b16 a[238:239], v6 offset:896
  v_mfma_f32_16x16x32_bf16 v[228:231], a[244:247], v[132:135], v[228:231]
  s_waitcnt lgkmcnt(8)
  v_mfma_f32_16x16x32_bf16 v[228:231], a[252:255], v[108:111], v[228:231]
  ds_read_b64_tr_b16 a[240:241], v6 offset:544
  v_mfma_f32_16x16x32_bf16 v[228:231], a[248:251], v[96:99], v[228:231]
  ds_read_b64_tr_b16 a[242:243], v6 offset:672
  v_mfma_f32_16x16x32_bf16 v[224:227], a[248:251], v[92:95], v[224:227]
  v_mfma_f32_16x16x32_bf16 v[224:227], a[252:255], v[104:107], v[224:227]
  ds_read_b64_tr_b16 a[244:245], v6 offset:800
  v_mfma_f32_16x16x32_bf16 v[220:223], a[252:255], v[100:103], v[220:223]
  ds_read_b64_tr_b16 a[246:247], v6 offset:928
  s_waitcnt vmcnt(0)
  v_mfma_f32_16x16x32_bf16 v[220:223], a[248:251], v[88:91], v[220:223]
  v_mov_b32 v8, 5
  buffer_store_dword v8, v28, s[44:47], 0 offen
  v_mfma_f32_16x16x32_bf16 v[20:23], a[172:175], a[32:35], 0
  v_mfma_f32_16x16x32_bf16 v[20:23], a[172:175], a[36:39], v[20:23]
  v_mfma_f32_16x16x32_bf16 v[20:23], a[172:175], a[40:43], v[20:23]
  v_mfma_f32_16x16x32_bf16 v[20:23], a[172:175], a[44:47], v[20:23]
  v_mfma_f32_16x16x32_bf16 v[20:23], a[176:179], a[48:51], v[20:23]
  v_mfma_f32_16x16x32_bf16 v[20:23], a[176:179], a[52:55], v[20:23]
  s_waitcnt lgkmcnt(8)
  v_mfma_f32_16x16x32_bf16 v[184:187], a[224:227], v[136:139], v[184:187]
  ds_read_b64_tr_b16 a[248:249], v6 offset:32
  v_mfma_f32_16x16x32_bf16 v[184:187], a[228:231], v[148:151], v[184:187]
  ds_read_b64_tr_b16 a[250:251], v6 offset:160
  v_mfma_f32_16x16x32_bf16 v[188:191], a[228:231], v[152:155], v[188:191]
  v_mfma_f32_16x16x32_bf16 v[188:191], a[224:227], v[140:143], v[188:191]
  ds_read_b64_tr_b16 a[252:253], v6 offset:288
  v_mfma_f32_16x16x32_bf16 v[192:195], a[224:227], v[144:147], v[192:195]
  ds_read_b64_tr_b16 a[254:255], v6 offset:416
  v_mfma_f32_16x16x32_bf16 v[192:195], a[228:231], v[156:159], v[192:195]
  s_waitcnt lgkmcnt(8)
  v_mfma_f32_16x16x32_bf16 v[192:195], a[236:239], v[180:183], v[192:195]
  ds_read_b64_tr_b16 a[224:225], v6 offset:64
  v_mfma_f32_16x16x32_bf16 v[192:195], a[232:235], v[168:171], v[192:195]
  ds_read_b64_tr_b16 a[226:227], v6 offset:192
  v_mfma_f32_16x16x32_bf16 v[188:191], a[232:235], v[164:167], v[188:191]
  v_mfma_f32_16x16x32_bf16 v[188:191], a[236:239], v[176:179], v[188:191]
  ds_read_b64_tr_b16 a[228:229], v6 offset:320
  v_mfma_f32_16x16x32_bf16 v[184:187], a[236:239], v[172:175], v[184:187]
  ds_read_b64_tr_b16 a[230:231], v6 offset:448
  v_mfma_f32_16x16x32_bf16 v[184:187], a[232:235], v[160:163], v[184:187]
  s_waitcnt lgkmcnt(8)
  v_mfma_f32_16x16x32_bf16 v[196:199], a[240:243], v[160:163], v[196:199]
  ds_read_b64_tr_b16 a[232:233], v6 offset:576
  v_mfma_f32_16x16x32_bf16 v[196:199], a[244:247], v[172:175], v[196:199]
  ds_read_b64_tr_b16 a[234:235], v6 offset:704
  v_mfma_f32_16x16x32_bf16 v[200:203], a[244:247], v[176:179], v[200:203]
  buffer_load_dword v24, v29, s[44:47], 0 offen sc1
  v_mfma_f32_16x16x32_bf16 v[200:203], a[240:243], v[164:167], v[200:203]
  ds_read_b64_tr_b16 a[236:237], v6 offset:832
  v_mfma_f32_16x16x32_bf16 v[204:207], a[240:243], v[168:171], v[204:207]
  ds_read_b64_tr_b16 a[238:239], v6 offset:960
  v_add_f32_dpp v20, v20, v20 row_ror:8 row_mask:0xc bank_mask:0xf
  v_mfma_f32_16x16x32_bf16 v[204:207], a[244:247], v[180:183], v[204:207]
  v_add_f32_dpp v21, v21, v21 row_ror:8 row_mask:0xc bank_mask:0xf
  s_waitcnt lgkmcnt(8)
  v_mfma_f32_16x16x32_bf16 v[204:207], a[252:255], v[156:159], v[204:207]
  ds_read_b64_tr_b16 a[240:241], v6 offset:608
  v_add_f32_dpp v22, v22, v22 row_ror:8 row_mask:0xc bank_mask:0xf
  v_mfma_f32_16x16x32_bf16 v[204:207], a[248:251], v[144:147], v[204:207]
  ds_read_b64_tr_b16 a[242:243], v6 offset:736
  v_add_f32_dpp v23, v23, v23 row_ror:8 row_mask:0xc bank_mask:0xf
  v_mfma_f32_16x16x32_bf16 v[200:203], a[248:251], v[140:143], v[200:203]
  v_cvt_pk_bf16_f32 v20, v20, v21
  v_cvt_pk_bf16_f32 v21, v22, v23
  v_mfma_f32_16x16x32_bf16 v[200:203], a[252:255], v[152:155], v[200:203]
  ds_read_b64_tr_b16 a[244:245], v6 offset:864
  buffer_store_dwordx2 v[20:21], v32, s[28:31], s57 offen offset:384
  v_mfma_f32_16x16x32_bf16 v[196:199], a[252:255], v[148:151], v[196:199]
  ds_read_b64_tr_b16 a[246:247], v6 offset:992
  v_mfma_f32_16x16x32_bf16 v[196:199], a[248:251], v[136:139], v[196:199]
  s_waitcnt lgkmcnt(8)
  v_mfma_f32_16x16x32_bf16 v[208:211], a[224:227], v[136:139], v[208:211]
  ds_read_b64_tr_b16 a[248:249], v6 offset:96
  v_mfma_f32_16x16x32_bf16 v[208:211], a[228:231], v[148:151], v[208:211]
  ds_read_b64_tr_b16 a[250:251], v6 offset:224
  v_mfma_f32_16x16x32_bf16 v[212:215], a[228:231], v[152:155], v[212:215]
  v_mfma_f32_16x16x32_bf16 v[212:215], a[224:227], v[140:143], v[212:215]
  ds_read_b64_tr_b16 a[252:253], v6 offset:352
  v_mfma_f32_16x16x32_bf16 v[216:219], a[224:227], v[144:147], v[216:219]
  ds_read_b64_tr_b16 a[254:255], v6 offset:480
  v_cvt_pk_bf16_f32 v232, v184, v185
  v_cvt_pk_bf16_f32 v233, v186, v187
  v_mfma_f32_16x16x32_bf16 v[216:219], a[228:231], v[156:159], v[216:219]
  s_waitcnt lgkmcnt(8)
  v_mfma_f32_16x16x32_bf16 v[216:219], a[236:239], v[180:183], v[216:219]
  v_cvt_pk_bf16_f32 v234, v196, v197
  v_cvt_pk_bf16_f32 v235, v198, v199
  v_mfma_f32_16x16x32_bf16 v[216:219], a[232:235], v[168:171], v[216:219]
  v_add_u32 v6, 118272, v5
  ds_read_b64_tr_b16 a[224:225], v6 offset:0
  v_mfma_f32_16x16x32_bf16 v[212:215], a[232:235], v[164:167], v[212:215]
  ds_read_b64_tr_b16 a[226:227], v6 offset:128
  s_waitcnt vmcnt(1)
  v_cmp_gt_u32 vcc, 5, v24
  s_cbranch_vccz L_go4
L_poll4:
  buffer_load_dword v24, v29, s[44:47], 0 offen sc1
  s_sub_u32 s39, s39, 1
  s_waitcnt vmcnt(0)
  v_cmp_gt_u32 vcc, 5, v24
  s_cbranch_scc1 L_giveup
  s_cbranch_vccnz L_poll4
L_go4:
  v_mfma_f32_16x16x32_bf16 v[212:215], a[236:239], v[176:179], v[212:215]
  ds_read_b64_tr_b16 a[228:229], v6 offset:256
  v_cvt_pk_bf16_f32 v236, v188, v189
  v_cvt_pk_bf16_f32 v237, v190, v191
  v_mfma_f32_16x16x32_bf16 v[208:211], a[236:239], v[172:175], v[208:211]
  ds_read_b64_tr_b16 a[230:231], v6 offset:384
  v_cvt_pk_bf16_f32 v238, v200, v201
  v_cvt_pk_bf16_f32 v239, v202, v203
  v_mfma_f32_16x16x32_bf16 v[208:211], a[232:235], v[160:163], v[208:211]
  buffer_load_dwordx4 a[0:3], v30, s[40:43], 0 offen sc1
  s_waitcnt lgkmcnt(8)
  v_mfma_f32_16x16x32_bf16 v[220:223], a[240:243], v[160:163], v[220:223]
  ds_read_b64_tr_b16 a[232:233], v6 offset:512
  buffer_store_dwordx4 v[232:235], v7, s[24:27], 0 offen
  v_mfma_f32_16x16x32_bf16 v[220:223], a[244:247], v[172:175], v[220:223]
  ds_read_b64_tr_b16 a[234:235], v6 offset:640
  v_cvt_pk_bf16_f32 v240, v192, v193
  v_cvt_pk_bf16_f32 v241, v194, v195
  v_mfma_f32_16x16x32_bf16 v[224:227], a[244:247], v[176:179], v[224:227]
  v_cvt_pk_bf16_f32 v242, v204, v205
  v_cvt_pk_bf16_f32 v243, v206, v207
  v_mfma_f32_16x16x32_bf16 v[224:227], a[240:243], v[164:167], v[224:227]
  ds_read_b64_tr_b16 a[236:237], v6 offset:768
  v_mfma_f32_16x16x32_bf16 v[228:231], a[240:243], v[168:171], v[228:231]
  ds_read_b64_tr_b16 a[238:239], v6 offset:896
  v_mfma_f32_16x16x32_bf16 v[228:231], a[244:247], v[180:183], v[228:231]
  buffer_load_dwordx4 a[4:7], v30, s[40:43], s81 offen sc1
  s_waitcnt lgkmcnt(8)
  v_mfma_f32_16x16x32_bf16 v[228:231], a[252:255], v[156:159], v[228:231]
  ds_read_b64_tr_b16 a[240:241], v6 offset:544
  buffer_store_dwordx4 v[236:239], v7, s[24:27], s77 offen
  v_mfma_f32_16x16x32_bf16 v[228:231], a[248:251], v[144:147], v[228:231]
  ds_read_b64_tr_b16 a[242:243], v6 offset:672
  v_mfma_f32_16x16x32_bf16 v[224:227], a[248:251], v[140:143], v[224:227]
  v_mfma_f32_16x16x32_bf16 v[224:227], a[252:255], v[152:155], v[224:227]
  ds_read_b64_tr_b16 a[244:245], v6 offset:800
  v_mfma_f32_16x16x32_bf16 v[220:223], a[252:255], v[148:151], v[220:223]
  ds_read_b64_tr_b16 a[246:247], v6 offset:928
  v_mfma_f32_16x16x32_bf16 v[220:223], a[248:251], v[136:139], v[220:223]
  buffer_load_dwordx4 a[8:11], v30, s[40:43], s82 offen sc1
  s_waitcnt lgkmcnt(8)
  v_mfma_f32_16x16x32_bf16 v[40:43], a[224:227], v[88:91], 0
  ds_read_b64_tr_b16 a[248:249], v6 offset:32
  buffer_store_dwordx4 v[240:243], v7, s[24:27], s79 offen
  v_mfma_f32_16x16x32_bf16 v[40:43], a[228:231], v[100:103], v[40:43]
  ds_read_b64_tr_b16 a[250:251], v6 offset:160
  v_mfma_f32_16x16x32_bf16 v[44:47], a[228:231], v[104:107], 0
  v_cvt_pk_bf16_f32 v244, v208, v209
  v_cvt_pk_bf16_f32 v245, v210, v211
  v_mfma_f32_16x16x32_bf16 v[44:47], a[224:227], v[92:95], v[44:47]
  ds_read_b64_tr_b16 a[252:253], v6 offset:288
  v_mfma_f32_16x16x32_bf16 v[48:51], a[224:227], v[96:99], 0
  ds_read_b64_tr_b16 a[254:255], v6 offset:416
  v_cvt_pk_bf16_f32 v246, v220, v221
  v_cvt_pk_bf16_f32 v247, v222, v223
  v_mfma_f32_16x16x32_bf16 v[48:51], a[228:231], v[108:111], v[48:51]
  buffer_load_dwordx4 a[12:15], v30, s[40:43], s83 offen sc1
  s_waitcnt lgkmcnt(8)
  v_mfma_f32_16x16x32_bf16 v[48:51], a[236:239], v[132:135], v[48:51]
  ds_read_b64_tr_b16 a[224:225], v6 offset:64
  buffer_store_dwordx4 v[244:247], v7, s[24:27], s76 offen
  v_cvt_pk_bf16_f32 v248, v212, v213
  v_mfma_f32_16x16x32_bf16 v[48:51], a[232:235], v[120:123], v[48:51]
  ds_read_b64_tr_b16 a[226:227], v6 offset:192
  v_cvt_pk_bf16_f32 v249, v214, v215
  v_mfma_f32_16x16x32_bf16 v[44:47], a[232:235], v[116:119], v[44:47]
  v_cvt_pk_bf16_f32 v250, v224, v225
  v_cvt_pk_bf16_f32 v251, v226, v227
  v_mfma_f32_16x16x32_bf16 v[44:47], a[236:239], v[128:131], v[44:47]
  ds_read_b64_tr_b16 a[228:229], v6 offset:320
  v_mfma_f32_16x16x32_bf16 v[40:43], a[236:239], v[124:127], v[40:43]
  ds_read_b64_tr_b16 a[230:231], v6 offset:448
  v_cvt_pk_bf16_f32 v252, v216, v217
  v_cvt_pk_bf16_f32 v253, v218, v219
  v_mfma_f32_16x16x32_bf16 v[40:43], a[232:235], v[112:115], v[40:43]
  buffer_load_dwordx4 a[16:19], v31, s[40:43], 0 offen sc1
  s_waitcnt lgkmcnt(8)
  v_mfma_f32_16x16x32_bf16 v[52:55], a[240:243], v[112:115], 0
  s_branch L_page10
.p2align 12
L_hop10:
  s_branch L_walked1
  s_nop 0
L_page10:
  ds_read_b64_tr_b16 a[232:233], v6 offset:576
  buffer_store_dwordx4 v[248:251], v7, s[24:27], s78 offen
  v_cvt_pk_bf16_f32 v254, v228, v229
  v_mfma_f32_16x16x32_bf16 v[52:55], a[244:247], v[124:127], v[52:55]
  ds_read_b64_tr_b16 a[234:235], v6 offset:704
  v_cvt_pk_bf16_f32 v255, v230, v231
  v_mfma_f32_16x16x32_bf16 v[56:59], a[244:247], v[128:131], 0
  v_mfma_f32_16x16x32_bf16 v[56:59], a[240:243], v[116:119], v[56:59]
  ds_read_b64_tr_b16 a[236:237], v6 offset:832
  v_mfma_f32_16x16x32_bf16 v[60:63], a[240:243], v[120:123], 0
  ds_read_b64_tr_b16 a[238:239], v6 offset:960
  v_mfma_f32_16x16x32_bf16 v[60:63], a[244:247], v[132:135], v[60:63]
  buffer_load_dwordx4 a[20:23], v31, s[40:43], s82 offen sc1
  v_add_u32 v30, 0x60000, v30
  s_waitcnt lgkmcnt(8)
  v_mfma_f32_16x16x32_bf16 v[60:63], a[252:255], v[108:111], v[60:63]
  ds_read_b64_tr_b16 a[240:241], v6 offset:608
  v_add_u32 v31, 0x60000, v31
  buffer_store_dwordx4 v[252:255], v7, s[24:27], s80 offen
  v_mfma_f32_16x16x32_bf16 v[60:63], a[248:251], v[96:99], v[60:63]
  ds_read_b64_tr_b16 a[242:243], v6 offset:736
  v_add_u32 v7, 0xfffa0000, v7
  v_mfma_f32_16x16x32_bf16 v[56:59], a[248:251], v[92:95], v[56:59]
  v_mfma_f32_16x16x32_bf16 v[56:59], a[252:255], v[104:107], v[56:59]
  ds_read_b64_tr_b16 a[244:245], v6 offset:864
  v_mfma_f32_16x16x32_bf16 v[52:55], a[252:255], v[100:103], v[52:55]
  ds_read_b64_tr_b16 a[246:247], v6 offset:992
  v_mfma_f32_16x16x32_bf16 v[52:55], a[248:251], v[88:91], v[52:55]
  s_waitcnt lgkmcnt(8)
  v_mfma_f32_16x16x32_bf16 v[64:67], a[224:227], v[88:91], 0
  ds_read_b64_tr_b16 a[248:249], v6 offset:96
  v_mfma_f32_16x16x32_bf16 v[64:67], a[228:231], v[100:103], v[64:67]
  ds_read_b64_tr_b16 a[250:251], v6 offset:224
  v_mfma_f32_16x16x32_bf16 v[68:71], a[228:231], v[104:107], 0
  v_mfma_f32_16x16x32_bf16 v[68:71], a[224:227], v[92:95], v[68:71]
  ds_read_b64_tr_b16 a[252:253], v6 offset:352
  v_mfma_f32_16x16x32_bf16 v[72:75], a[224:227], v[96:99], 0
  ds_read_b64_tr_b16 a[254:255], v6 offset:480
  v_mfma_f32_16x16x32_bf16 v[72:75], a[228:231], v[108:111], v[72:75]
  s_waitcnt lgkmcnt(8)
  v_mfma_f32_16x16x32_bf16 v[72:75], a[236:239], v[132:135], v[72:75]
  s_waitcnt vmcnt(29)
  s_barrier
  v_mfma_f32_16x16x32_bf16 v[72:75], a[232:235], v[120:123], v[72:75]
  v_add_u32 v6, 84480, v5
  ds_read_b64_tr_b16 a[224:225], v6 offset:0
  v_mfma_f32_16x16x32_bf16 v[68:71], a[232:235], v[116:119], v[68:71]
  ds_read_b64_tr_b16 a[226:227], v6 offset:128
  v_mfma_f32_16x16x32_bf16 v[68:71], a[236:239], v[128:131], v[68:71]
  ds_read_b64_tr_b16 a[228:229], v6 offset:256
  v_mfma_f32_16x16x32_bf16 v[64:67], a[236:239], v[124:127], v[64:67]
  ds_read_b64_tr_b16 a[230:231], v6 offset:384
  v_mfma_f32_16x16x32_bf16 v[64:67], a[232:235], v[112:115], v[64:67]
  s_waitcnt lgkmcnt(8)
  v_mfma_f32_16x16x32_bf16 v[76:79], a[240:243], v[112:115], 0
  ds_read_b64_tr_b16 a[232:233], v6 offset:512
  v_mfma_f32_16x16x32_bf16 v[76:79], a[244:247], v[124:127], v[76:79]
  ds_read_b64_tr_b16 a[234:235], v6 offset:640
  v_mfma_f32_16x16x32_bf16 v[80:83], a[244:247], v[128:131], 0
  v_mfma_f32_16x16x32_bf16 v[80:83], a[240:243], v[116:119], v[80:83]
  ds_read_b64_tr_b16 a[236:237], v6 offset:768
  v_mfma_f32_16x16x32_bf16 v[84:87], a[240:243], v[120:123], 0
  ds_read_b64_tr_b16 a[238:239], v6 offset:896
  v_mfma_f32_16x16x32_bf16 v[84:87], a[244:247], v[132:135], v[84:87]
  s_waitcnt lgkmcnt(8)
  v_mfma_f32_16x16x32_bf16 v[84:87], a[252:255], v[108:111], v[84:87]
  ds_read_b64_tr_b16 a[240:241], v6 offset:544
  v_mfma_f32_16x16x32_bf16 v[84:87], a[248:251], v[96:99], v[84:87]
  ds_read_b64_tr_b16 a[242:243], v6 offset:672
  v_mfma_f32_16x16x32_bf16 v[80:83], a[248:251], v[92:95], v[80:83]
  v_mfma_f32_16x16x32_bf16 v[80:83], a[252:255], v[104:107], v[80:83]
  ds_read_b64_tr_b16 a[244:245], v6 offset:800
  v_mfma_f32_16x16x32_bf16 v[76:79], a[252:255], v[100:103], v[76:79]
  ds_read_b64_tr_b16 a[246:247], v6 offset:928
  s_waitcnt vmcnt(0)
  v_mfma_f32_16x16x32_bf16 v[76:79], a[248:251], v[88:91], v[76:79]
  v_mov_b32 v8, 6
  buffer_store_dword v8, v28, s[44:47], 0 offen
  v_mfma_f32_16x16x32_bf16 v[20:23], a[172:175], a[0:3], 0
  v_mfma_f32_16x16x32_bf16 v[20:23], a[172:175], a[4:7], v[20:23]
  v_mfma_f32_16x16x32_bf16 v[20:23], a[172:175], a[8:11], v[20:23]
  v_mfma_f32_16x16x32_bf16 v[20:23], a[172:175], a[12:15], v[20:23]
  v_mfma_f32_16x16x32_bf16 v[20:23], a[176:179], a[16:19], v[20:23]
  v_mfma_f32_16x16x32_bf16 v[20:23], a[176:179], a[20:23], v[20:23]
  s_waitcnt lgkmcnt(8)
  v_mfma_f32_16x16x32_bf16 v[40:43], a[224:227], v[136:139], v[40:43]
  ds_read_b64_tr_b16 a[248:249], v6 offset:32
  v_mfma_f32_16x16x32_bf16 v[40:43], a[228:231], v[148:151], v[40:43]
  ds_read_b64_tr_b16 a[250:251], v6 offset:160
  v_mfma_f32_16x16x32_bf16 v[44:47], a[228:231], v[152:155], v[44:47]
  v_mfma_f32_16x16x32_bf16 v[44:47], a[224:227], v[140:143], v[44:47]
  ds_read_b64_tr_b16 a[252:253], v6 offset:288
  v_mfma_f32_16x16x32_bf16 v[48:51], a[224:227], v[144:147], v[48:51]
  ds_read_b64_tr_b16 a[254:255], v6 offset:416
  v_mfma_f32_16x16x32_bf16 v[48:51], a[228:231], v[156:159], v[48:51]
  s_waitcnt lgkmcnt(8)
  v_mfma_f32_16x16x32_bf16 v[48:51], a[236:239], v[180:183], v[48:51]
  ds_read_b64_tr_b16 a[224:225], v6 offset:64
  v_mfma_f32_16x16x32_bf16 v[48:51], a[232:235], v[168:171], v[48:51]
  ds_read_b64_tr_b16 a[226:227], v6 offset:192
  v_mfma_f32_16x16x32_bf16 v[44:47], a[232:235], v[164:167], v[44:47]
  v_mfma_f32_16x16x32_bf16 v[44:47], a[236:239], v[176:179], v[44:47]
  ds_read_b64_tr_b16 a[228:229], v6 offset:320
  v_mfma_f32_16x16x32_bf16 v[40:43], a[236:239], v[172:175], v[40:43]
  ds_read_b64_tr_b16 a[230:231], v6 offset:448
  v_mfma_f32_16x16x32_bf16 v[40:43], a[232:235], v[160:163], v[40:43]
  s_waitcnt lgkmcnt(8)
  v_mfma_f32_16x16x32_bf16 v[52:55], a[240:243], v[160:163], v[52:55]
  ds_read_b64_tr_b16 a[232:233], v6 offset:576
  v_mfma_f32_16x16x32_bf16 v[52:55], a[244:247], v[172:175], v[52:55]
  ds_read_b64_tr_b16 a[234:235], v6 offset:704
  v_mfma_f32_16x16x32_bf16 v[56:59], a[244:247], v[176:179], v[56:59]
  buffer_load_dword v24, v29, s[44:47], 0 offen sc1
  v_mfma_f32_16x16x32_bf16 v[56:59], a[240:243], v[164:167], v[56:59]
  ds_read_b64_tr_b16 a[236:237], v6 offset:832
  v_mfma_f32_16x16x32_bf16 v[60:63], a[240:243], v[168:171], v[60:63]
  ds_read_b64_tr_b16 a[238:239], v6 offset:960
  v_add_f32_dpp v20, v20, v20 row_ror:8 row_mask:0xc bank_mask:0xf
  v_mfma_f32_16x16x32_bf16 v[60:63], a[244:247], v[180:183], v[60:63]
  v_add_f32_dpp v21, v21, v21 row_ror:8 row_mask:0xc bank_mask:0xf
  s_waitcnt lgkmcnt(8)
  v_mfma_f32_16x16x32_bf16 v[60:63], a[252:255], v[156:159], v[60:63]
  ds_read_b64_tr_b16 a[240:241], v6 offset:608
  v_add_f32_dpp v22, v22, v22 row_ror:8 row_mask:0xc bank_mask:0xf
  v_mfma_f32_16x16x32_bf16 v[60:63], a[248:251], v[144:147], v[60:63]
  ds_read_b64_tr_b16 a[242:243], v6 offset:736
  v_add_f32_dpp v23, v23, v23 row_ror:8 row_mask:0xc bank_mask:0xf
  v_mfma_f32_16x16x32_bf16 v[56:59], a[248:251], v[140:143], v[56:59]
  v_cvt_pk_bf16_f32 v20, v20, v21
  v_cvt_pk_bf16_f32 v21, v22, v23
  v_mfma_f32_16x16x32_bf16 v[56:59], a[252:255], v[152:155], v[56:59]
  ds_read_b64_tr_b16 a[244:245], v6 offset:864
  buffer_store_dwordx2 v[20:21], v32, s[28:31], s57 offen offset:512
  v_mfma_f32_16x16x32_bf16 v[52:55], a[252:255], v[148:151], v[52:55]
  ds_read_b64_tr_b16 a[246:247], v6 offset:992
  v_mfma_f32_16x16x32_bf16 v[52:55], a[248:251], v[136:139], v[52:55]
  s_waitcnt lgkmcnt(8)
  v_mfma_f32_16x16x32_bf16 v[64:67], a[224:227], v[136:139], v[64:67]
  ds_read_b64_tr_b16 a[248:249], v6 offset:96
  v_mfma_f32_16x16x32_bf16 v[64:67], a[228:231], v[148:151], v[64:67]
  ds_read_b64_tr_b16 a[250:251], v6 offset:224
  v_mfma_f32_16x16x32_bf16 v[68:71], a[228:231], v[152:155], v[68:71]
  v_mfma_f32_16x16x32_bf16 v[68:71], a[224:227], v[140:143], v[68:71]
  ds_read_b64_tr_b16 a[252:253], v6 offset:352
  v_mfma_f32_16x16x32_bf16 v[72:75], a[224:227], v[144:147], v[72:75]
  ds_read_b64_tr_b16 a[254:255], v6 offset:480
  v_cvt_pk_bf16_f32 v232, v40, v41
  v_mfma_f32_16x16x32_bf16 v[72:75], a[228:231], v[156:159], v[72:75]
  v_cvt_pk_bf16_f32 v233, v42, v43
  s_waitcnt lgkmcnt(8)
  v_mfma_f32_16x16x32_bf16 v[72:75], a[236:239], v[180:183], v[72:75]
  v_cvt_pk_bf16_f32 v234, v52, v53
  v_cvt_pk_bf16_f32 v235, v54, v55
  v_mfma_f32_16x16x32_bf16 v[72:75], a[232:235], v[168:171], v[72:75]
  v_mfma_f32_16x16x32_bf16 v[68:71], a[232:235], v[164:167], v[68:71]
  s_waitcnt vmcnt(1)
  v_cmp_gt_u32 vcc, 6, v24
  s_cbranch_vccz L_go5
L_poll5:
  buffer_load_dword v24, v29, s[44:47], 0 offen sc1
  s_sub_u32 s39, s39, 1
  s_waitcnt vmcnt(0)
  v_cmp_gt_u32 vcc, 6, v24
  s_cbranch_scc1 L_giveup
  s_cbranch_vccnz L_poll5
L_go5:
  v_mfma_f32_16x16x32_bf16 v[68:71], a[236:239], v[176:179], v[68:71]
  v_cvt_pk_bf16_f32 v236, v44, v45
  v_cvt_pk_bf16_f32 v237, v46, v47
  v_mfma_f32_16x16x32_bf16 v[64:67], a[236:239], v[172:175], v[64:67]
  v_cvt_pk_bf16_f32 v238, v56, v57
  v_cvt_pk_bf16_f32 v239, v58, v59
  v_mfma_f32_16x16x32_bf16 v[64:67], a[232:235], v[160:163], v[64:67]
  buffer_load_dwordx4 a[32:35], v30, s[40:43], 0 offen sc1
  s_waitcnt lgkmcnt(4)
  v_mfma_f32_16x16x32_bf16 v[76:79], a[240:243], v[160:163], v[76:79]
  buffer_load_dwordx4 a[36:39], v30, s[40:43], s81 offen sc1
  buffer_store_dwordx4 v[232:235], v7, s[24:27], 0 offen
  v_cvt_pk_bf16_f32 v240, v48, v49
  v_mfma_f32_16x16x32_bf16 v[76:79], a[244:247], v[172:175], v[76:79]
  v_cvt_pk_bf16_f32 v241, v50, v51
  buffer_load_dwordx4 a[40:43], v30, s[40:43], s82 offen sc1
  v_mfma_f32_16x16x32_bf16 v[80:83], a[244:247], v[176:179], v[80:83]
  buffer_load_dwordx4 a[44:47], v30, s[40:43], s83 offen sc1
  v_cvt_pk_bf16_f32 v242, v60, v61
  v_mfma_f32_16x16x32_bf16 v[80:83], a[240:243], v[164:167], v[80:83]
  v_cvt_pk_bf16_f32 v243, v62, v63
  buffer_load_dwordx4 a[48:51], v31, s[40:43], 0 offen sc1
  buffer_store_dwordx4 v[236:239], v7, s[24:27], s77 offen
  v_mfma_f32_16x16x32_bf16 v[84:87], a[240:243], v[168:171], v[84:87]
  buffer_load_dwordx4 a[52:55], v31, s[40:43], s82 offen sc1
  v_add_u32 v30, 0xfffa0000, v30
  v_mfma_f32_16x16x32_bf16 v[84:87], a[244:247], v[180:183], v[84:87]
  v_add_u32 v31, 0xfffa0000, v31
  s_waitcnt lgkmcnt(0)
  v_mfma_f32_16x16x32_bf16 v[84:87], a[252:255], v[156:159], v[84:87]
  buffer_store_dwordx4 v[240:243], v7, s[24:27], s79 offen
  v_mfma_f32_16x16x32_bf16 v[84:87], a[248:251], v[144:147], v[84:87]
  v_mfma_f32_16x16x32_bf16 v[80:83], a[248:251], v[140:143], v[80:83]
  v_mfma_f32_16x16x32_bf16 v[80:83], a[252:255], v[152:155], v[80:83]
  v_mfma_f32_16x16x32_bf16 v[76:79], a[252:255], v[148:151], v[76:79]
  v_mfma_f32_16x16x32_bf16 v[76:79], a[248:251], v[136:139], v[76:79]
  s_nop 7
  v_cvt_pk_bf16_f32 v244, v64, v65
  v_cvt_pk_bf16_f32 v245, v66, v67
  v_cvt_pk_bf16_f32 v246, v76, v77
  v_cvt_pk_bf16_f32 v247, v78, v79
  buffer_store_dwordx4 v[244:247], v7, s[24:27], s76 offen
  v_cvt_pk_bf16_f32 v248, v68, v69
  v_cvt_pk_bf16_f32 v249, v70, v71
  v_cvt_pk_bf16_f32 v250, v80, v81
  v_cvt_pk_bf16_f32 v251, v82, v83
  buffer_store_dwordx4 v[248:251], v7, s[24:27], s78 offen
  v_cvt_pk_bf16_f32 v252, v72, v73
  v_cvt_pk_bf16_f32 v253, v74, v75
  v_cvt_pk_bf16_f32 v254, v84, v85
  v_cvt_pk_bf16_f32 v255, v86, v87
  buffer_store_dwordx4 v[252:255], v7, s[24:27], s80 offen
  s_waitcnt vmcnt(4)
  v_mfma_f32_16x16x32_bf16 v[20:23], a[172:175], a[32:35], 0
  v_mfma_f32_16x16x32_bf16 v[20:23], a[172:175], a[36:39], v[20:23]
  v_mfma_f32_16x16x32_bf16 v[20:23], a[172:175], a[40:43], v[20:23]
  v_mfma_f32_16x16x32_bf16 v[20:23], a[172:175], a[44:47], v[20:23]
  v_mfma_f32_16x16x32_bf16 v[20:23], a[176:179], a[48:51], v[20:23]
  v_mfma_f32_16x16x32_bf16 v[20:23], a[176:179], a[52:55], v[20:23]
  s_waitcnt vmcnt(0)
  v_mov_b32 v8, 7
  buffer_store_dword v8, v28, s[44:47], 0 offen
  buffer_load_dword v24, v29, s[44:47], 0 offen sc1
  s_waitcnt vmcnt(0)
  v_cmp_gt_u32 vcc, 7, v24
  s_cbranch_vccz L_go6
L_poll6:
  buffer_load_dword v24, v29, s[44:47], 0 offen sc1
  s_sub_u32 s39, s39, 1
  s_waitcnt vmcnt(0)
  v_cmp_gt_u32 vcc, 7, v24
  s_cbranch_scc1 L_giveup
  s_cbranch_vccnz L_poll6
L_go6:
  buffer_load_dwordx4 a[0:3], v30, s[40:43], 0 offen sc1
  buffer_load_dwordx4 a[4:7], v30, s[40:43], s81 offen sc1
  buffer_load_dwordx4 a[8:11], v30, s[40:43], s82 offen sc1
  buffer_load_dwordx4 a[12:15], v30, s[40:43], s83 offen sc1
  buffer_load_dwordx4 a[16:19], v31, s[40:43], 0 offen sc1
  buffer_load_dwordx4 a[20:23], v31, s[40:43], s82 offen sc1
  v_add_f32_dpp v20, v20, v20 row_ror:8 row_mask:0xc bank_mask:0xf
  v_add_f32_dpp v21, v21, v21 row_ror:8 row_mask:0xc bank_mask:0xf
  v_add_f32_dpp v22, v22, v22 row_ror:8 row_mask:0xc bank_mask:0xf
  v_add_f32_dpp v23, v23, v23 row_ror:8 row_mask:0xc bank_mask:0xf
  v_cvt_pk_bf16_f32 v20, v20, v21
  v_cvt_pk_bf16_f32 v21, v22, v23
  buffer_store_dwordx2 v[20:21], v32, s[28:31], s57 offen offset:640
  s_waitcnt vmcnt(6)
  v_mfma_f32_16x16x32_bf16 v[20:23], a[172:175], a[0:3], 0
  s_waitcnt vmcnt(5)
  v_mfma_f32_16x16x32_bf16 v[20:23], a[172:175], a[4:7], v[20:23]
  s_waitcnt vmcnt(4)
  v_mfma_f32_16x16x32_bf16 v[20:23], a[172:175], a[8:11], v[20:23]
  s_waitcnt vmcnt(3)
  v_mfma_f32_16x16x32_bf16 v[20:23], a[172:175], a[12:15], v[20:23]
  s_waitcnt vmcnt(2)
  v_mfma_f32_16x16x32_bf16 v[20:23], a[176:179], a[16:19], v[20:23]
  s_waitcnt vmcnt(1)
  v_mfma_f32_16x16x32_bf16 v[20:23], a[176:179], a[20:23], v[20:23]
  s_nop 7
  v_add_f32_dpp v20, v20, v20 row_ror:8 row_mask:0xc bank_mask:0xf
  v_add_f32_dpp v21, v21, v21 row_ror:8 row_mask:0xc bank_mask:0xf
  v_add_f32_dpp v22, v22, v22 row_ror:8 row_mask:0xc bank_mask:0xf
  v_add_f32_dpp v23, v23, v23 row_ror:8 row_mask:0xc bank_mask:0xf
  v_cvt_pk_bf16_f32 v20, v20, v21
  v_cvt_pk_bf16_f32 v21, v22, v23
  buffer_store_dwordx2 v[20:21], v32, s[28:31], s57 offen offset:768
L_fin:
L_giveup:
L_end:
  s_endpgm
L_hot_end:
L_notlocal:
  s_add_u32 s62, s60, s61
  s_mul_i32 s62, s62, 0x01010101
  s_lshr_b32 s62, s62, 24
  s_cmp_ge_u32 s62, 16
  s_cbranch_scc1 L_remote
  s_sub_u32 s39, s39, 1
  s_cbranch_scc1 L_giveup
  buffer_load_dwordx2 v[10:11], off, s[48:51], 0 sc1
  s_waitcnt vmcnt(0)
  v_readfirstlane_b32 s60, v10
  v_readfirstlane_b32 s61, v11
  s_nop 1
  s_branch L_regchk
L_remote:
  v_add_u32 v7, 786432, v7
  v_add_u32 v30, 786432, v30
  v_add_u32 v31, 786432, v31
  s_waitcnt lgkmcnt(8)
  v_mfma_f32_16x16x32_bf16 v[40:43], a[224:227], v[136:139], v[40:43]
  ds_read_b64_tr_b16 a[248:249], v6 offset:96
  v_mul_f32 v232, v232, v13
  v_mul_f32 v233, v233, v13
  v_mul_f32 v234, v234, v13
  v_mul_f32 v235, v235, v13
  v_mul_f32 v236, v236, v13
  v_mfma_f32_16x16x32_bf16 v[40:43], a[228:231], v[148:151], v[40:43]
  ds_read_b64_tr_b16 a[250:251], v6 offset:224
  v_mul_f32 v237, v237, v13
  v_mul_f32 v238, v238, v13
  v_mul_f32 v239, v239, v13
  v_cvt_pk_bf16_f32 v160, v232, v233
  v_cvt_pk_bf16_f32 v161, v234, v235
  v_mfma_f32_16x16x32_bf16 v[44:47], a[228:231], v[152:155], v[44:47]
  s_add_u32 m0, s33, 51168
  v_cvt_pk_bf16_f32 v162, v236, v237
  v_cvt_pk_bf16_f32 v163, v238, v239
  v_accvgpr_read_b32 v240, a96
  v_accvgpr_read_b32 v241, a97
  v_accvgpr_read_b32 v242, a98
  v_mfma_f32_16x16x32_bf16 v[44:47], a[224:227], v[140:143], v[44:47]
  buffer_load_dwordx4 v2, s[20:23], s71 offen offset:2688 lds
  ds_read_b64_tr_b16 a[252:253], v6 offset:352
  v_accvgpr_read_b32 v243, a99
  v_mul_f32 v240, v240, v14
  v_mul_f32 v241, v241, v14
  v_mul_f32 v242, v242, v14
  v_mfma_f32_16x16x32_bf16 v[48:51], a[224:227], v[144:147], v[48:51]
  ds_read_b64_tr_b16 a[254:255], v6 offset:480
  v_mul_f32 v243, v243, v14
  v_accvgpr_read_b32 v244, a100
  v_accvgpr_read_b32 v245, a101
  v_accvgpr_read_b32 v246, a102
  v_accvgpr_read_b32 v247, a103
  v_mfma_f32_16x16x32_bf16 v[48:51], a[228:231], v[156:159], v[48:51]
  v_mul_f32 v244, v244, v14
  v_mul_f32 v245, v245, v14
  v_mul_f32 v246, v246, v14
  v_mul_f32 v247, v247, v14
  v_cvt_pk_bf16_f32 v164, v240, v241
  s_waitcnt lgkmcnt(8)
  v_mfma_f32_16x16x32_bf16 v[60:63], a[236:239], v[156:159], v[60:63]
  ds_read_b64_tr_b16 a[224:225], v6 offset:512
  v_cvt_pk_bf16_f32 v165, v242, v243
  v_cvt_pk_bf16_f32 v166, v244, v245
  v_cvt_pk_bf16_f32 v167, v246, v247
  v_accvgpr_read_b32 v248, a104
  v_accvgpr_read_b32 v249, a105
  v_mfma_f32_16x16x32_bf16 v[60:63], a[232:235], v[144:147], v[60:63]
  ds_read_b64_tr_b16 a[226:227], v6 offset:640
  v_accvgpr_read_b32 v250, a106
  v_accvgpr_read_b32 v251, a107
  v_mul_f32 v248, v248, v15
  v_mul_f32 v249, v249, v15
  v_mul_f32 v250, v250, v15
  v_mfma_f32_16x16x32_bf16 v[56:59], a[232:235], v[140:143], v[56:59]
  s_add_u32 s58, s69, 393216
  buffer_load_dword a182, v9, s[40:43], s58 offen
  v_mul_f32 v251, v251, v15
  v_accvgpr_read_b32 v252, a108
  v_accvgpr_read_b32 v253, a109
  v_accvgpr_read_b32 v254, a110
  v_accvgpr_read_b32 v255, a111
  v_mfma_f32_16x16x32_bf16 v[56:59], a[236:239], v[152:155], v[56:59]
  ds_read_b64_tr_b16 a[228:229], v6 offset:768
  v_mul_f32 v252, v252, v15
  v_mul_f32 v253, v253, v15
  v_mul_f32 v254, v254, v15
  v_mul_f32 v255, v255, v15
  v_cvt_pk_bf16_f32 v168, v248, v249
  v_mfma_f32_16x16x32_bf16 v[52:55], a[236:239], v[148:151], v[52:55]
  ds_read_b64_tr_b16 a[230:231], v6 offset:896
  v_cvt_pk_bf16_f32 v169, v250, v251
  v_cvt_pk_bf16_f32 v170, v252, v253
  v_cvt_pk_bf16_f32 v171, v254, v255
  v_accvgpr_read_b32 v232, a112
  v_accvgpr_read_b32 v233, a113
  v_mfma_f32_16x16x32_bf16 v[52:55], a[232:235], v[136:139], v[52:55]
  v_accvgpr_read_b32 v234, a114
  v_accvgpr_read_b32 v235, a115
  v_mul_f32 v232, v232, v13
  v_mul_f32 v233, v233, v13
  v_mul_f32 v234, v234, v13
  s_waitcnt lgkmcnt(8)
  v_mfma_f32_16x16x32_bf16 v[64:67], a[240:243], v[136:139], v[64:67]
  ds_read_b64_tr_b16 a[232:233], v6 offset:544
  v_mul_f32 v235, v235, v13
  v_accvgpr_read_b32 v236, a116
  v_accvgpr_read_b32 v237, a117
  v_accvgpr_read_b32 v238, a118
  v_accvgpr_read_b32 v239, a119
  v_mfma_f32_16x16x32_bf16 v[64:67], a[244:247], v[148:151], v[64:67]
  ds_read_b64_tr_b16 a[234:235], v6 offset:672
  v_mul_f32 v236, v236, v13
  v_mul_f32 v237, v237, v13
  v_mul_f32 v238, v238, v13
  v_mul_f32 v239, v239, v13
  v_cvt_pk_bf16_f32 v172, v232, v233
  v_mfma_f32_16x16x32_bf16 v[68:71], a[244:247], v[152:155], v[68:71]
  v_cvt_pk_bf16_f32 v173, v234, v235
  v_cvt_pk_bf16_f32 v174, v236, v237
  v_cvt_pk_bf16_f32 v175, v238, v239
  v_accvgpr_read_b32 v240, a120
  v_accvgpr_read_b32 v241, a121
  v_accvgpr_read_b32 v242, a122
  v_mfma_f32_16x16x32_bf16 v[68:71], a[240:243], v[140:143], v[68:71]
  ds_read_b64_tr_b16 a[236:237], v6 offset:800
  v_accvgpr_read_b32 v243, a123
  v_mul_f32 v240, v240, v14
  v_mul_f32 v241, v241, v14
  v_mul_f32 v242, v242, v14
  v_mul_f32 v243, v243, v14
  v_mfma_f32_16x16x32_bf16 v[72:75], a[240:243], v[144:147], v[72:75]
  ds_read_b64_tr_b16 a[238:239], v6 offset:928
  v_accvgpr_read_b32 v244, a124
  v_accvgpr_read_b32 v245, a125
  v_accvgpr_read_b32 v246, a126
  v_accvgpr_read_b32 v247, a127
  v_mul_f32 v244, v244, v14
  v_mfma_f32_16x16x32_bf16 v[72:75], a[244:247], v[156:159], v[72:75]
  v_mul_f32 v245, v245, v14
  v_mul_f32 v246, v246, v14
  v_mul_f32 v247, v247, v14
  v_cvt_pk_bf16_f32 v176, v240, v241
  v_cvt_pk_bf16_f32 v177, v242, v243
  v_cvt_pk_bf16_f32 v178, v244, v245
  s_waitcnt lgkmcnt(8)
  v_mfma_f32_16x16x32_bf16 v[84:87], a[252:255], v[156:159], v[84:87]
  ds_read_b64_tr_b16 a[240:241], v6 offset:576
  v_cvt_pk_bf16_f32 v179, v246, v247
  v_accvgpr_read_b32 v248, a128
  v_accvgpr_read_b32 v249, a129
  v_accvgpr_read_b32 v250, a130
  v_accvgpr_read_b32 v251, a131
  v_mfma_f32_16x16x32_bf16 v[84:87], a[248:251], v[144:147], v[84:87]
  ds_read_b64_tr_b16 a[242:243], v6 offset:704
  v_mul_f32 v248, v248, v15
  v_mul_f32 v249, v249, v15
  v_mul_f32 v250, v250, v15
  v_mul_f32 v251, v251, v15
  v_accvgpr_read_b32 v252, a132
  v_mfma_f32_16x16x32_bf16 v[80:83], a[248:251], v[140:143], v[80:83]
  v_accvgpr_read_b32 v253, a133
  v_accvgpr_read_b32 v254, a134
  v_accvgpr_read_b32 v255, a135
  v_mul_f32 v252, v252, v15
  v_mul_f32 v253, v253, v15
  v_mul_f32 v254, v254, v15
  v_mfma_f32_16x16x32_bf16 v[80:83], a[252:255], v[152:155], v[80:83]
  ds_read_b64_tr_b16 a[244:245], v6 offset:832
  v_mul_f32 v255, v255, v15
  v_cvt_pk_bf16_f32 v180, v248, v249
  v_cvt_pk_bf16_f32 v181, v250, v251
  v_cvt_pk_bf16_f32 v182, v252, v253
  v_cvt_pk_bf16_f32 v183, v254, v255
  v_mfma_f32_16x16x32_bf16 v[76:79], a[252:255], v[148:151], v[76:79]
  ds_read_b64_tr_b16 a[246:247], v6 offset:960
  v_mfma_f32_16x16x32_bf16 v[76:79], a[248:251], v[136:139], v[76:79]
  s_waitcnt lgkmcnt(8)
  v_mfma_f32_16x16x32_bf16 v[40:43], a[224:227], v[160:163], v[40:43]
  ds_read_b64_tr_b16 a[248:249], v6 offset:608
  v_mfma_f32_16x16x32_bf16 v[40:43], a[228:231], v[172:175], v[40:43]
  ds_read_b64_tr_b16 a[250:251], v6 offset:736
  v_mfma_f32_16x16x32_bf16 v[44:47], a[228:231], v[176:179], v[44:47]
  v_mfma_f32_16x16x32_bf16 v[44:47], a[224:227], v[164:167], v[44:47]
  ds_read_b64_tr_b16 a[252:253], v6 offset:864
  v_mfma_f32_16x16x32_bf16 v[48:51], a[224:227], v[168:171], v[48:51]
  ds_read_b64_tr_b16 a[254:255], v6 offset:992
  v_mfma_f32_16x16x32_bf16 v[48:51], a[228:231], v[180:183], v[48:51]
  s_waitcnt lgkmcnt(8)
  v_mfma_f32_16x16x32_bf16 v[60:63], a[236:239], v[180:183], v[60:63]
  s_waitcnt vmcnt(63)
  s_barrier
  v_mfma_f32_16x16x32_bf16 v[60:63], a[232:235], v[168:171], v[60:63]
  v_add_u32 v6, 101376, v5
  ds_read_b64_tr_b16 a[224:225], v6 offset:0
  v_mfma_f32_16x16x32_bf16 v[56:59], a[232:235], v[164:167], v[56:59]
  ds_read_b64_tr_b16 a[226:227], v6 offset:128
  s_add_u32 m0, s33, 67584
  s_mov_b32 s71, 115200
  v_mfma_f32_16x16x32_bf16 v[56:59], a[236:239], v[176:179], v[56:59]
  buffer_load_dwordx4 v2, s[20:23], s71 offen offset:0 lds
  ds_read_b64_tr_b16 a[228:229], v6 offset:256
  v_mfma_f32_16x16x32_bf16 v[52:55], a[236:239], v[172:175], v[52:55]
  ds_read_b64_tr_b16 a[230:231], v6 offset:384
  v_mfma_f32_16x16x32_bf16 v[52:55], a[232:235], v[160:163], v[52:55]
  s_waitcnt lgkmcnt(8)
  v_mfma_f32_16x16x32_bf16 v[64:67], a[240:243], v[160:163], v[64:67]
  ds_read_b64_tr_b16 a[232:233], v6 offset:512
  v_mfma_f32_16x16x32_bf16 v[64:67], a[244:247], v[172:175], v[64:67]
  ds_read_b64_tr_b16 a[234:235], v6 offset:640
  v_mfma_f32_16x16x32_bf16 v[68:71], a[244:247], v[176:179], v[68:71]
  s_add_u32 m0, s33, 67744
  v_mfma_f32_16x16x32_bf16 v[68:71], a[240:243], v[164:167], v[68:71]
  buffer_load_dwordx4 v2, s[20:23], s71 offen offset:896 lds
  ds_read_b64_tr_b16 a[236:237], v6 offset:768
  v_mfma_f32_16x16x32_bf16 v[72:75], a[240:243], v[168:171], v[72:75]
  ds_read_b64_tr_b16 a[238:239], v6 offset:896
  v_cvt_pk_bf16_f32 v232, v40, v41
  v_cvt_pk_bf16_f32 v233, v42, v43
  v_mfma_f32_16x16x32_bf16 v[72:75], a[244:247], v[180:183], v[72:75]
  s_waitcnt lgkmcnt(8)
  v_mfma_f32_16x16x32_bf16 v[84:87], a[252:255], v[180:183], v[84:87]
  ds_read_b64_tr_b16 a[240:241], v6 offset:544
  v_cvt_pk_bf16_f32 v234, v52, v53
  v_cvt_pk_bf16_f32 v235, v54, v55
  v_mfma_f32_16x16x32_bf16 v[84:87], a[248:251], v[168:171], v[84:87]
  ds_read_b64_tr_b16 a[242:243], v6 offset:672
  v_mfma_f32_16x16x32_bf16 v[80:83], a[248:251], v[164:167], v[80:83]
  s_add_u32 m0, s33, 67904
  buffer_store_dwordx4 v[232:235], v7, s[24:27], 0 offen sc1
  v_cvt_pk_bf16_f32 v236, v44, v45
  v_cvt_pk_bf16_f32 v237, v46, v47
  v_mfma_f32_16x16x32_bf16 v[80:83], a[252:255], v[176:179], v[80:83]
  buffer_load_dwordx4 v2, s[20:23], s71 offen offset:1792 lds
  ds_read_b64_tr_b16 a[244:245], v6 offset:800
  v_mfma_f32_16x16x32_bf16 v[76:79], a[252:255], v[172:175], v[76:79]
  ds_read_b64_tr_b16 a[246:247], v6 offset:928
  v_cvt_pk_bf16_f32 v238, v56, v57
  v_mfma_f32_16x16x32_bf16 v[76:79], a[248:251], v[160:163], v[76:79]
  v_cvt_pk_bf16_f32 v239, v58, v59
  s_waitcnt lgkmcnt(8)
  v_mfma_f32_16x16x32_bf16 v[184:187], a[224:227], v[88:91], 0
  ds_read_b64_tr_b16 a[248:249], v6 offset:32
  buffer_store_dwordx4 v[236:239], v7, s[24:27], s77 offen sc1
  v_mfma_f32_16x16x32_bf16 v[184:187], a[228:231], v[100:103], v[184:187]
  ds_read_b64_tr_b16 a[250:251], v6 offset:160
  v_cvt_pk_bf16_f32 v240, v48, v49
  v_cvt_pk_bf16_f32 v241, v50, v51
  v_mfma_f32_16x16x32_bf16 v[188:191], a[228:231], v[104:107], 0
  s_add_u32 m0, s33, 68064
  v_cvt_pk_bf16_f32 v242, v60, v61
  v_cvt_pk_bf16_f32 v243, v62, v63
  v_mfma_f32_16x16x32_bf16 v[188:191], a[224:227], v[92:95], v[188:191]
  buffer_load_dwordx4 v2, s[20:23], s71 offen offset:2688 lds
  ds_read_b64_tr_b16 a[252:253], v6 offset:288
  v_mfma_f32_16x16x32_bf16 v[192:195], a[224:227], v[96:99], 0
  ds_read_b64_tr_b16 a[254:255], v6 offset:416
  buffer_store_dwordx4 v[240:243], v7, s[24:27], s79 offen sc1
  v_mfma_f32_16x16x32_bf16 v[192:195], a[228:231], v[108:111], v[192:195]
  v_cvt_pk_bf16_f32 v244, v64, v65
  v_cvt_pk_bf16_f32 v245, v66, v67
  s_waitcnt lgkmcnt(8)
  v_mfma_f32_16x16x32_bf16 v[192:195], a[236:239], v[132:135], v[192:195]
  ds_read_b64_tr_b16 a[224:225], v6 offset:64
  v_cvt_pk_bf16_f32 v246, v76, v77
  v_mfma_f32_16x16x32_bf16 v[192:195], a[232:235], v[120:123], v[192:195]
  ds_read_b64_tr_b16 a[226:227], v6 offset:192
  v_cvt_pk_bf16_f32 v247, v78, v79
  v_mfma_f32_16x16x32_bf16 v[188:191], a[232:235], v[116:119], v[188:191]
  buffer_store_dwordx4 v[244:247], v7, s[24:27], s76 offen sc1
  v_cvt_pk_bf16_f32 v248, v68, v69
  v_cvt_pk_bf16_f32 v249, v70, v71
  v_mfma_f32_16x16x32_bf16 v[188:191], a[236:239], v[128:131], v[188:191]
  ds_read_b64_tr_b16 a[228:229], v6 offset:320
  v_mfma_f32_16x16x32_bf16 v[184:187], a[236:239], v[124:127], v[184:187]
  ds_read_b64_tr_b16 a[230:231], v6 offset:448
  v_cvt_pk_bf16_f32 v250, v80, v81
  v_mfma_f32_16x16x32_bf16 v[184:187], a[232:235], v[112:115], v[184:187]
  v_cvt_pk_bf16_f32 v251, v82, v83
  s_waitcnt lgkmcnt(8)
  v_mfma_f32_16x16x32_bf16 v[196:199], a[240:243], v[112:115], 0
  ds_read_b64_tr_b16 a[232:233], v6 offset:576
  buffer_store_dwordx4 v[248:251], v7, s[24:27], s78 offen sc1
  v_cvt_pk_bf16_f32 v252, v72, v73
  v_mfma_f32_16x16x32_bf16 v[196:199], a[244:247], v[124:127], v[196:199]
  ds_read_b64_tr_b16 a[234:235], v6 offset:704
  v_cvt_pk_bf16_f32 v253, v74, v75
  v_mfma_f32_16x16x32_bf16 v[200:203], a[244:247], v[128:131], 0
  v_cvt_pk_bf16_f32 v254, v84, v85
  v_cvt_pk_bf16_f32 v255, v86, v87
  v_mfma_f32_16x16x32_bf16 v[200:203], a[240:243], v[116:119], v[200:203]
  ds_read_b64_tr_b16 a[236:237], v6 offset:832
  v_mfma_f32_16x16x32_bf16 v[204:207], a[240:243], v[120:123], 0
  ds_read_b64_tr_b16 a[238:239], v6 offset:960
  buffer_store_dwordx4 v[252:255], v7, s[24:27], s80 offen sc1
  v_mfma_f32_16x16x32_bf16 v[204:207], a[244:247], v[132:135], v[204:207]
  v_add_u32 v7, 0x60000, v7
  s_waitcnt lgkmcnt(8)
  v_mfma_f32_16x16x32_bf16 v[204:207], a[252:255], v[108:111], v[204:207]
  ds_read_b64_tr_b16 a[240:241], v6 offset:608
  v_mfma_f32_16x16x32_bf16 v[204:207], a[248:251], v[96:99], v[204:207]
  ds_read_b64_tr_b16 a[242:243], v6 offset:736
  v_mfma_f32_16x16x32_bf16 v[200:203], a[248:251], v[92:95], v[200:203]
  v_mfma_f32_16x16x32_bf16 v[200:203], a[252:255], v[104:107], v[200:203]
  ds_read_b64_tr_b16 a[244:245], v6 offset:864
  v_mfma_f32_16x16x32_bf16 v[196:199], a[252:255], v[100:103], v[196:199]
  ds_read_b64_tr_b16 a[246:247], v6 offset:992
  v_mfma_f32_16x16x32_bf16 v[196:199], a[248:251], v[88:91], v[196:199]
  s_waitcnt lgkmcnt(8)
  v_mfma_f32_16x16x32_bf16 v[208:211], a[224:227], v[88:91], 0
  ds_read_b64_tr_b16 a[248:249], v6 offset:96
  v_mfma_f32_16x16x32_bf16 v[208:211], a[228:231], v[100:103], v[208:211]
  ds_read_b64_tr_b16 a[250:251], v6 offset:224
  v_mfma_f32_16x16x32_bf16 v[212:215], a[228:231], v[104:107], 0
  v_mfma_f32_16x16x32_bf16 v[212:215], a[224:227], v[92:95], v[212:215]
  ds_read_b64_tr_b16 a[252:253], v6 offset:352
  v_mfma_f32_16x16x32_bf16 v[216:219], a[224:227], v[96:99], 0
  ds_read_b64_tr_b16 a[254:255], v6 offset:480
  v_mfma_f32_16x16x32_bf16 v[216:219], a[228:231], v[108:111], v[216:219]
  s_waitcnt lgkmcnt(8)
  v_mfma_f32_16x16x32_bf16 v[216:219], a[236:239], v[132:135], v[216:219]
  s_waitcnt vmcnt(63)
  s_barrier
  v_mfma_f32_16x16x32_bf16 v[216:219], a[232:235], v[120:123], v[216:219]
  v_add_u32 v6, 118272, v5
  ds_read_b64_tr_b16 a[224:225], v6 offset:0
  v_mfma_f32_16x16x32_bf16 v[212:215], a[232:235], v[116:119], v[212:215]
  ds_read_b64_tr_b16 a[226:227], v6 offset:128
  s_add_u32 m0, s33, 135168
  s_mov_b32 s71, 640
  v_mfma_f32_16x16x32_bf16 v[212:215], a[236:239], v[128:131], v[212:215]
  buffer_load_dwordx4 v2, s[20:23], s71 offen offset:0 lds
  ds_read_b64_tr_b16 a[228:229], v6 offset:256
  v_mfma_f32_16x16x32_bf16 v[208:211], a[236:239], v[124:127], v[208:211]
  ds_read_b64_tr_b16 a[230:231], v6 offset:384
  v_mfma_f32_16x16x32_bf16 v[208:211], a[232:235], v[112:115], v[208:211]
  s_waitcnt lgkmcnt(8)
  v_mfma_f32_16x16x32_bf16 v[220:223], a[240:243], v[112:115], 0
  ds_read_b64_tr_b16 a[232:233], v6 offset:512
  v_mfma_f32_16x16x32_bf16 v[220:223], a[244:247], v[124:127], v[220:223]
  ds_read_b64_tr_b16 a[234:235], v6 offset:640
  v_mfma_f32_16x16x32_bf16 v[224:227], a[244:247], v[128:131], 0
  s_add_u32 m0, s33, 135328
  v_mfma_f32_16x16x32_bf16 v[224:227], a[240:243], v[116:119], v[224:227]
  buffer_load_dwordx4 v2, s[20:23], s71 offen offset:896 lds
  ds_read_b64_tr_b16 a[236:237], v6 offset:768
  v_mfma_f32_16x16x32_bf16 v[228:231], a[240:243], v[120:123], 0
  ds_read_b64_tr_b16 a[238:239], v6 offset:896
  v_mfma_f32_16x16x32_bf16 v[228:231], a[244:247], v[132:135], v[228:231]
  s_waitcnt lgkmcnt(8)
  v_mfma_f32_16x16x32_bf16 v[228:231], a[252:255], v[108:111], v[228:231]
  ds_read_b64_tr_b16 a[240:241], v6 offset:544
  v_mfma_f32_16x16x32_bf16 v[228:231], a[248:251], v[96:99], v[228:231]
  ds_read_b64_tr_b16 a[242:243], v6 offset:672
  v_mfma_f32_16x16x32_bf16 v[224:227], a[248:251], v[92:95], v[224:227]
  s_add_u32 m0, s33, 135488
  v_mfma_f32_16x16x32_bf16 v[224:227], a[252:255], v[104:107], v[224:227]
  buffer_load_dwordx4 v2, s[20:23], s71 offen offset:1792 lds
  ds_read_b64_tr_b16 a[244:245], v6 offset:800
  v_mfma_f32_16x16x32_bf16 v[220:223], a[252:255], v[100:103], v[220:223]
  ds_read_b64_tr_b16 a[246:247], v6 offset:928
  s_waitcnt vmcnt(3)
  v_mfma_f32_16x16x32_bf16 v[220:223], a[248:251], v[88:91], v[220:223]
  v_mov_b32 v8, 1
  buffer_store_dword v8, v28, s[44:47], 0 offen sc1
  s_waitcnt lgkmcnt(8)
  v_mfma_f32_16x16x32_bf16 v[184:187], a[224:227], v[136:139], v[184:187]
  ds_read_b64_tr_b16 a[248:249], v6 offset:32
  v_mfma_f32_16x16x32_bf16 v[184:187], a[228:231], v[148:151], v[184:187]
  ds_read_b64_tr_b16 a[250:251], v6 offset:160
  v_mfma_f32_16x16x32_bf16 v[188:191], a[228:231], v[152:155], v[188:191]
  s_add_u32 m0, s33, 135648
  v_mfma_f32_16x16x32_bf16 v[188:191], a[224:227], v[140:143], v[188:191]
  buffer_load_dwordx4 v2, s[20:23], s71 offen offset:2688 lds
  ds_read_b64_tr_b16 a[252:253], v6 offset:288
  v_mfma_f32_16x16x32_bf16 v[192:195], a[224:227], v[144:147], v[192:195]
  ds_read_b64_tr_b16 a[254:255], v6 offset:416
  v_mfma_f32_16x16x32_bf16 v[192:195], a[228:231], v[156:159], v[192:195]
  s_waitcnt lgkmcnt(8)
  v_mfma_f32_16x16x32_bf16 v[192:195], a[236:239], v[180:183], v[192:195]
  ds_read_b64_tr_b16 a[224:225], v6 offset:64
  v_mfma_f32_16x16x32_bf16 v[192:195], a[232:235], v[168:171], v[192:195]
  ds_read_b64_tr_b16 a[226:227], v6 offset:192
  v_mfma_f32_16x16x32_bf16 v[188:191], a[232:235], v[164:167], v[188:191]
  v_mfma_f32_16x16x32_bf16 v[188:191], a[236:239], v[176:179], v[188:191]
  ds_read_b64_tr_b16 a[228:229], v6 offset:320
  v_mfma_f32_16x16x32_bf16 v[184:187], a[236:239], v[172:175], v[184:187]
  ds_read_b64_tr_b16 a[230:231], v6 offset:448
  v_mfma_f32_16x16x32_bf16 v[184:187], a[232:235], v[160:163], v[184:187]
  s_waitcnt lgkmcnt(8)
  v_mfma_f32_16x16x32_bf16 v[196:199], a[240:243], v[160:163], v[196:199]
  ds_read_b64_tr_b16 a[232:233], v6 offset:576
  v_mfma_f32_16x16x32_bf16 v[196:199], a[244:247], v[172:175], v[196:199]
  ds_read_b64_tr_b16 a[234:235], v6 offset:704
  v_mfma_f32_16x16x32_bf16 v[200:203], a[244:247], v[176:179], v[200:203]
  buffer_load_dword v24, v29, s[44:47], 0 offen sc1
  v_mfma_f32_16x16x32_bf16 v[200:203], a[240:243], v[164:167], v[200:203]
  ds_read_b64_tr_b16 a[236:237], v6 offset:832
  v_mfma_f32_16x16x32_bf16 v[204:207], a[240:243], v[168:171], v[204:207]
  ds_read_b64_tr_b16 a[238:239], v6 offset:960
  v_mfma_f32_16x16x32_bf16 v[204:207], a[244:247], v[180:183], v[204:207]
  s_waitcnt lgkmcnt(8)
  v_mfma_f32_16x16x32_bf16 v[204:207], a[252:255], v[156:159], v[204:207]
  ds_read_b64_tr_b16 a[240:241], v6 offset:608
  v_mfma_f32_16x16x32_bf16 v[204:207], a[248:251], v[144:147], v[204:207]
  ds_read_b64_tr_b16 a[242:243], v6 offset:736
  v_mfma_f32_16x16x32_bf16 v[200:203], a[248:251], v[140:143], v[200:203]
  v_mfma_f32_16x16x32_bf16 v[200:203], a[252:255], v[152:155], v[200:203]
  ds_read_b64_tr_b16 a[244:245], v6 offset:864
  v_mfma_f32_16x16x32_bf16 v[196:199], a[252:255], v[148:151], v[196:199]
  ds_read_b64_tr_b16 a[246:247], v6 offset:992
  v_mfma_f32_16x16x32_bf16 v[196:199], a[248:251], v[136:139], v[196:199]
  s_waitcnt lgkmcnt(8)
  v_mfma_f32_16x16x32_bf16 v[208:211], a[224:227], v[136:139], v[208:211]
  ds_read_b64_tr_b16 a[248:249], v6 offset:96
  v_mfma_f32_16x16x32_bf16 v[208:211], a[228:231], v[148:151], v[208:211]
  ds_read_b64_tr_b16 a[250:251], v6 offset:224
  v_mfma_f32_16x16x32_bf16 v[212:215], a[228:231], v[152:155], v[212:215]
  v_mfma_f32_16x16x32_bf16 v[212:215], a[224:227], v[140:143], v[212:215]
  ds_read_b64_tr_b16 a[252:253], v6 offset:352
  v_mfma_f32_16x16x32_bf16 v[216:219], a[224:227], v[144:147], v[216:219]
  ds_read_b64_tr_b16 a[254:255], v6 offset:480
  v_cvt_pk_bf16_f32 v232, v184, v185
  v_cvt_pk_bf16_f32 v233, v186, v187
  v_mfma_f32_16x16x32_bf16 v[216:219], a[228:231], v[156:159], v[216:219]
  s_waitcnt lgkmcnt(8)
  v_mfma_f32_16x16x32_bf16 v[216:219], a[236:239], v[180:183], v[216:219]
  v_cvt_pk_bf16_f32 v234, v196, v197
  v_cvt_pk_bf16_f32 v235, v198, v199
  v_mfma_f32_16x16x32_bf16 v[216:219], a[232:235], v[168:171], v[216:219]
  v_add_u32 v6, 84480, v5
  ds_read_b64_tr_b16 a[224:225], v6 offset:0
  v_mfma_f32_16x16x32_bf16 v[212:215], a[232:235], v[164:167], v[212:215]
  ds_read_b64_tr_b16 a[226:227], v6 offset:128
  s_waitcnt vmcnt(0)
  v_cmp_gt_u32 vcc, 1, v24
  s_cbranch_vccz L_go7
L_poll7:
  buffer_load_dword v24, v29, s[44:47], 0 offen sc1
  s_sub_u32 s39, s39, 1
  s_waitcnt vmcnt(0)
  v_cmp_gt_u32 vcc, 1, v24
  s_cbranch_scc1 L_giveup
  s_cbranch_vccnz L_poll7
L_go7:
  v_mfma_f32_16x16x32_bf16 v[212:215], a[236:239], v[176:179], v[212:215]
  ds_read_b64_tr_b16 a[228:229], v6 offset:256
  v_cvt_pk_bf16_f32 v236, v188, v189
  v_cvt_pk_bf16_f32 v237, v190, v191
  v_mfma_f32_16x16x32_bf16 v[208:211], a[236:239], v[172:175], v[208:211]
  ds_read_b64_tr_b16 a[230:231], v6 offset:384
  v_cvt_pk_bf16_f32 v238, v200, v201
  v_cvt_pk_bf16_f32 v239, v202, v203
  v_mfma_f32_16x16x32_bf16 v[208:211], a[232:235], v[160:163], v[208:211]
  buffer_load_dwordx4 a[0:3], v30, s[40:43], 0 offen sc1
  s_waitcnt lgkmcnt(8)
  v_mfma_f32_16x16x32_bf16 v[220:223], a[240:243], v[160:163], v[220:223]
  ds_read_b64_tr_b16 a[232:233], v6 offset:512
  buffer_store_dwordx4 v[232:235], v7, s[24:27], 0 offen sc1
  v_mfma_f32_16x16x32_bf16 v[220:223], a[244:247], v[172:175], v[220:223]
  ds_read_b64_tr_b16 a[234:235], v6 offset:640
  v_cvt_pk_bf16_f32 v240, v192, v193
  v_cvt_pk_bf16_f32 v241, v194, v195
  v_mfma_f32_16x16x32_bf16 v[224:227], a[244:247], v[176:179], v[224:227]
  v_cvt_pk_bf16_f32 v242, v204, v205
  v_cvt_pk_bf16_f32 v243, v206, v207
  v_mfma_f32_16x16x32_bf16 v[224:227], a[240:243], v[164:167], v[224:227]
  ds_read_b64_tr_b16 a[236:237], v6 offset:768
  v_mfma_f32_16x16x32_bf16 v[228:231], a[240:243], v[168:171], v[228:231]
  ds_read_b64_tr_b16 a[238:239], v6 offset:896
  v_mfma_f32_16x16x32_bf16 v[228:231], a[244:247], v[180:183], v[228:231]
  buffer_load_dwordx4 a[4:7], v30, s[40:43], s81 offen sc1
  s_waitcnt lgkmcnt(8)
  v_mfma_f32_16x16x32_bf16 v[228:231], a[252:255], v[156:159], v[228:231]
  ds_read_b64_tr_b16 a[240:241], v6 offset:544
  buffer_store_dwordx4 v[236:239], v7, s[24:27], s77 offen sc1
  v_mfma_f32_16x16x32_bf16 v[228:231], a[248:251], v[144:147], v[228:231]
  ds_read_b64_tr_b16 a[242:243], v6 offset:672
  v_mfma_f32_16x16x32_bf16 v[224:227], a[248:251], v[140:143], v[224:227]
  v_mfma_f32_16x16x32_bf16 v[224:227], a[252:255], v[152:155], v[224:227]
  ds_read_b64_tr_b16 a[244:245], v6 offset:800
  v_mfma_f32_16x16x32_bf16 v[220:223], a[252:255], v[148:151], v[220:223]
  ds_read_b64_tr_b16 a[246:247], v6 offset:928
  v_mfma_f32_16x16x32_bf16 v[220:223], a[248:251], v[136:139], v[220:223]
  buffer_load_dwordx4 a[8:11], v30, s[40:43], s82 offen sc1
  s_waitcnt lgkmcnt(8)
  v_mfma_f32_16x16x32_bf16 v[40:43], a[224:227], v[88:91], 0
  ds_read_b64_tr_b16 a[248:249], v6 offset:32
  buffer_store_dwordx4 v[240:243], v7, s[24:27], s79 offen sc1
  v_mfma_f32_16x16x32_bf16 v[40:43], a[228:231], v[100:103], v[40:43]
  ds_read_b64_tr_b16 a[250:251], v6 offset:160
  v_mfma_f32_16x16x32_bf16 v[44:47], a[228:231], v[104:107], 0
  v_cvt_pk_bf16_f32 v244, v208, v209
  v_cvt_pk_bf16_f32 v245, v210, v211
  v_mfma_f32_16x16x32_bf16 v[44:47], a[224:227], v[92:95], v[44:47]
  ds_read_b64_tr_b16 a[252:253], v6 offset:288
  v_mfma_f32_16x16x32_bf16 v[48:51], a[224:227], v[96:99], 0
  ds_read_b64_tr_b16 a[254:255], v6 offset:416
  v_cvt_pk_bf16_f32 v246, v220, v221
  v_cvt_pk_bf16_f32 v247, v222, v223
  v_mfma_f32_16x16x32_bf16 v[48:51], a[228:231], v[108:111], v[48:51]
  buffer_load_dwordx4 a[12:15], v30, s[40:43], s83 offen sc1
  s_waitcnt lgkmcnt(8)
  v_mfma_f32_16x16x32_bf16 v[48:51], a[236:239], v[132:135], v[48:51]
  ds_read_b64_tr_b16 a[224:225], v6 offset:64
  buffer_store_dwordx4 v[244:247], v7, s[24:27], s76 offen sc1
  v_cvt_pk_bf16_f32 v248, v212, v213
  v_mfma_f32_16x16x32_bf16 v[48:51], a[232:235], v[120:123], v[48:51]
  ds_read_b64_tr_b16 a[226:227], v6 offset:192
  v_cvt_pk_bf16_f32 v249, v214, v215
  v_mfma_f32_16x16x32_bf16 v[44:47], a[232:235], v[116:119], v[44:47]
  v_cvt_pk_bf16_f32 v250, v224, v225
  v_cvt_pk_bf16_f32 v251, v226, v227
  v_mfma_f32_16x16x32_bf16 v[44:47], a[236:239], v[128:131], v[44:47]
  ds_read_b64_tr_b16 a[228:229], v6 offset:320
  v_mfma_f32_16x16x32_bf16 v[40:43], a[236:239], v[124:127], v[40:43]
  ds_read_b64_tr_b16 a[230:231], v6 offset:448
  v_cvt_pk_bf16_f32 v252, v216, v217
  v_cvt_pk_bf16_f32 v253, v218, v219
  v_mfma_f32_16x16x32_bf16 v[40:43], a[232:235], v[112:115], v[40:43]
  buffer_load_dwordx4 a[16:19], v31, s[40:43], 0 offen sc1
  s_waitcnt lgkmcnt(8)
  v_mfma_f32_16x16x32_bf16 v[52:55], a[240:243], v[112:115], 0
  ds_read_b64_tr_b16 a[232:233], v6 offset:576
  buffer_store_dwordx4 v[248:251], v7, s[24:27], s78 offen sc1
  v_cvt_pk_bf16_f32 v254, v228, v229
  v_mfma_f32_16x16x32_bf16 v[52:55], a[244:247], v[124:127], v[52:55]
  ds_read_b64_tr_b16 a[234:235], v6 offset:704
  v_cvt_pk_bf16_f32 v255, v230, v231
  v_mfma_f32_16x16x32_bf16 v[56:59], a[244:247], v[128:131], 0
  v_mfma_f32_16x16x32_bf16 v[56:59], a[240:243], v[116:119], v[56:59]
  ds_read_b64_tr_b16 a[236:237], v6 offset:832
  v_mfma_f32_16x16x32_bf16 v[60:63], a[240:243], v[120:123], 0
  ds_read_b64_tr_b16 a[238:239], v6 offset:960
  v_mfma_f32_16x16x32_bf16 v[60:63], a[244:247], v[132:135], v[60:63]
  buffer_load_dwordx4 a[20:23], v31, s[40:43], s82 offen sc1
  v_add_u32 v30, 0x60000, v30
  s_waitcnt lgkmcnt(8)
  v_mfma_f32_16x16x32_bf16 v[60:63], a[252:255], v[108:111], v[60:63]
  ds_read_b64_tr_b16 a[240:241], v6 offset:608
  v_add_u32 v31, 0x60000, v31
  buffer_store_dwordx4 v[252:255], v7, s[24:27], s80 offen sc1
  v_mfma_f32_16x16x32_bf16 v[60:63], a[248:251], v[96:99], v[60:63]
  ds_read_b64_tr_b16 a[242:243], v6 offset:736
  v_add_u32 v7, 0x60000, v7
  v_mfma_f32_16x16x32_bf16 v[56:59], a[248:251], v[92:95], v[56:59]
  v_mfma_f32_16x16x32_bf16 v[56:59], a[252:255], v[104:107], v[56:59]
  ds_read_b64_tr_b16 a[244:245], v6 offset:864
  v_mfma_f32_16x16x32_bf16 v[52:55], a[252:255], v[100:103], v[52:55]
  ds_read_b64_tr_b16 a[246:247], v6 offset:992
  v_mfma_f32_16x16x32_bf16 v[52:55], a[248:251], v[88:91], v[52:55]
  s_waitcnt lgkmcnt(8)
  v_mfma_f32_16x16x32_bf16 v[64:67], a[224:227], v[88:91], 0
  ds_read_b64_tr_b16 a[248:249], v6 offset:96
  v_mfma_f32_16x16x32_bf16 v[64:67], a[228:231], v[100:103], v[64:67]
  ds_read_b64_tr_b16 a[250:251], v6 offset:224
  v_mfma_f32_16x16x32_bf16 v[68:71], a[228:231], v[104:107], 0
  v_mfma_f32_16x16x32_bf16 v[68:71], a[224:227], v[92:95], v[68:71]
  ds_read_b64_tr_b16 a[252:253], v6 offset:352
  v_mfma_f32_16x16x32_bf16 v[72:75], a[224:227], v[96:99], 0
  ds_read_b64_tr_b16 a[254:255], v6 offset:480
  v_mfma_f32_16x16x32_bf16 v[72:75], a[228:231], v[108:111], v[72:75]
  s_waitcnt lgkmcnt(8)
  v_mfma_f32_16x16x32_bf16 v[72:75], a[236:239], v[132:135], v[72:75]
  s_waitcnt vmcnt(39)
  s_barrier
  v_mfma_f32_16x16x32_bf16 v[72:75], a[232:235], v[120:123], v[72:75]
  v_add_u32 v6, 0, v5
  ds_read_b64_tr_b16 a[224:225], v6 offset:0
  v_mfma_f32_16x16x32_bf16 v[68:71], a[232:235], v[116:119], v[68:71]
  ds_read_b64_tr_b16 a[226:227], v6 offset:128
  s_add_u32 m0, s33, 101376
  s_mov_b32 s71, 115328
  v_mfma_f32_16x16x32_bf16 v[68:71], a[236:239], v[128:131], v[68:71]
  buffer_load_dwordx4 v2, s[20:23], s71 offen offset:0 lds
  ds_read_b64_tr_b16 a[228:229], v6 offset:256
  v_mfma_f32_16x16x32_bf16 v[64:67], a[236:239], v[124:127], v[64:67]
  ds_read_b64_tr_b16 a[230:231], v6 offset:384
  v_mfma_f32_16x16x32_bf16 v[64:67], a[232:235], v[112:115], v[64:67]
  s_waitcnt lgkmcnt(8)
  v_mfma_f32_16x16x32_bf16 v[76:79], a[240:243], v[112:115], 0
  ds_read_b64_tr_b16 a[232:233], v6 offset:512
  v_mfma_f32_16x16x32_bf16 v[76:79], a[244:247], v[124:127], v[76:79]
  ds_read_b64_tr_b16 a[234:235], v6 offset:640
  v_mfma_f32_16x16x32_bf16 v[80:83], a[244:247], v[128:131], 0
  s_add_u32 m0, s33, 101536
  v_mfma_f32_16x16x32_bf16 v[80:83], a[240:243], v[116:119], v[80:83]
  buffer_load_dwordx4 v2, s[20:23], s71 offen offset:896 lds
  ds_read_b64_tr_b16 a[236:237], v6 offset:768
  v_mfma_f32_16x16x32_bf16 v[84:87], a[240:243], v[120:123], 0
  ds_read_b64_tr_b16 a[238:239], v6 offset:896
  v_mfma_f32_16x16x32_bf16 v[84:87], a[244:247], v[132:135], v[84:87]
  s_waitcnt lgkmcnt(8)
  v_mfma_f32_16x16x32_bf16 v[84:87], a[252:255], v[108:111], v[84:87]
  ds_read_b64_tr_b16 a[240:241], v6 offset:544
  v_mfma_f32_16x16x32_bf16 v[84:87], a[248:251], v[96:99], v[84:87]
  ds_read_b64_tr_b16 a[242:243], v6 offset:672
  v_mfma_f32_16x16x32_bf16 v[80:83], a[248:251], v[92:95], v[80:83]
  s_add_u32 m0, s33, 101696
  v_mfma_f32_16x16x32_bf16 v[80:83], a[252:255], v[104:107], v[80:83]
  buffer_load_dwordx4 v2, s[20:23], s71 offen offset:1792 lds
  ds_read_b64_tr_b16 a[244:245], v6 offset:800
  v_mfma_f32_16x16x32_bf16 v[76:79], a[252:255], v[100:103], v[76:79]
  ds_read_b64_tr_b16 a[246:247], v6 offset:928
  s_waitcnt vmcnt(3)
  v_mfma_f32_16x16x32_bf16 v[76:79], a[248:251], v[88:91], v[76:79]
  v_mov_b32 v8, 2
  buffer_store_dword v8, v28, s[44:47], 0 offen sc1
  v_mfma_f32_16x16x32_bf16 v[20:23], a[172:175], a[0:3], 0
  v_mfma_f32_16x16x32_bf16 v[20:23], a[172:175], a[4:7], v[20:23]
  v_mfma_f32_16x16x32_bf16 v[20:23], a[172:175], a[8:11], v[20:23]
  v_mfma_f32_16x16x32_bf16 v[20:23], a[172:175], a[12:15], v[20:23]
  v_mfma_f32_16x16x32_bf16 v[20:23], a[176:179], a[16:19], v[20:23]
  v_mfma_f32_16x16x32_bf16 v[20:23], a[176:179], a[20:23], v[20:23]
  s_waitcnt lgkmcnt(8)
  v_mfma_f32_16x16x32_bf16 v[40:43], a[224:227], v[136:139], v[40:43]
  ds_read_b64_tr_b16 a[248:249], v6 offset:32
  v_mfma_f32_16x16x32_bf16 v[40:43], a[228:231], v[148:151], v[40:43]
  ds_read_b64_tr_b16 a[250:251], v6 offset:160
  v_mfma_f32_16x16x32_bf16 v[44:47], a[228:231], v[152:155], v[44:47]
  s_add_u32 m0, s33, 101856
  v_mfma_f32_16x16x32_bf16 v[44:47], a[224:227], v[140:143], v[44:47]
  buffer_load_dwordx4 v2, s[20:23], s71 offen offset:2688 lds
  ds_read_b64_tr_b16 a[252:253], v6 offset:288
  v_mfma_f32_16x16x32_bf16 v[48:51], a[224:227], v[144:147], v[48:51]
  ds_read_b64_tr_b16 a[254:255], v6 offset:416
  v_mfma_f32_16x16x32_bf16 v[48:51], a[228:231], v[156:159], v[48:51]
  s_waitcnt lgkmcnt(8)
  v_mfma_f32_16x16x32_bf16 v[48:51], a[236:239], v[180:183], v[48:51]
  ds_read_b64_tr_b16 a[224:225], v6 offset:64
  v_mfma_f32_16x16x32_bf16 v[48:51], a[232:235], v[168:171], v[48:51]
  ds_read_b64_tr_b16 a[226:227], v6 offset:192
  v_mfma_f32_16x16x32_bf16 v[44:47], a[232:235], v[164:167], v[44:47]
  v_mfma_f32_16x16x32_bf16 v[44:47], a[236:239], v[176:179], v[44:47]
  ds_read_b64_tr_b16 a[228:229], v6 offset:320
  v_mfma_f32_16x16x32_bf16 v[40:43], a[236:239], v[172:175], v[40:43]
  ds_read_b64_tr_b16 a[230:231], v6 offset:448
  v_mfma_f32_16x16x32_bf16 v[40:43], a[232:235], v[160:163], v[40:43]
  s_waitcnt lgkmcnt(8)
  v_mfma_f32_16x16x32_bf16 v[52:55], a[240:243], v[160:163], v[52:55]
  ds_read_b64_tr_b16 a[232:233], v6 offset:576
  v_mfma_f32_16x16x32_bf16 v[52:55], a[244:247], v[172:175], v[52:55]
  ds_read_b64_tr_b16 a[234:235], v6 offset:704
  v_mfma_f32_16x16x32_bf16 v[56:59], a[244:247], v[176:179], v[56:59]
  buffer_load_dword v24, v29, s[44:47], 0 offen sc1
  v_mfma_f32_16x16x32_bf16 v[56:59], a[240:243], v[164:167], v[56:59]
  ds_read_b64_tr_b16 a[236:237], v6 offset:832
  v_mfma_f32_16x16x32_bf16 v[60:63], a[240:243], v[168:171], v[60:63]
  ds_read_b64_tr_b16 a[238:239], v6 offset:960
  v_add_f32_dpp v20, v20, v20 row_ror:8 row_mask:0xc bank_mask:0xf
  v_mfma_f32_16x16x32_bf16 v[60:63], a[244:247], v[180:183], v[60:63]
  v_add_f32_dpp v21, v21, v21 row_ror:8 row_mask:0xc bank_mask:0xf
  s_waitcnt lgkmcnt(8)
  v_mfma_f32_16x16x32_bf16 v[60:63], a[252:255], v[156:159], v[60:63]
  ds_read_b64_tr_b16 a[240:241], v6 offset:608
  v_add_f32_dpp v22, v22, v22 row_ror:8 row_mask:0xc bank_mask:0xf
  v_mfma_f32_16x16x32_bf16 v[60:63], a[248:251], v[144:147], v[60:63]
  ds_read_b64_tr_b16 a[242:243], v6 offset:736
  v_add_f32_dpp v23, v23, v23 row_ror:8 row_mask:0xc bank_mask:0xf
  v_mfma_f32_16x16x32_bf16 v[56:59], a[248:251], v[140:143], v[56:59]
  v_cvt_pk_bf16_f32 v20, v20, v21
  v_cvt_pk_bf16_f32 v21, v22, v23
  v_mfma_f32_16x16x32_bf16 v[56:59], a[252:255], v[152:155], v[56:59]
  ds_read_b64_tr_b16 a[244:245], v6 offset:864
  buffer_store_dwordx2 v[20:21], v32, s[28:31], s57 offen offset:0
  v_mfma_f32_16x16x32_bf16 v[52:55], a[252:255], v[148:151], v[52:55]
  ds_read_b64_tr_b16 a[246:247], v6 offset:992
  v_mfma_f32_16x16x32_bf16 v[52:55], a[248:251], v[136:139], v[52:55]
  s_waitcnt lgkmcnt(8)
  v_mfma_f32_16x16x32_bf16 v[64:67], a[224:227], v[136:139], v[64:67]
  ds_read_b64_tr_b16 a[248:249], v6 offset:96
  v_mfma_f32_16x16x32_bf16 v[64:67], a[228:231], v[148:151], v[64:67]
  ds_read_b64_tr_b16 a[250:251], v6 offset:224
  v_mfma_f32_16x16x32_bf16 v[68:71], a[228:231], v[152:155], v[68:71]
  v_mfma_f32_16x16x32_bf16 v[68:71], a[224:227], v[140:143], v[68:71]
  ds_read_b64_tr_b16 a[252:253], v6 offset:352
  v_mfma_f32_16x16x32_bf16 v[72:75], a[224:227], v[144:147], v[72:75]
  ds_read_b64_tr_b16 a[254:255], v6 offset:480
  v_cvt_pk_bf16_f32 v232, v40, v41
  v_cvt_pk_bf16_f32 v233, v42, v43
  v_mfma_f32_16x16x32_bf16 v[72:75], a[228:231], v[156:159], v[72:75]
  s_waitcnt lgkmcnt(8)
  v_mfma_f32_16x16x32_bf16 v[72:75], a[236:239], v[180:183], v[72:75]
  v_cvt_pk_bf16_f32 v234, v52, v53
  v_cvt_pk_bf16_f32 v235, v54, v55
  v_mfma_f32_16x16x32_bf16 v[72:75], a[232:235], v[168:171], v[72:75]
  v_add_u32 v6, 16896, v5
  ds_read_b64_tr_b16 a[224:225], v6 offset:0
  v_mfma_f32_16x16x32_bf16 v[68:71], a[232:235], v[164:167], v[68:71]
  ds_read_b64_tr_b16 a[226:227], v6 offset:128
  s_waitcnt vmcnt(1)
  v_cmp_gt_u32 vcc, 2, v24
  s_cbranch_vccz L_go8
L_poll8:
  buffer_load_dword v24, v29, s[44:47], 0 offen sc1
  s_sub_u32 s39, s39, 1
  s_waitcnt vmcnt(0)
  v_cmp_gt_u32 vcc, 2, v24
  s_cbranch_scc1 L_giveup
  s_cbranch_vccnz L_poll8
L_go8:
  v_mfma_f32_16x16x32_bf16 v[68:71], a[236:239], v[176:179], v[68:71]
  ds_read_b64_tr_b16 a[228:229], v6 offset:256
  v_cvt_pk_bf16_f32 v236, v44, v45
  v_cvt_pk_bf16_f32 v237, v46, v47
  v_mfma_f32_16x16x32_bf16 v[64:67], a[236:239], v[172:175], v[64:67]
  ds_read_b64_tr_b16 a[230:231], v6 offset:384
  v_cvt_pk_bf16_f32 v238, v56, v57
  v_cvt_pk_bf16_f32 v239, v58, v59
  v_mfma_f32_16x16x32_bf16 v[64:67], a[232:235], v[160:163], v[64:67]
  buffer_load_dwordx4 a[32:35], v30, s[40:43], 0 offen sc1
  s_waitcnt lgkmcnt(8)
  v_mfma_f32_16x16x32_bf16 v[76:79], a[240:243], v[160:163], v[76:79]
  ds_read_b64_tr_b16 a[232:233], v6 offset:512
  buffer_store_dwordx4 v[232:235], v7, s[24:27], 0 offen sc1
  v_mfma_f32_16x16x32_bf16 v[76:79], a[244:247], v[172:175], v[76:79]
  ds_read_b64_tr_b16 a[234:235], v6 offset:640
  v_cvt_pk_bf16_f32 v240, v48, v49
  v_cvt_pk_bf16_f32 v241, v50, v51
  v_mfma_f32_16x16x32_bf16 v[80:83], a[244:247], v[176:179], v[80:83]
  v_cvt_pk_bf16_f32 v242, v60, v61
  v_cvt_pk_bf16_f32 v243, v62, v63
  v_mfma_f32_16x16x32_bf16 v[80:83], a[240:243], v[164:167], v[80:83]
  ds_read_b64_tr_b16 a[236:237], v6 offset:768
  v_mfma_f32_16x16x32_bf16 v[84:87], a[240:243], v[168:171], v[84:87]
  ds_read_b64_tr_b16 a[238:239], v6 offset:896
  v_mfma_f32_16x16x32_bf16 v[84:87], a[244:247], v[180:183], v[84:87]
  buffer_load_dwordx4 a[36:39], v30, s[40:43], s81 offen sc1
  s_waitcnt lgkmcnt(8)
  v_mfma_f32_16x16x32_bf16 v[84:87], a[252:255], v[156:159], v[84:87]
  ds_read_b64_tr_b16 a[240:241], v6 offset:544
  buffer_store_dwordx4 v[236:239], v7, s[24:27], s77 offen sc1
  v_mfma_f32_16x16x32_bf16 v[84:87], a[248:251], v[144:147], v[84:87]
  ds_read_b64_tr_b16 a[242:243], v6 offset:672
  v_mfma_f32_16x16x32_bf16 v[80:83], a[248:251], v[140:143], v[80:83]
  v_mfma_f32_16x16x32_bf16 v[80:83], a[252:255], v[152:155], v[80:83]
  ds_read_b64_tr_b16 a[244:245], v6 offset:800
  v_mfma_f32_16x16x32_bf16 v[76:79], a[252:255], v[148:151], v[76:79]
  ds_read_b64_tr_b16 a[246:247], v6 offset:928
  v_mfma_f32_16x16x32_bf16 v[76:79], a[248:251], v[136:139], v[76:79]
  buffer_load_dwordx4 a[40:43], v30, s[40:43], s82 offen sc1
  s_waitcnt lgkmcnt(8)
  v_mfma_f32_16x16x32_bf16 v[184:187], a[224:227], v[88:91], 0
  ds_read_b64_tr_b16 a[248:249], v6 offset:32
  buffer_store_dwordx4 v[240:243], v7, s[24:27], s79 offen sc1
  v_mfma_f32_16x16x32_bf16 v[184:187], a[228:231], v[100:103], v[184:187]
  ds_read_b64_tr_b16 a[250:251], v6 offset:160
  v_mfma_f32_16x16x32_bf16 v[188:191], a[228:231], v[104:107], 0
  v_cvt_pk_bf16_f32 v244, v64, v65
  v_cvt_pk_bf16_f32 v245, v66, v67
  v_mfma_f32_16x16x32_bf16 v[188:191], a[224:227], v[92:95], v[188:191]
  ds_read_b64_tr_b16 a[252:253], v6 offset:288
  v_mfma_f32_16x16x32_bf16 v[192:195], a[224:227], v[96:99], 0
  ds_read_b64_tr_b16 a[254:255], v6 offset:416
  v_cvt_pk_bf16_f32 v246, v76, v77
  v_cvt_pk_bf16_f32 v247, v78, v79
  v_mfma_f32_16x16x32_bf16 v[192:195], a[228:231], v[108:111], v[192:195]
  buffer_load_dwordx4 a[44:47], v30, s[40:43], s83 offen sc1
  s_waitcnt lgkmcnt(8)
  v_mfma_f32_16x16x32_bf16 v[192:195], a[236:239], v[132:135], v[192:195]
  ds_read_b64_tr_b16 a[224:225], v6 offset:64
  buffer_store_dwordx4 v[244:247], v7, s[24:27], s76 offen sc1
  v_cvt_pk_bf16_f32 v248, v68, v69
  v_mfma_f32_16x16x32_bf16 v[192:195], a[232:235], v[120:123], v[192:195]
  ds_read_b64_tr_b16 a[226:227], v6 offset:192
  v_cvt_pk_bf16_f32 v249, v70, v71
  v_mfma_f32_16x16x32_bf16 v[188:191], a[232:235], v[116:119], v[188:191]
  v_cvt_pk_bf16_f32 v250, v80, v81
  v_cvt_pk_bf16_f32 v251, v82, v83
  v_mfma_f32_16x16x32_bf16 v[188:191], a[236:239], v[128:131], v[188:191]
  ds_read_b64_tr_b16 a[228:229], v6 offset:320
  v_mfma_f32_16x16x32_bf16 v[184:187], a[236:239], v[124:127], v[184:187]
  ds_read_b64_tr_b16 a[230:231], v6 offset:448
  v_cvt_pk_bf16_f32 v252, v72, v73
  v_cvt_pk_bf16_f32 v253, v74, v75
  v_mfma_f32_16x16x32_bf16 v[184:187], a[232:235], v[112:115], v[184:187]
  buffer_load_dwordx4 a[48:51], v31, s[40:43], 0 offen sc1
  s_waitcnt lgkmcnt(8)
  v_mfma_f32_16x16x32_bf16 v[196:199], a[240:243], v[112:115], 0
  ds_read_b64_tr_b16 a[232:233], v6 offset:576
  buffer_store_dwordx4 v[248:251], v7, s[24:27], s78 offen sc1
  v_cvt_pk_bf16_f32 v254, v84, v85
  v_mfma_f32_16x16x32_bf16 v[196:199], a[244:247], v[124:127], v[196:199]
  ds_read_b64_tr_b16 a[234:235], v6 offset:704
  v_cvt_pk_bf16_f32 v255, v86, v87
  v_mfma_f32_16x16x32_bf16 v[200:203], a[244:247], v[128:131], 0
  v_mfma_f32_16x16x32_bf16 v[200:203], a[240:243], v[116:119], v[200:203]
  ds_read_b64_tr_b16 a[236:237], v6 offset:832
  v_mfma_f32_16x16x32_bf16 v[204:207], a[240:243], v[120:123], 0
  ds_read_b64_tr_b16 a[238:239], v6 offset:960
  v_mfma_f32_16x16x32_bf16 v[204:207], a[244:247], v[132:135], v[204:207]
  buffer_load_dwordx4 a[52:55], v31, s[40:43], s82 offen sc1
  v_add_u32 v30, 0x60000, v30
  s_waitcnt lgkmcnt(8)
  v_mfma_f32_16x16x32_bf16 v[204:207], a[252:255], v[108:111], v[204:207]
  ds_read_b64_tr_b16 a[240:241], v6 offset:608
  v_add_u32 v31, 0x60000, v31
  buffer_store_dwordx4 v[252:255], v7, s[24:27], s80 offen sc1
  v_mfma_f32_16x16x32_bf16 v[204:207], a[248:251], v[96:99], v[204:207]
  ds_read_b64_tr_b16 a[242:243], v6 offset:736
  v_add_u32 v7, 0x60000, v7
  v_mfma_f32_16x16x32_bf16 v[200:203], a[248:251], v[92:95], v[200:203]
  v_mfma_f32_16x16x32_bf16 v[200:203], a[252:255], v[104:107], v[200:203]
  ds_read_b64_tr_b16 a[244:245], v6 offset:864
  v_mfma_f32_16x16x32_bf16 v[196:199], a[252:255], v[100:103], v[196:199]
  ds_read_b64_tr_b16 a[246:247], v6 offset:992
  v_mfma_f32_16x16x32_bf16 v[196:199], a[248:251], v[88:91], v[196:199]
  s_waitcnt lgkmcnt(8)
  v_mfma_f32_16x16x32_bf16 v[208:211], a[224:227], v[88:91], 0
  ds_read_b64_tr_b16 a[248:249], v6 offset:96
  v_mfma_f32_16x16x32_bf16 v[208:211], a[228:231], v[100:103], v[208:211]
  ds_read_b64_tr_b16 a[250:251], v6 offset:224
  v_mfma_f32_16x16x32_bf16 v[212:215], a[228:231], v[104:107], 0
  v_mfma_f32_16x16x32_bf16 v[212:215], a[224:227], v[92:95], v[212:215]
  ds_read_b64_tr_b16 a[252:253], v6 offset:352
  v_mfma_f32_16x16x32_bf16 v[216:219], a[224:227], v[96:99], 0
  ds_read_b64_tr_b16 a[254:255], v6 offset:480
  v_mfma_f32_16x16x32_bf16 v[216:219], a[228:231], v[108:111], v[216:219]
  s_waitcnt lgkmcnt(8)
  v_mfma_f32_16x16x32_bf16 v[216:219], a[236:239], v[132:135], v[216:219]
  s_waitcnt vmcnt(48)
  s_barrier
  v_mfma_f32_16x16x32_bf16 v[216:219], a[232:235], v[120:123], v[216:219]
  v_add_u32 v6, 33792, v5
  ds_read_b64_tr_b16 a[224:225], v6 offset:0
  v_mfma_f32_16x16x32_bf16 v[212:215], a[232:235], v[116:119], v[212:215]
  ds_read_b64_tr_b16 a[226:227], v6 offset:128
  s_add_u32 m0, s33, 118272
  s_mov_b32 s71, 768
  v_mfma_f32_16x16x32_bf16 v[212:215], a[236:239], v[128:131], v[212:215]
  buffer_load_dwordx4 v2, s[20:23], s71 offen offset:0 lds
  ds_read_b64_tr_b16 a[228:229], v6 offset:256
  v_mfma_f32_16x16x32_bf16 v[208:211], a[236:239], v[124:127], v[208:211]
  ds_read_b64_tr_b16 a[230:231], v6 offset:384
  v_mfma_f32_16x16x32_bf16 v[208:211], a[232:235], v[112:115], v[208:211]
  s_waitcnt lgkmcnt(8)
  v_mfma_f32_16x16x32_bf16 v[220:223], a[240:243], v[112:115], 0
  ds_read_b64_tr_b16 a[232:233], v6 offset:512
  v_mfma_f32_16x16x32_bf16 v[220:223], a[244:247], v[124:127], v[220:223]
  ds_read_b64_tr_b16 a[234:235], v6 offset:640
  v_mfma_f32_16x16x32_bf16 v[224:227], a[244:247], v[128:131], 0
  s_add_u32 m0, s33, 118432
  v_mfma_f32_16x16x32_bf16 v[224:227], a[240:243], v[116:119], v[224:227]
  buffer_load_dwordx4 v2, s[20:23], s71 offen offset:896 lds
  ds_read_b64_tr_b16 a[236:237], v6 offset:768
  v_mfma_f32_16x16x32_bf16 v[228:231], a[240:243], v[120:123], 0
  ds_read_b64_tr_b16 a[238:239], v6 offset:896
  v_mfma_f32_16x16x32_bf16 v[228:231], a[244:247], v[132:135], v[228:231]
  s_waitcnt lgkmcnt(8)
  v_mfma_f32_16x16x32_bf16 v[228:231], a[252:255], v[108:111], v[228:231]
  ds_read_b64_tr_b16 a[240:241], v6 offset:544
  v_mfma_f32_16x16x32_bf16 v[228:231], a[248:251], v[96:99], v[228:231]
  ds_read_b64_tr_b16 a[242:243], v6 offset:672
  v_mfma_f32_16x16x32_bf16 v[224:227], a[248:251], v[92:95], v[224:227]
  s_add_u32 m0, s33, 118592
  v_mfma_f32_16x16x32_bf16 v[224:227], a[252:255], v[104:107], v[224:227]
  buffer_load_dwordx4 v2, s[20:23], s71 offen offset:1792 lds
  ds_read_b64_tr_b16 a[244:245], v6 offset:800
  v_mfma_f32_16x16x32_bf16 v[220:223], a[252:255], v[100:103], v[220:223]
  ds_read_b64_tr_b16 a[246:247], v6 offset:928
  s_waitcnt vmcnt(3)
  v_mfma_f32_16x16x32_bf16 v[220:223], a[248:251], v[88:91], v[220:223]
  v_mov_b32 v8, 3
  buffer_store_dword v8, v28, s[44:47], 0 offen sc1
  v_mfma_f32_16x16x32_bf16 v[20:23], a[172:175], a[32:35], 0
  v_mfma_f32_16x16x32_bf16 v[20:23], a[172:175], a[36:39], v[20:23]
  v_mfma_f32_16x16x32_bf16 v[20:23], a[172:175], a[40:43], v[20:23]
  v_mfma_f32_16x16x32_bf16 v[20:23], a[172:175], a[44:47], v[20:23]
  v_mfma_f32_16x16x32_bf16 v[20:23], a[176:179], a[48:51], v[20:23]
  v_mfma_f32_16x16x32_bf16 v[20:23], a[176:179], a[52:55], v[20:23]
  s_waitcnt lgkmcnt(8)
  v_mfma_f32_16x16x32_bf16 v[184:187], a[224:227], v[136:139], v[184:187]
  ds_read_b64_tr_b16 a[248:249], v6 offset:32
  v_mfma_f32_16x16x32_bf16 v[184:187], a[228:231], v[148:151], v[184:187]
  ds_read_b64_tr_b16 a[250:251], v6 offset:160
  v_mfma_f32_16x16x32_bf16 v[188:191], a[228:231], v[152:155], v[188:191]
  s_add_u32 m0, s33, 118752
  v_mfma_f32_16x16x32_bf16 v[188:191], a[224:227], v[140:143], v[188:191]
  buffer_load_dwordx4 v2, s[20:23], s71 offen offset:2688 lds
  ds_read_b64_tr_b16 a[252:253], v6 offset:288
  v_mfma_f32_16x16x32_bf16 v[192:195], a[224:227], v[144:147], v[192:195]
  ds_read_b64_tr_b16 a[254:255], v6 offset:416
  v_mfma_f32_16x16x32_bf16 v[192:195], a[228:231], v[156:159], v[192:195]
  s_waitcnt lgkmcnt(8)
  v_mfma_f32_16x16x32_bf16 v[192:195], a[236:239], v[180:183], v[192:195]
  ds_read_b64_tr_b16 a[224:225], v6 offset:64
  v_mfma_f32_16x16x32_bf16 v[192:195], a[232:235], v[168:171], v[192:195]
  ds_read_b64_tr_b16 a[226:227], v6 offset:192
  v_mfma_f32_16x16x32_bf16 v[188:191], a[232:235], v[164:167], v[188:191]
  v_mfma_f32_16x16x32_bf16 v[188:191], a[236:239], v[176:179], v[188:191]
  ds_read_b64_tr_b16 a[228:229], v6 offset:320
  v_mfma_f32_16x16x32_bf16 v[184:187], a[236:239], v[172:175], v[184:187]
  ds_read_b64_tr_b16 a[230:231], v6 offset:448
  v_mfma_f32_16x16x32_bf16 v[184:187], a[232:235], v[160:163], v[184:187]
  s_waitcnt lgkmcnt(8)
  v_mfma_f32_16x16x32_bf16 v[196:199], a[240:243], v[160:163], v[196:199]
  ds_read_b64_tr_b16 a[232:233], v6 offset:576
  v_mfma_f32_16x16x32_bf16 v[196:199], a[244:247], v[172:175], v[196:199]
  ds_read_b64_tr_b16 a[234:235], v6 offset:704
  v_mfma_f32_16x16x32_bf16 v[200:203], a[244:247], v[176:179], v[200:203]
  buffer_load_dword v24, v29, s[44:47], 0 offen sc1
  v_mfma_f32_16x16x32_bf16 v[200:203], a[240:243], v[164:167], v[200:203]
  ds_read_b64_tr_b16 a[236:237], v6 offset:832
  v_mfma_f32_16x16x32_bf16 v[204:207], a[240:243], v[168:171], v[204:207]
  ds_read_b64_tr_b16 a[238:239], v6 offset:960
  v_add_f32_dpp v20, v20, v20 row_ror:8 row_mask:0xc bank_mask:0xf
  v_mfma_f32_16x16x32_bf16 v[204:207], a[244:247], v[180:183], v[204:207]
  v_add_f32_dpp v21, v21, v21 row_ror:8 row_mask:0xc bank_mask:0xf
  s_waitcnt lgkmcnt(8)
  v_mfma_f32_16x16x32_bf16 v[204:207], a[252:255], v[156:159], v[204:207]
  ds_read_b64_tr_b16 a[240:241], v6 offset:608
  v_add_f32_dpp v22, v22, v22 row_ror:8 row_mask:0xc bank_mask:0xf
  v_mfma_f32_16x16x32_bf16 v[204:207], a[248:251], v[144:147], v[204:207]
  ds_read_b64_tr_b16 a[242:243], v6 offset:736
  v_add_f32_dpp v23, v23, v23 row_ror:8 row_mask:0xc bank_mask:0xf
  v_mfma_f32_16x16x32_bf16 v[200:203], a[248:251], v[140:143], v[200:203]
  v_cvt_pk_bf16_f32 v20, v20, v21
  v_cvt_pk_bf16_f32 v21, v22, v23
  v_mfma_f32_16x16x32_bf16 v[200:203], a[252:255], v[152:155], v[200:203]
  ds_read_b64_tr_b16 a[244:245], v6 offset:864
  buffer_store_dwordx2 v[20:21], v32, s[28:31], s57 offen offset:128
  v_mfma_f32_16x16x32_bf16 v[196:199], a[252:255], v[148:151], v[196:199]
  ds_read_b64_tr_b16 a[246:247], v6 offset:992
  v_mfma_f32_16x16x32_bf16 v[196:199], a[248:251], v[136:139], v[196:199]
  s_waitcnt lgkmcnt(8)
  v_mfma_f32_16x16x32_bf16 v[208:211], a[224:227], v[136:139], v[208:211]
  ds_read_b64_tr_b16 a[248:249], v6 offset:96
  v_mfma_f32_16x16x32_bf16 v[208:211], a[228:231], v[148:151], v[208:211]
  ds_read_b64_tr_b16 a[250:251], v6 offset:224
  v_mfma_f32_16x16x32_bf16 v[212:215], a[228:231], v[152:155], v[212:215]
  v_mfma_f32_16x16x32_bf16 v[212:215], a[224:227], v[140:143], v[212:215]
  ds_read_b64_tr_b16 a[252:253], v6 offset:352
  v_mfma_f32_16x16x32_bf16 v[216:219], a[224:227], v[144:147], v[216:219]
  ds_read_b64_tr_b16 a[254:255], v6 offset:480
  v_cvt_pk_bf16_f32 v232, v184, v185
  v_cvt_pk_bf16_f32 v233, v186, v187
  v_mfma_f32_16x16x32_bf16 v[216:219], a[228:231], v[156:159], v[216:219]
  s_waitcnt lgkmcnt(8)
  v_mfma_f32_16x16x32_bf16 v[216:219], a[236:239], v[180:183], v[216:219]
  v_cvt_pk_bf16_f32 v234, v196, v197
  v_cvt_pk_bf16_f32 v235, v198, v199
  v_mfma_f32_16x16x32_bf16 v[216:219], a[232:235], v[168:171], v[216:219]
  v_add_u32 v6, 50688, v5
  ds_read_b64_tr_b16 a[224:225], v6 offset:0
  v_mfma_f32_16x16x32_bf16 v[212:215], a[232:235], v[164:167], v[212:215]
  ds_read_b64_tr_b16 a[226:227], v6 offset:128
  s_waitcnt vmcnt(1)
  v_cmp_gt_u32 vcc, 3, v24
  s_cbranch_vccz L_go9
L_poll9:
  buffer_load_dword v24, v29, s[44:47], 0 offen sc1
  s_sub_u32 s39, s39, 1
  s_waitcnt vmcnt(0)
  v_cmp_gt_u32 vcc, 3, v24
  s_cbranch_scc1 L_giveup
  s_cbranch_vccnz L_poll9
L_go9:
  v_mfma_f32_16x16x32_bf16 v[212:215], a[236:239], v[176:179], v[212:215]
  ds_read_b64_tr_b16 a[228:229], v6 offset:256
  v_cvt_pk_bf16_f32 v236, v188, v189
  v_cvt_pk_bf16_f32 v237, v190, v191
  v_mfma_f32_16x16x32_bf16 v[208:211], a[236:239], v[172:175], v[208:211]
  ds_read_b64_tr_b16 a[230:231], v6 offset:384
  v_cvt_pk_bf16_f32 v238, v200, v201
  v_cvt_pk_bf16_f32 v239, v202, v203
  v_mfma_f32_16x16x32_bf16 v[208:211], a[232:235], v[160:163], v[208:211]
  buffer_load_dwordx4 a[0:3], v30, s[40:43], 0 offen sc1
  s_waitcnt lgkmcnt(8)
  v_mfma_f32_16x16x32_bf16 v[220:223], a[240:243], v[160:163], v[220:223]
  ds_read_b64_tr_b16 a[232:233], v6 offset:512
  buffer_store_dwordx4 v[232:235], v7, s[24:27], 0 offen sc1
  v_mfma_f32_16x16x32_bf16 v[220:223], a[244:247], v[172:175], v[220:223]
  ds_read_b64_tr_b16 a[234:235], v6 offset:640
  v_cvt_pk_bf16_f32 v240, v192, v193
  v_cvt_pk_bf16_f32 v241, v194, v195
  v_mfma_f32_16x16x32_bf16 v[224:227], a[244:247], v[176:179], v[224:227]
  v_cvt_pk_bf16_f32 v242, v204, v205
  v_cvt_pk_bf16_f32 v243, v206, v207
  v_mfma_f32_16x16x32_bf16 v[224:227], a[240:243], v[164:167], v[224:227]
  ds_read_b64_tr_b16 a[236:237], v6 offset:768
  v_mfma_f32_16x16x32_bf16 v[228:231], a[240:243], v[168:171], v[228:231]
  ds_read_b64_tr_b16 a[238:239], v6 offset:896
  v_mfma_f32_16x16x32_bf16 v[228:231], a[244:247], v[180:183], v[228:231]
  buffer_load_dwordx4 a[4:7], v30, s[40:43], s81 offen sc1
  s_waitcnt lgkmcnt(8)
  v_mfma_f32_16x16x32_bf16 v[228:231], a[252:255], v[156:159], v[228:231]
  ds_read_b64_tr_b16 a[240:241], v6 offset:544
  buffer_store_dwordx4 v[236:239], v7, s[24:27], s77 offen sc1
  v_mfma_f32_16x16x32_bf16 v[228:231], a[248:251], v[144:147], v[228:231]
  ds_read_b64_tr_b16 a[242:243], v6 offset:672
  v_mfma_f32_16x16x32_bf16 v[224:227], a[248:251], v[140:143], v[224:227]
  v_mfma_f32_16x16x32_bf16 v[224:227], a[252:255], v[152:155], v[224:227]
  ds_read_b64_tr_b16 a[244:245], v6 offset:800
  v_mfma_f32_16x16x32_bf16 v[220:223], a[252:255], v[148:151], v[220:223]
  ds_read_b64_tr_b16 a[246:247], v6 offset:928
  v_mfma_f32_16x16x32_bf16 v[220:223], a[248:251], v[136:139], v[220:223]
  buffer_load_dwordx4 a[8:11], v30, s[40:43], s82 offen sc1
  s_waitcnt lgkmcnt(8)
  v_mfma_f32_16x16x32_bf16 v[40:43], a[224:227], v[88:91], 0
  ds_read_b64_tr_b16 a[248:249], v6 offset:32
  buffer_store_dwordx4 v[240:243], v7, s[24:27], s79 offen sc1
  v_mfma_f32_16x16x32_bf16 v[40:43], a[228:231], v[100:103], v[40:43]
  ds_read_b64_tr_b16 a[250:251], v6 offset:160
  v_mfma_f32_16x16x32_bf16 v[44:47], a[228:231], v[104:107], 0
  v_cvt_pk_bf16_f32 v244, v208, v209
  v_cvt_pk_bf16_f32 v245, v210, v211
  v_mfma_f32_16x16x32_bf16 v[44:47], a[224:227], v[92:95], v[44:47]
  ds_read_b64_tr_b16 a[252:253], v6 offset:288
  v_mfma_f32_16x16x32_bf16 v[48:51], a[224:227], v[96:99], 0
  ds_read_b64_tr_b16 a[254:255], v6 offset:416
  v_cvt_pk_bf16_f32 v246, v220, v221
  v_cvt_pk_bf16_f32 v247, v222, v223
  v_mfma_f32_16x16x32_bf16 v[48:51], a[228:231], v[108:111], v[48:51]
  buffer_load_dwordx4 a[12:15], v30, s[40:43], s83 offen sc1
  s_waitcnt lgkmcnt(8)
  v_mfma_f32_16x16x32_bf16 v[48:51], a[236:239], v[132:135], v[48:51]
  ds_read_b64_tr_b16 a[224:225], v6 offset:64
  buffer_store_dwordx4 v[244:247], v7, s[24:27], s76 offen sc1
  v_cvt_pk_bf16_f32 v248, v212, v213
  v_mfma_f32_16x16x32_bf16 v[48:51], a[232:235], v[120:123], v[48:51]
  ds_read_b64_tr_b16 a[226:227], v6 offset:192
  v_cvt_pk_bf16_f32 v249, v214, v215
  v_mfma_f32_16x16x32_bf16 v[44:47], a[232:235], v[116:119], v[44:47]
  v_cvt_pk_bf16_f32 v250, v224, v225
  v_cvt_pk_bf16_f32 v251, v226, v227
  v_mfma_f32_16x16x32_bf16 v[44:47], a[236:239], v[128:131], v[44:47]
  ds_read_b64_tr_b16 a[228:229], v6 offset:320
  v_mfma_f32_16x16x32_bf16 v[40:43], a[236:239], v[124:127], v[40:43]
  ds_read_b64_tr_b16 a[230:231], v6 offset:448
  v_cvt_pk_bf16_f32 v252, v216, v217
  v_cvt_pk_bf16_f32 v253, v218, v219
  v_mfma_f32_16x16x32_bf16 v[40:43], a[232:235], v[112:115], v[40:43]
  buffer_load_dwordx4 a[16:19], v31, s[40:43], 0 offen sc1
  s_waitcnt lgkmcnt(8)
  v_mfma_f32_16x16x32_bf16 v[52:55], a[240:243], v[112:115], 0
  ds_read_b64_tr_b16 a[232:233], v6 offset:576
  buffer_store_dwordx4 v[248:251], v7, s[24:27], s78 offen sc1
  v_cvt_pk_bf16_f32 v254, v228, v229
  v_mfma_f32_16x16x32_bf16 v[52:55], a[244:247], v[124:127], v[52:55]
  ds_read_b64_tr_b16 a[234:235], v6 offset:704
  v_cvt_pk_bf16_f32 v255, v230, v231
  v_mfma_f32_16x16x32_bf16 v[56:59], a[244:247], v[128:131], 0
  v_mfma_f32_16x16x32_bf16 v[56:59], a[240:243], v[116:119], v[56:59]
  ds_read_b64_tr_b16 a[236:237], v6 offset:832
  v_mfma_f32_16x16x32_bf16 v[60:63], a[240:243], v[120:123], 0
  ds_read_b64_tr_b16 a[238:239], v6 offset:960
  v_mfma_f32_16x16x32_bf16 v[60:63], a[244:247], v[132:135], v[60:63]
  buffer_load_dwordx4 a[20:23], v31, s[40:43], s82 offen sc1
  v_add_u32 v30, 0x60000, v30
  s_waitcnt lgkmcnt(8)
  v_mfma_f32_16x16x32_bf16 v[60:63], a[252:255], v[108:111], v[60:63]
  ds_read_b64_tr_b16 a[240:241], v6 offset:608
  v_add_u32 v31, 0x60000, v31
  buffer_store_dwordx4 v[252:255], v7, s[24:27], s80 offen sc1
  v_mfma_f32_16x16x32_bf16 v[60:63], a[248:251], v[96:99], v[60:63]
  ds_read_b64_tr_b16 a[242:243], v6 offset:736
  v_add_u32 v7, 0x60000, v7
  v_mfma_f32_16x16x32_bf16 v[56:59], a[248:251], v[92:95], v[56:59]
  v_mfma_f32_16x16x32_bf16 v[56:59], a[252:255], v[104:107], v[56:59]
  ds_read_b64_tr_b16 a[244:245], v6 offset:864
  v_mfma_f32_16x16x32_bf16 v[52:55], a[252:255], v[100:103], v[52:55]
  ds_read_b64_tr_b16 a[246:247], v6 offset:992
  v_mfma_f32_16x16x32_bf16 v[52:55], a[248:251], v[88:91], v[52:55]
  s_waitcnt lgkmcnt(8)
  v_mfma_f32_16x16x32_bf16 v[64:67], a[224:227], v[88:91], 0
  ds_read_b64_tr_b16 a[248:249], v6 offset:96
  v_mfma_f32_16x16x32_bf16 v[64:67], a[228:231], v[100:103], v[64:67]
  ds_read_b64_tr_b16 a[250:251], v6 offset:224
  v_mfma_f32_16x16x32_bf16 v[68:71], a[228:231], v[104:107], 0
  v_mfma_f32_16x16x32_bf16 v[68:71], a[224:227], v[92:95], v[68:71]
  ds_read_b64_tr_b16 a[252:253], v6 offset:352
  v_mfma_f32_16x16x32_bf16 v[72:75], a[224:227], v[96:99], 0
  ds_read_b64_tr_b16 a[254:255], v6 offset:480
  v_mfma_f32_16x16x32_bf16 v[72:75], a[228:231], v[108:111], v[72:75]
  s_waitcnt lgkmcnt(8)
  v_mfma_f32_16x16x32_bf16 v[72:75], a[236:239], v[132:135], v[72:75]
  s_waitcnt vmcnt(14)
  s_barrier
  v_mfma_f32_16x16x32_bf16 v[72:75], a[232:235], v[120:123], v[72:75]
  v_add_u32 v6, 67584, v5
  ds_read_b64_tr_b16 a[224:225], v6 offset:0
  v_mfma_f32_16x16x32_bf16 v[68:71], a[232:235], v[116:119], v[68:71]
  ds_read_b64_tr_b16 a[226:227], v6 offset:128
  s_add_u32 m0, s33, 84480
  s_mov_b32 s71, 115456
  v_mfma_f32_16x16x32_bf16 v[68:71], a[236:239], v[128:131], v[68:71]
  buffer_load_dwordx4 v2, s[20:23], s71 offen offset:0 lds
  ds_read_b64_tr_b16 a[228:229], v6 offset:256
  v_mfma_f32_16x16x32_bf16 v[64:67], a[236:239], v[124:127], v[64:67]
  ds_read_b64_tr_b16 a[230:231], v6 offset:384
  v_mfma_f32_16x16x32_bf16 v[64:67], a[232:235], v[112:115], v[64:67]
  s_waitcnt lgkmcnt(8)
  v_mfma_f32_16x16x32_bf16 v[76:79], a[240:243], v[112:115], 0
  ds_read_b64_tr_b16 a[232:233], v6 offset:512
  v_mfma_f32_16x16x32_bf16 v[76:79], a[244:247], v[124:127], v[76:79]
  ds_read_b64_tr_b16 a[234:235], v6 offset:640
  v_mfma_f32_16x16x32_bf16 v[80:83], a[244:247], v[128:131], 0
  s_add_u32 m0, s33, 84640
  v_mfma_f32_16x16x32_bf16 v[80:83], a[240:243], v[116:119], v[80:83]
  buffer_load_dwordx4 v2, s[20:23], s71 offen offset:896 lds
  ds_read_b64_tr_b16 a[236:237], v6 offset:768
  v_mfma_f32_16x16x32_bf16 v[84:87], a[240:243], v[120:123], 0
  ds_read_b64_tr_b16 a[238:239], v6 offset:896
  v_mfma_f32_16x16x32_bf16 v[84:87], a[244:247], v[132:135], v[84:87]
  s_waitcnt lgkmcnt(8)
  v_mfma_f32_16x16x32_bf16 v[84:87], a[252:255], v[108:111], v[84:87]
  ds_read_b64_tr_b16 a[240:241], v6 offset:544
  v_mfma_f32_16x16x32_bf16 v[84:87], a[248:251], v[96:99], v[84:87]
  ds_read_b64_tr_b16 a[242:243], v6 offset:672
  v_mfma_f32_16x16x32_bf16 v[80:83], a[248:251], v[92:95], v[80:83]
  s_add_u32 m0, s33, 84800
  v_mfma_f32_16x16x32_bf16 v[80:83], a[252:255], v[104:107], v[80:83]
  buffer_load_dwordx4 v2, s[20:23], s71 offen offset:1792 lds
  ds_read_b64_tr_b16 a[244:245], v6 offset:800
  v_mfma_f32_16x16x32_bf16 v[76:79], a[252:255], v[100:103], v[76:79]
  ds_read_b64_tr_b16 a[246:247], v6 offset:928
  s_waitcnt vmcnt(3)
  v_mfma_f32_16x16x32_bf16 v[76:79], a[248:251], v[88:91], v[76:79]
  v_mov_b32 v8, 4
  buffer_store_dword v8, v28, s[44:47], 0 offen sc1
  v_mfma_f32_16x16x32_bf16 v[20:23], a[172:175], a[0:3], 0
  v_mfma_f32_16x16x32_bf16 v[20:23], a[172:175], a[4:7], v[20:23]
  v_mfma_f32_16x16x32_bf16 v[20:23], a[172:175], a[8:11], v[20:23]
  v_mfma_f32_16x16x32_bf16 v[20:23], a[172:175], a[12:15], v[20:23]
  v_mfma_f32_16x16x32_bf16 v[20:23], a[176:179], a[16:19], v[20:23]
  v_mfma_f32_16x16x32_bf16 v[20:23], a[176:179], a[20:23], v[20:23]
  s_waitcnt lgkmcnt(8)
  v_mfma_f32_16x16x32_bf16 v[40:43], a[224:227], v[136:139], v[40:43]
  ds_read_b64_tr_b16 a[248:249], v6 offset:32
  v_mfma_f32_16x16x32_bf16 v[40:43], a[228:231], v[148:151], v[40:43]
  ds_read_b64_tr_b16 a[250:251], v6 offset:160
  v_mfma_f32_16x16x32_bf16 v[44:47], a[228:231], v[152:155], v[44:47]
  s_add_u32 m0, s33, 84960
  v_mfma_f32_16x16x32_bf16 v[44:47], a[224:227], v[140:143], v[44:47]
  buffer_load_dwordx4 v2, s[20:23], s71 offen offset:2688 lds
  ds_read_b64_tr_b16 a[252:253], v6 offset:288
  v_mfma_f32_16x16x32_bf16 v[48:51], a[224:227], v[144:147], v[48:51]
  ds_read_b64_tr_b16 a[254:255], v6 offset:416
  v_mfma_f32_16x16x32_bf16 v[48:51], a[228:231], v[156:159], v[48:51]
  s_waitcnt lgkmcnt(8)
  v_mfma_f32_16x16x32_bf16 v[48:51], a[236:239], v[180:183], v[48:51]
  ds_read_b64_tr_b16 a[224:225], v6 offset:64
  v_mfma_f32_16x16x32_bf16 v[48:51], a[232:235], v[168:171], v[48:51]
  ds_read_b64_tr_b16 a[226:227], v6 offset:192
  v_mfma_f32_16x16x32_bf16 v[44:47], a[232:235], v[164:167], v[44:47]
  v_mfma_f32_16x16x32_bf16 v[44:47], a[236:239], v[176:179], v[44:47]
  ds_read_b64_tr_b16 a[228:229], v6 offset:320
  v_mfma_f32_16x16x32_bf16 v[40:43], a[236:239], v[172:175], v[40:43]
  ds_read_b64_tr_b16 a[230:231], v6 offset:448
  v_mfma_f32_16x16x32_bf16 v[40:43], a[232:235], v[160:163], v[40:43]
  s_waitcnt lgkmcnt(8)
  v_mfma_f32_16x16x32_bf16 v[52:55], a[240:243], v[160:163], v[52:55]
  ds_read_b64_tr_b16 a[232:233], v6 offset:576
  v_mfma_f32_16x16x32_bf16 v[52:55], a[244:247], v[172:175], v[52:55]
  ds_read_b64_tr_b16 a[234:235], v6 offset:704
  v_mfma_f32_16x16x32_bf16 v[56:59], a[244:247], v[176:179], v[56:59]
  buffer_load_dword v24, v29, s[44:47], 0 offen sc1
  v_mfma_f32_16x16x32_bf16 v[56:59], a[240:243], v[164:167], v[56:59]
  ds_read_b64_tr_b16 a[236:237], v6 offset:832
  v_mfma_f32_16x16x32_bf16 v[60:63], a[240:243], v[168:171], v[60:63]
  ds_read_b64_tr_b16 a[238:239], v6 offset:960
  v_add_f32_dpp v20, v20, v20 row_ror:8 row_mask:0xc bank_mask:0xf
  v_mfma_f32_16x16x32_bf16 v[60:63], a[244:247], v[180:183], v[60:63]
  v_add_f32_dpp v21, v21, v21 row_ror:8 row_mask:0xc bank_mask:0xf
  s_waitcnt lgkmcnt(8)
  v_mfma_f32_16x16x32_bf16 v[60:63], a[252:255], v[156:159], v[60:63]
  ds_read_b64_tr_b16 a[240:241], v6 offset:608
  v_add_f32_dpp v22, v22, v22 row_ror:8 row_mask:0xc bank_mask:0xf
  v_mfma_f32_16x16x32_bf16 v[60:63], a[248:251], v[144:147], v[60:63]
  ds_read_b64_tr_b16 a[242:243], v6 offset:736
  v_add_f32_dpp v23, v23, v23 row_ror:8 row_mask:0xc bank_mask:0xf
  v_mfma_f32_16x16x32_bf16 v[56:59], a[248:251], v[140:143], v[56:59]
  v_cvt_pk_bf16_f32 v20, v20, v21
  v_cvt_pk_bf16_f32 v21, v22, v23
  v_mfma_f32_16x16x32_bf16 v[56:59], a[252:255], v[152:155], v[56:59]
  ds_read_b64_tr_b16 a[244:245], v6 offset:864
  buffer_store_dwordx2 v[20:21], v32, s[28:31], s57 offen offset:256
  v_mfma_f32_16x16x32_bf16 v[52:55], a[252:255], v[148:151], v[52:55]
  ds_read_b64_tr_b16 a[246:247], v6 offset:992
  v_mfma_f32_16x16x32_bf16 v[52:55], a[248:251], v[136:139], v[52:55]
  s_waitcnt lgkmcnt(8)
  v_mfma_f32_16x16x32_bf16 v[64:67], a[224:227], v[136:139], v[64:67]
  ds_read_b64_tr_b16 a[248:249], v6 offset:96
  v_mfma_f32_16x16x32_bf16 v[64:67], a[228:231], v[148:151], v[64:67]
  ds_read_b64_tr_b16 a[250:251], v6 offset:224
  v_mfma_f32_16x16x32_bf16 v[68:71], a[228:231], v[152:155], v[68:71]
  v_mfma_f32_16x16x32_bf16 v[68:71], a[224:227], v[140:143], v[68:71]
  ds_read_b64_tr_b16 a[252:253], v6 offset:352
  v_mfma_f32_16x16x32_bf16 v[72:75], a[224:227], v[144:147], v[72:75]
  ds_read_b64_tr_b16 a[254:255], v6 offset:480
  v_cvt_pk_bf16_f32 v232, v40, v41
  v_cvt_pk_bf16_f32 v233, v42, v43
  v_mfma_f32_16x16x32_bf16 v[72:75], a[228:231], v[156:159], v[72:75]
  s_waitcnt lgkmcnt(8)
  v_mfma_f32_16x16x32_bf16 v[72:75], a[236:239], v[180:183], v[72:75]
  v_cvt_pk_bf16_f32 v234, v52, v53
  v_cvt_pk_bf16_f32 v235, v54, v55
  v_mfma_f32_16x16x32_bf16 v[72:75], a[232:235], v[168:171], v[72:75]
  v_add_u32 v6, 135168, v5
  ds_read_b64_tr_b16 a[224:225], v6 offset:0
  v_mfma_f32_16x16x32_bf16 v[68:71], a[232:235], v[164:167], v[68:71]
  ds_read_b64_tr_b16 a[226:227], v6 offset:128
  s_waitcnt vmcnt(1)
  v_cmp_gt_u32 vcc, 4, v24
  s_cbranch_vccz L_go10
L_poll10:
  buffer_load_dword v24, v29, s[44:47], 0 offen sc1
  s_sub_u32 s39, s39, 1
  s_waitcnt vmcnt(0)
  v_cmp_gt_u32 vcc, 4, v24
  s_cbranch_scc1 L_giveup
  s_cbranch_vccnz L_poll10
L_go10:
  v_mfma_f32_16x16x32_bf16 v[68:71], a[236:239], v[176:179], v[68:71]
  ds_read_b64_tr_b16 a[228:229], v6 offset:256
  v_cvt_pk_bf16_f32 v236, v44, v45
  v_cvt_pk_bf16_f32 v237, v46, v47
  v_mfma_f32_16x16x32_bf16 v[64:67], a[236:239], v[172:175], v[64:67]
  ds_read_b64_tr_b16 a[230:231], v6 offset:384
  v_cvt_pk_bf16_f32 v238, v56, v57
  v_cvt_pk_bf16_f32 v239, v58, v59
  v_mfma_f32_16x16x32_bf16 v[64:67], a[232:235], v[160:163], v[64:67]
  buffer_load_dwordx4 a[32:35], v30, s[40:43], 0 offen sc1
  s_waitcnt lgkmcnt(8)
  v_mfma_f32_16x16x32_bf16 v[76:79], a[240:243], v[160:163], v[76:79]
  ds_read_b64_tr_b16 a[232:233], v6 offset:512
  buffer_store_dwordx4 v[232:235], v7, s[24:27], 0 offen sc1
  v_mfma_f32_16x16x32_bf16 v[76:79], a[244:247], v[172:175], v[76:79]
  ds_read_b64_tr_b16 a[234:235], v6 offset:640
  v_cvt_pk_bf16_f32 v240, v48, v49
  v_cvt_pk_bf16_f32 v241, v50, v51
  v_mfma_f32_16x16x32_bf16 v[80:83], a[244:247], v[176:179], v[80:83]
  v_cvt_pk_bf16_f32 v242, v60, v61
  v_cvt_pk_bf16_f32 v243, v62, v63
  v_mfma_f32_16x16x32_bf16 v[80:83], a[240:243], v[164:167], v[80:83]
  ds_read_b64_tr_b16 a[236:237], v6 offset:768
  v_mfma_f32_16x16x32_bf16 v[84:87], a[240:243], v[168:171], v[84:87]
  ds_read_b64_tr_b16 a[238:239], v6 offset:896
  v_mfma_f32_16x16x32_bf16 v[84:87], a[244:247], v[180:183], v[84:87]
  buffer_load_dwordx4 a[36:39], v30, s[40:43], s81 offen sc1
  s_waitcnt lgkmcnt(8)
  v_mfma_f32_16x16x32_bf16 v[84:87], a[252:255], v[156:159], v[84:87]
  ds_read_b64_tr_b16 a[240:241], v6 offset:544
  buffer_store_dwordx4 v[236:239], v7, s[24:27], s77 offen sc1
  v_mfma_f32_16x16x32_bf16 v[84:87], a[248:251], v[144:147], v[84:87]
  ds_read_b64_tr_b16 a[242:243], v6 offset:672
  v_mfma_f32_16x16x32_bf16 v[80:83], a[248:251], v[140:143], v[80:83]
  v_mfma_f32_16x16x32_bf16 v[80:83], a[252:255], v[152:155], v[80:83]
  ds_read_b64_tr_b16 a[244:245], v6 offset:800
  v_mfma_f32_16x16x32_bf16 v[76:79], a[252:255], v[148:151], v[76:79]
  ds_read_b64_tr_b16 a[246:247], v6 offset:928
  v_mfma_f32_16x16x32_bf16 v[76:79], a[248:251], v[136:139], v[76:79]
  buffer_load_dwordx4 a[40:43], v30, s[40:43], s82 offen sc1
  s_waitcnt lgkmcnt(8)
  v_mfma_f32_16x16x32_bf16 v[184:187], a[224:227], v[88:91], 0
  ds_read_b64_tr_b16 a[248:249], v6 offset:32
  buffer_store_dwordx4 v[240:243], v7, s[24:27], s79 offen sc1
  v_mfma_f32_16x16x32_bf16 v[184:187], a[228:231], v[100:103], v[184:187]
  ds_read_b64_tr_b16 a[250:251], v6 offset:160
  v_mfma_f32_16x16x32_bf16 v[188:191], a[228:231], v[104:107], 0
  v_cvt_pk_bf16_f32 v244, v64, v65
  v_cvt_pk_bf16_f32 v245, v66, v67
  v_mfma_f32_16x16x32_bf16 v[188:191], a[224:227], v[92:95], v[188:191]
  ds_read_b64_tr_b16 a[252:253], v6 offset:288
  v_mfma_f32_16x16x32_bf16 v[192:195], a[224:227], v[96:99], 0
  ds_read_b64_tr_b16 a[254:255], v6 offset:416
  v_cvt_pk_bf16_f32 v246, v76, v77
  v_cvt_pk_bf16_f32 v247, v78, v79
  v_mfma_f32_16x16x32_bf16 v[192:195], a[228:231], v[108:111], v[192:195]
  buffer_load_dwordx4 a[44:47], v30, s[40:43], s83 offen sc1
  s_waitcnt lgkmcnt(8)
  v_mfma_f32_16x16x32_bf16 v[192:195], a[236:239], v[132:135], v[192:195]
  ds_read_b64_tr_b16 a[224:225], v6 offset:64
  buffer_store_dwordx4 v[244:247], v7, s[24:27], s76 offen sc1
  v_cvt_pk_bf16_f32 v248, v68, v69
  v_mfma_f32_16x16x32_bf16 v[192:195], a[232:235], v[120:123], v[192:195]
  ds_read_b64_tr_b16 a[226:227], v6 offset:192
  v_cvt_pk_bf16_f32 v249, v70, v71
  v_mfma_f32_16x16x32_bf16 v[188:191], a[232:235], v[116:119], v[188:191]
  v_cvt_pk_bf16_f32 v250, v80, v81
  v_cvt_pk_bf16_f32 v251, v82, v83
  v_mfma_f32_16x16x32_bf16 v[188:191], a[236:239], v[128:131], v[188:191]
  ds_read_b64_tr_b16 a[228:229], v6 offset:320
  v_mfma_f32_16x16x32_bf16 v[184:187], a[236:239], v[124:127], v[184:187]
  ds_read_b64_tr_b16 a[230:231], v6 offset:448
  v_cvt_pk_bf16_f32 v252, v72, v73
  v_cvt_pk_bf16_f32 v253, v74, v75
  v_mfma_f32_16x16x32_bf16 v[184:187], a[232:235], v[112:115], v[184:187]
  buffer_load_dwordx4 a[48:51], v31, s[40:43], 0 offen sc1
  s_waitcnt lgkmcnt(8)
  v_mfma_f32_16x16x32_bf16 v[196:199], a[240:243], v[112:115], 0
  ds_read_b64_tr_b16 a[232:233], v6 offset:576
  buffer_store_dwordx4 v[248:251], v7, s[24:27], s78 offen sc1
  v_cvt_pk_bf16_f32 v254, v84, v85
  v_mfma_f32_16x16x32_bf16 v[196:199], a[244:247], v[124:127], v[196:199]
  ds_read_b64_tr_b16 a[234:235], v6 offset:704
  v_cvt_pk_bf16_f32 v255, v86, v87
  v_mfma_f32_16x16x32_bf16 v[200:203], a[244:247], v[128:131], 0
  v_mfma_f32_16x16x32_bf16 v[200:203], a[240:243], v[116:119], v[200:203]
  ds_read_b64_tr_b16 a[236:237], v6 offset:832
  v_mfma_f32_16x16x32_bf16 v[204:207], a[240:243], v[120:123], 0
  ds_read_b64_tr_b16 a[238:239], v6 offset:960
  v_mfma_f32_16x16x32_bf16 v[204:207], a[244:247], v[132:135], v[204:207]
  buffer_load_dwordx4 a[52:55], v31, s[40:43], s82 offen sc1
  v_add_u32 v30, 0x60000, v30
  s_waitcnt lgkmcnt(8)
  v_mfma_f32_16x16x32_bf16 v[204:207], a[252:255], v[108:111], v[204:207]
  ds_read_b64_tr_b16 a[240:241], v6 offset:608
  v_add_u32 v31, 0x60000, v31
  buffer_store_dwordx4 v[252:255], v7, s[24:27], s80 offen sc1
  v_mfma_f32_16x16x32_bf16 v[204:207], a[248:251], v[96:99], v[204:207]
  ds_read_b64_tr_b16 a[242:243], v6 offset:736
  v_add_u32 v7, 0x60000, v7
  v_mfma_f32_16x16x32_bf16 v[200:203], a[248:251], v[92:95], v[200:203]
  v_mfma_f32_16x16x32_bf16 v[200:203], a[252:255], v[104:107], v[200:203]
  ds_read_b64_tr_b16 a[244:245], v6 offset:864
  v_mfma_f32_16x16x32_bf16 v[196:199], a[252:255], v[100:103], v[196:199]
  ds_read_b64_tr_b16 a[246:247], v6 offset:992
  v_mfma_f32_16x16x32_bf16 v[196:199], a[248:251], v[88:91], v[196:199]
  s_waitcnt lgkmcnt(8)
  v_mfma_f32_16x16x32_bf16 v[208:211], a[224:227], v[88:91], 0
  ds_read_b64_tr_b16 a[248:249], v6 offset:96
  v_mfma_f32_16x16x32_bf16 v[208:211], a[228:231], v[100:103], v[208:211]
  ds_read_b64_tr_b16 a[250:251], v6 offset:224
  v_mfma_f32_16x16x32_bf16 v[212:215], a[228:231], v[104:107], 0
  v_mfma_f32_16x16x32_bf16 v[212:215], a[224:227], v[92:95], v[212:215]
  ds_read_b64_tr_b16 a[252:253], v6 offset:352
  v_mfma_f32_16x16x32_bf16 v[216:219], a[224:227], v[96:99], 0
  ds_read_b64_tr_b16 a[254:255], v6 offset:480
  v_mfma_f32_16x16x32_bf16 v[216:219], a[228:231], v[108:111], v[216:219]
  s_waitcnt lgkmcnt(8)
  v_mfma_f32_16x16x32_bf16 v[216:219], a[236:239], v[132:135], v[216:219]
  v_mfma_f32_16x16x32_bf16 v[216:219], a[232:235], v[120:123], v[216:219]
  v_add_u32 v6, 101376, v5
  ds_read_b64_tr_b16 a[224:225], v6 offset:0
  v_mfma_f32_16x16x32_bf16 v[212:215], a[232:235], v[116:119], v[212:215]
  ds_read_b64_tr_b16 a[226:227], v6 offset:128
  v_mfma_f32_16x16x32_bf16 v[212:215], a[236:239], v[128:131], v[212:215]
  ds_read_b64_tr_b16 a[228:229], v6 offset:256
  v_mfma_f32_16x16x32_bf16 v[208:211], a[236:239], v[124:127], v[208:211]
  ds_read_b64_tr_b16 a[230:231], v6 offset:384
  v_mfma_f32_16x16x32_bf16 v[208:211], a[232:235], v[112:115], v[208:211]
  s_waitcnt lgkmcnt(8)
  v_mfma_f32_16x16x32_bf16 v[220:223], a[240:243], v[112:115], 0
  ds_read_b64_tr_b16 a[232:233], v6 offset:512
  v_mfma_f32_16x16x32_bf16 v[220:223], a[244:247], v[124:127], v[220:223]
  ds_read_b64_tr_b16 a[234:235], v6 offset:640
  v_mfma_f32_16x16x32_bf16 v[224:227], a[244:247], v[128:131], 0
  v_mfma_f32_16x16x32_bf16 v[224:227], a[240:243], v[116:119], v[224:227]
  ds_read_b64_tr_b16 a[236:237], v6 offset:768
  v_mfma_f32_16x16x32_bf16 v[228:231], a[240:243], v[120:123], 0
  ds_read_b64_tr_b16 a[238:239], v6 offset:896
  v_mfma_f32_16x16x32_bf16 v[228:231], a[244:247], v[132:135], v[228:231]
  s_waitcnt lgkmcnt(8)
  v_mfma_f32_16x16x32_bf16 v[228:231], a[252:255], v[108:111], v[228:231]
  ds_read_b64_tr_b16 a[240:241], v6 offset:544
  v_mfma_f32_16x16x32_bf16 v[228:231], a[248:251], v[96:99], v[228:231]
  ds_read_b64_tr_b16 a[242:243], v6 offset:672
  v_mfma_f32_16x16x32_bf16 v[224:227], a[248:251], v[92:95], v[224:227]
  v_mfma_f32_16x16x32_bf16 v[224:227], a[252:255], v[104:107], v[224:227]
  ds_read_b64_tr_b16 a[244:245], v6 offset:800
  v_mfma_f32_16x16x32_bf16 v[220:223], a[252:255], v[100:103], v[220:223]
  ds_read_b64_tr_b16 a[246:247], v6 offset:928
  s_waitcnt vmcnt(0)
  v_mfma_f32_16x16x32_bf16 v[220:223], a[248:251], v[88:91], v[220:223]
  v_mov_b32 v8, 5
  buffer_store_dword v8, v28, s[44:47], 0 offen sc1
  v_mfma_f32_16x16x32_bf16 v[20:23], a[172:175], a[32:35], 0
  v_mfma_f32_16x16x32_bf16 v[20:23], a[172:175], a[36:39], v[20:23]
  v_mfma_f32_16x16x32_bf16 v[20:23], a[172:175], a[40:43], v[20:23]
  v_mfma_f32_16x16x32_bf16 v[20:23], a[172:175], a[44:47], v[20:23]
  v_mfma_f32_16x16x32_bf16 v[20:23], a[176:179], a[48:51], v[20:23]
  v_mfma_f32_16x16x32_bf16 v[20:23], a[176:179], a[52:55], v[20:23]
  s_waitcnt lgkmcnt(8)
  v_mfma_f32_16x16x32_bf16 v[184:187], a[224:227], v[136:139], v[184:187]
  ds_read_b64_tr_b16 a[248:249], v6 offset:32
  v_mfma_f32_16x16x32_bf16 v[184:187], a[228:231], v[148:151], v[184:187]
  ds_read_b64_tr_b16 a[250:251], v6 offset:160
  v_mfma_f32_16x16x32_bf16 v[188:191], a[228:231], v[152:155], v[188:191]
  v_mfma_f32_16x16x32_bf16 v[188:191], a[224:227], v[140:143], v[188:191]
  ds_read_b64_tr_b16 a[252:253], v6 offset:288
  v_mfma_f32_16x16x32_bf16 v[192:195], a[224:227], v[144:147], v[192:195]
  ds_read_b64_tr_b16 a[254:255], v6 offset:416
  v_mfma_f32_16x16x32_bf16 v[192:195], a[228:231], v[156:159], v[192:195]
  s_waitcnt lgkmcnt(8)
  v_mfma_f32_16x16x32_bf16 v[192:195], a[236:239], v[180:183], v[192:195]
  ds_read_b64_tr_b16 a[224:225], v6 offset:64
  v_mfma_f32_16x16x32_bf16 v[192:195], a[232:235], v[168:171], v[192:195]
  ds_read_b64_tr_b16 a[226:227], v6 offset:192
  v_mfma_f32_16x16x32_bf16 v[188:191], a[232:235], v[164:167], v[188:191]
  v_mfma_f32_16x16x32_bf16 v[188:191], a[236:239], v[176:179], v[188:191]
  ds_read_b64_tr_b16 a[228:229], v6 offset:320
  v_mfma_f32_16x16x32_bf16 v[184:187], a[236:239], v[172:175], v[184:187]
  ds_read_b64_tr_b16 a[230:231], v6 offset:448
  v_mfma_f32_16x16x32_bf16 v[184:187], a[232:235], v[160:163], v[184:187]
  s_waitcnt lgkmcnt(8)
  v_mfma_f32_16x16x32_bf16 v[196:199], a[240:243], v[160:163], v[196:199]
  ds_read_b64_tr_b16 a[232:233], v6 offset:576
  v_mfma_f32_16x16x32_bf16 v[196:199], a[244:247], v[172:175], v[196:199]
  ds_read_b64_tr_b16 a[234:235], v6 offset:704
  v_mfma_f32_16x16x32_bf16 v[200:203], a[244:247], v[176:179], v[200:203]
  buffer_load_dword v24, v29, s[44:47], 0 offen sc1
  v_mfma_f32_16x16x32_bf16 v[200:203], a[240:243], v[164:167], v[200:203]
  ds_read_b64_tr_b16 a[236:237], v6 offset:832
  v_mfma_f32_16x16x32_bf16 v[204:207], a[240:243], v[168:171], v[204:207]
  ds_read_b64_tr_b16 a[238:239], v6 offset:960
  v_add_f32_dpp v20, v20, v20 row_ror:8 row_mask:0xc bank_mask:0xf
  v_mfma_f32_16x16x32_bf16 v[204:207], a[244:247], v[180:183], v[204:207]
  v_add_f32_dpp v21, v21, v21 row_ror:8 row_mask:0xc bank_mask:0xf
  s_waitcnt lgkmcnt(8)
  v_mfma_f32_16x16x32_bf16 v[204:207], a[252:255], v[156:159], v[204:207]
  ds_read_b64_tr_b16 a[240:241], v6 offset:608
  v_add_f32_dpp v22, v22, v22 row_ror:8 row_mask:0xc bank_mask:0xf
  v_mfma_f32_16x16x32_bf16 v[204:207], a[248:251], v[144:147], v[204:207]
  ds_read_b64_tr_b16 a[242:243], v6 offset:736
  v_add_f32_dpp v23, v23, v23 row_ror:8 row_mask:0xc bank_mask:0xf
  v_mfma_f32_16x16x32_bf16 v[200:203], a[248:251], v[140:143], v[200:203]
  v_cvt_pk_bf16_f32 v20, v20, v21
  v_cvt_pk_bf16_f32 v21, v22, v23
  v_mfma_f32_16x16x32_bf16 v[200:203], a[252:255], v[152:155], v[200:203]
  ds_read_b64_tr_b16 a[244:245], v6 offset:864
  buffer_store_dwordx2 v[20:21], v32, s[28:31], s57 offen offset:384
  v_mfma_f32_16x16x32_bf16 v[196:199], a[252:255], v[148:151], v[196:199]
  ds_read_b64_tr_b16 a[246:247], v6 offset:992
  v_mfma_f32_16x16x32_bf16 v[196:199], a[248:251], v[136:139], v[196:199]
  s_waitcnt lgkmcnt(8)
  v_mfma_f32_16x16x32_bf16 v[208:211], a[224:227], v[136:139], v[208:211]
  ds_read_b64_tr_b16 a[248:249], v6 offset:96
  v_mfma_f32_16x16x32_bf16 v[208:211], a[228:231], v[148:151], v[208:211]
  ds_read_b64_tr_b16 a[250:251], v6 offset:224
  v_mfma_f32_16x16x32_bf16 v[212:215], a[228:231], v[152:155], v[212:215]
  v_mfma_f32_16x16x32_bf16 v[212:215], a[224:227], v[140:143], v[212:215]
  ds_read_b64_tr_b16 a[252:253], v6 offset:352
  v_mfma_f32_16x16x32_bf16 v[216:219], a[224:227], v[144:147], v[216:219]
  ds_read_b64_tr_b16 a[254:255], v6 offset:480
  v_cvt_pk_bf16_f32 v232, v184, v185
  v_cvt_pk_bf16_f32 v233, v186, v187
  v_mfma_f32_16x16x32_bf16 v[216:219], a[228:231], v[156:159], v[216:219]
  s_waitcnt lgkmcnt(8)
  v_mfma_f32_16x16x32_bf16 v[216:219], a[236:239], v[180:183], v[216:219]
  v_cvt_pk_bf16_f32 v234, v196, v197
  v_cvt_pk_bf16_f32 v235, v198, v199
  v_mfma_f32_16x16x32_bf16 v[216:219], a[232:235], v[168:171], v[216:219]
  v_add_u32 v6, 118272, v5
  ds_read_b64_tr_b16 a[224:225], v6 offset:0
  v_mfma_f32_16x16x32_bf16 v[212:215], a[232:235], v[164:167], v[212:215]
  ds_read_b64_tr_b16 a[226:227], v6 offset:128
  s_waitcnt vmcnt(1)
  v_cmp_gt_u32 vcc, 5, v24
  s_cbranch_vccz L_go11
L_poll11:
  buffer_load_dword v24, v29, s[44:47], 0 offen sc1
  s_sub_u32 s39, s39, 1
  s_waitcnt vmcnt(0)
  v_cmp_gt_u32 vcc, 5, v24
  s_cbranch_scc1 L_giveup
  s_cbranch_vccnz L_poll11
L_go11:
  v_mfma_f32_16x16x32_bf16 v[212:215], a[236:239], v[176:179], v[212:215]
  ds_read_b64_tr_b16 a[228:229], v6 offset:256
  v_cvt_pk_bf16_f32 v236, v188, v189
  v_cvt_pk_bf16_f32 v237, v190, v191
  v_mfma_f32_16x16x32_bf16 v[208:211], a[236:239], v[172:175], v[208:211]
  ds_read_b64_tr_b16 a[230:231], v6 offset:384
  v_cvt_pk_bf16_f32 v238, v200, v201
  v_cvt_pk_bf16_f32 v239, v202, v203
  v_mfma_f32_16x16x32_bf16 v[208:211], a[232:235], v[160:163], v[208:211]
  buffer_load_dwordx4 a[0:3], v30, s[40:43], 0 offen sc1
  s_waitcnt lgkmcnt(8)
  v_mfma_f32_16x16x32_bf16 v[220:223], a[240:243], v[160:163], v[220:223]
  ds_read_b64_tr_b16 a[232:233], v6 offset:512
  buffer_store_dwordx4 v[232:235], v7, s[24:27], 0 offen sc1
  v_mfma_f32_16x16x32_bf16 v[220:223], a[244:247], v[172:175], v[220:223]
  ds_read_b64_tr_b16 a[234:235], v6 offset:640
  v_cvt_pk_bf16_f32 v240, v192, v193
  v_cvt_pk_bf16_f32 v241, v194, v195
  v_mfma_f32_16x16x32_bf16 v[224:227], a[244:247], v[176:179], v[224:227]
  v_cvt_pk_bf16_f32 v242, v204, v205
  v_cvt_pk_bf16_f32 v243, v206, v207
  v_mfma_f32_16x16x32_bf16 v[224:227], a[240:243], v[164:167], v[224:227]
  ds_read_b64_tr_b16 a[236:237], v6 offset:768
  v_mfma_f32_16x16x32_bf16 v[228:231], a[240:243], v[168:171], v[228:231]
  ds_read_b64_tr_b16 a[238:239], v6 offset:896
  v_mfma_f32_16x16x32_bf16 v[228:231], a[244:247], v[180:183], v[228:231]
  buffer_load_dwordx4 a[4:7], v30, s[40:43], s81 offen sc1
  s_waitcnt lgkmcnt(8)
  v_mfma_f32_16x16x32_bf16 v[228:231], a[252:255], v[156:159], v[228:231]
  ds_read_b64_tr_b16 a[240:241], v6 offset:544
  buffer_store_dwordx4 v[236:239], v7, s[24:27], s77 offen sc1
  v_mfma_f32_16x16x32_bf16 v[228:231], a[248:251], v[144:147], v[228:231]
  ds_read_b64_tr_b16 a[242:243], v6 offset:672
  v_mfma_f32_16x16x32_bf16 v[224:227], a[248:251], v[140:143], v[224:227]
  v_mfma_f32_16x16x32_bf16 v[224:227], a[252:255], v[152:155], v[224:227]
  ds_read_b64_tr_b16 a[244:245], v6 offset:800
  v_mfma_f32_16x16x32_bf16 v[220:223], a[252:255], v[148:151], v[220:223]
  ds_read_b64_tr_b16 a[246:247], v6 offset:928
  v_mfma_f32_16x16x32_bf16 v[220:223], a[248:251], v[136:139], v[220:223]
  buffer_load_dwordx4 a[8:11], v30, s[40:43], s82 offen sc1
  s_waitcnt lgkmcnt(8)
  v_mfma_f32_16x16x32_bf16 v[40:43], a[224:227], v[88:91], 0
  ds_read_b64_tr_b16 a[248:249], v6 offset:32
  buffer_store_dwordx4 v[240:243], v7, s[24:27], s79 offen sc1
  v_mfma_f32_16x16x32_bf16 v[40:43], a[228:231], v[100:103], v[40:43]
  ds_read_b64_tr_b16 a[250:251], v6 offset:160
  v_mfma_f32_16x16x32_bf16 v[44:47], a[228:231], v[104:107], 0
  v_cvt_pk_bf16_f32 v244, v208, v209
  v_cvt_pk_bf16_f32 v245, v210, v211
  v_mfma_f32_16x16x32_bf16 v[44:47], a[224:227], v[92:95], v[44:47]
  ds_read_b64_tr_b16 a[252:253], v6 offset:288
  v_mfma_f32_16x16x32_bf16 v[48:51], a[224:227], v[96:99], 0
  ds_read_b64_tr_b16 a[254:255], v6 offset:416
  v_cvt_pk_bf16_f32 v246, v220, v221
  v_cvt_pk_bf16_f32 v247, v222, v223
  v_mfma_f32_16x16x32_bf16 v[48:51], a[228:231], v[108:111], v[48:51]
  buffer_load_dwordx4 a[12:15], v30, s[40:43], s83 offen sc1
  s_waitcnt lgkmcnt(8)
  v_mfma_f32_16x16x32_bf16 v[48:51], a[236:239], v[132:135], v[48:51]
  ds_read_b64_tr_b16 a[224:225], v6 offset:64
  buffer_store_dwordx4 v[244:247], v7, s[24:27], s76 offen sc1
  v_cvt_pk_bf16_f32 v248, v212, v213
  v_mfma_f32_16x16x32_bf16 v[48:51], a[232:235], v[120:123], v[48:51]
  ds_read_b64_tr_b16 a[226:227], v6 offset:192
  v_cvt_pk_bf16_f32 v249, v214, v215
  v_mfma_f32_16x16x32_bf16 v[44:47], a[232:235], v[116:119], v[44:47]
  v_cvt_pk_bf16_f32 v250, v224, v225
  v_cvt_pk_bf16_f32 v251, v226, v227
  v_mfma_f32_16x16x32_bf16 v[44:47], a[236:239], v[128:131], v[44:47]
  ds_read_b64_tr_b16 a[228:229], v6 offset:320
  v_mfma_f32_16x16x32_bf16 v[40:43], a[236:239], v[124:127], v[40:43]
  ds_read_b64_tr_b16 a[230:231], v6 offset:448
  v_cvt_pk_bf16_f32 v252, v216, v217
  v_cvt_pk_bf16_f32 v253, v218, v219
  v_mfma_f32_16x16x32_bf16 v[40:43], a[232:235], v[112:115], v[40:43]
  buffer_load_dwordx4 a[16:19], v31, s[40:43], 0 offen sc1
  s_waitcnt lgkmcnt(8)
  v_mfma_f32_16x16x32_bf16 v[52:55], a[240:243], v[112:115], 0
  ds_read_b64_tr_b16 a[232:233], v6 offset:576
  buffer_store_dwordx4 v[248:251], v7, s[24:27], s78 offen sc1
  v_cvt_pk_bf16_f32 v254, v228, v229
  v_mfma_f32_16x16x32_bf16 v[52:55], a[244:247], v[124:127], v[52:55]
  ds_read_b64_tr_b16 a[234:235], v6 offset:704
  v_cvt_pk_bf16_f32 v255, v230, v231
  v_mfma_f32_16x16x32_bf16 v[56:59], a[244:247], v[128:131], 0
  v_mfma_f32_16x16x32_bf16 v[56:59], a[240:243], v[116:119], v[56:59]
  ds_read_b64_tr_b16 a[236:237], v6 offset:832
  v_mfma_f32_16x16x32_bf16 v[60:63], a[240:243], v[120:123], 0
  ds_read_b64_tr_b16 a[238:239], v6 offset:960
  v_mfma_f32_16x16x32_bf16 v[60:63], a[244:247], v[132:135], v[60:63]
  buffer_load_dwordx4 a[20:23], v31, s[40:43], s82 offen sc1
  v_add_u32 v30, 0x60000, v30
  s_waitcnt lgkmcnt(8)
  v_mfma_f32_16x16x32_bf16 v[60:63], a[252:255], v[108:111], v[60:63]
  ds_read_b64_tr_b16 a[240:241], v6 offset:608
  v_add_u32 v31, 0x60000, v31
  buffer_store_dwordx4 v[252:255], v7, s[24:27], s80 offen sc1
  v_mfma_f32_16x16x32_bf16 v[60:63], a[248:251], v[96:99], v[60:63]
  ds_read_b64_tr_b16 a[242:243], v6 offset:736
  v_add_u32 v7, 0x60000, v7
  v_mfma_f32_16x16x32_bf16 v[56:59], a[248:251], v[92:95], v[56:59]
  v_mfma_f32_16x16x32_bf16 v[56:59], a[252:255], v[104:107], v[56:59]
  ds_read_b64_tr_b16 a[244:245], v6 offset:864
  v_mfma_f32_16x16x32_bf16 v[52:55], a[252:255], v[100:103], v[52:55]
  ds_read_b64_tr_b16 a[246:247], v6 offset:992
  v_mfma_f32_16x16x32_bf16 v[52:55], a[248:251], v[88:91], v[52:55]
  s_waitcnt lgkmcnt(8)
  v_mfma_f32_16x16x32_bf16 v[64:67], a[224:227], v[88:91], 0
  ds_read_b64_tr_b16 a[248:249], v6 offset:96
  v_mfma_f32_16x16x32_bf16 v[64:67], a[228:231], v[100:103], v[64:67]
  ds_read_b64_tr_b16 a[250:251], v6 offset:224
  v_mfma_f32_16x16x32_bf16 v[68:71], a[228:231], v[104:107], 0
  v_mfma_f32_16x16x32_bf16 v[68:71], a[224:227], v[92:95], v[68:71]
  ds_read_b64_tr_b16 a[252:253], v6 offset:352
  v_mfma_f32_16x16x32_bf16 v[72:75], a[224:227], v[96:99], 0
  ds_read_b64_tr_b16 a[254:255], v6 offset:480
  v_mfma_f32_16x16x32_bf16 v[72:75], a[228:231], v[108:111], v[72:75]
  s_waitcnt lgkmcnt(8)
  v_mfma_f32_16x16x32_bf16 v[72:75], a[236:239], v[132:135], v[72:75]
  s_waitcnt vmcnt(29)
  s_barrier
  v_mfma_f32_16x16x32_bf16 v[72:75], a[232:235], v[120:123], v[72:75]
  v_add_u32 v6, 84480, v5
  ds_read_b64_tr_b16 a[224:225], v6 offset:0
  v_mfma_f32_16x16x32_bf16 v[68:71], a[232:235], v[116:119], v[68:71]
  ds_read_b64_tr_b16 a[226:227], v6 offset:128
  v_mfma_f32_16x16x32_bf16 v[68:71], a[236:239], v[128:131], v[68:71]
  ds_read_b64_tr_b16 a[228:229], v6 offset:256
  v_mfma_f32_16x16x32_bf16 v[64:67], a[236:239], v[124:127], v[64:67]
  ds_read_b64_tr_b16 a[230:231], v6 offset:384
  v_mfma_f32_16x16x32_bf16 v[64:67], a[232:235], v[112:115], v[64:67]
  s_waitcnt lgkmcnt(8)
  v_mfma_f32_16x16x32_bf16 v[76:79], a[240:243], v[112:115], 0
  ds_read_b64_tr_b16 a[232:233], v6 offset:512
  v_mfma_f32_16x16x32_bf16 v[76:79], a[244:247], v[124:127], v[76:79]
  ds_read_b64_tr_b16 a[234:235], v6 offset:640
  v_mfma_f32_16x16x32_bf16 v[80:83], a[244:247], v[128:131], 0
  v_mfma_f32_16x16x32_bf16 v[80:83], a[240:243], v[116:119], v[80:83]
  ds_read_b64_tr_b16 a[236:237], v6 offset:768
  v_mfma_f32_16x16x32_bf16 v[84:87], a[240:243], v[120:123], 0
  ds_read_b64_tr_b16 a[238:239], v6 offset:896
  v_mfma_f32_16x16x32_bf16 v[84:87], a[244:247], v[132:135], v[84:87]
  s_waitcnt lgkmcnt(8)
  v_mfma_f32_16x16x32_bf16 v[84:87], a[252:255], v[108:111], v[84:87]
  ds_read_b64_tr_b16 a[240:241], v6 offset:544
  v_mfma_f32_16x16x32_bf16 v[84:87], a[248:251], v[96:99], v[84:87]
  ds_read_b64_tr_b16 a[242:243], v6 offset:672
  v_mfma_f32_16x16x32_bf16 v[80:83], a[248:251], v[92:95], v[80:83]
  v_mfma_f32_16x16x32_bf16 v[80:83], a[252:255], v[104:107], v[80:83]
  ds_read_b64_tr_b16 a[244:245], v6 offset:800
  v_mfma_f32_16x16x32_bf16 v[76:79], a[252:255], v[100:103], v[76:79]
  ds_read_b64_tr_b16 a[246:247], v6 offset:928
  s_waitcnt vmcnt(0)
  v_mfma_f32_16x16x32_bf16 v[76:79], a[248:251], v[88:91], v[76:79]
  v_mov_b32 v8, 6
  buffer_store_dword v8, v28, s[44:47], 0 offen sc1
  v_mfma_f32_16x16x32_bf16 v[20:23], a[172:175], a[0:3], 0
  v_mfma_f32_16x16x32_bf16 v[20:23], a[172:175], a[4:7], v[20:23]
  v_mfma_f32_16x16x32_bf16 v[20:23], a[172:175], a[8:11], v[20:23]
  v_mfma_f32_16x16x32_bf16 v[20:23], a[172:175], a[12:15], v[20:23]
  v_mfma_f32_16x16x32_bf16 v[20:23], a[176:179], a[16:19], v[20:23]
  v_mfma_f32_16x16x32_bf16 v[20:23], a[176:179], a[20:23], v[20:23]
  s_waitcnt lgkmcnt(8)
  v_mfma_f32_16x16x32_bf16 v[40:43], a[224:227], v[136:139], v[40:43]
  ds_read_b64_tr_b16 a[248:249], v6 offset:32
  v_mfma_f32_16x16x32_bf16 v[40:43], a[228:231], v[148:151], v[40:43]
  ds_read_b64_tr_b16 a[250:251], v6 offset:160
  v_mfma_f32_16x16x32_bf16 v[44:47], a[228:231], v[152:155], v[44:47]
  v_mfma_f32_16x16x32_bf16 v[44:47], a[224:227], v[140:143], v[44:47]
  ds_read_b64_tr_b16 a[252:253], v6 offset:288
  v_mfma_f32_16x16x32_bf16 v[48:51], a[224:227], v[144:147], v[48:51]
  ds_read_b64_tr_b16 a[254:255], v6 offset:416
  v_mfma_f32_16x16x32_bf16 v[48:51], a[228:231], v[156:159], v[48:51]
  s_waitcnt lgkmcnt(8)
  v_mfma_f32_16x16x32_bf16 v[48:51], a[236:239], v[180:183], v[48:51]
  ds_read_b64_tr_b16 a[224:225], v6 offset:64
  v_mfma_f32_16x16x32_bf16 v[48:51], a[232:235], v[168:171], v[48:51]
  ds_read_b64_tr_b16 a[226:227], v6 offset:192
  v_mfma_f32_16x16x32_bf16 v[44:47], a[232:235], v[164:167], v[44:47]
  v_mfma_f32_16x16x32_bf16 v[44:47], a[236:239], v[176:179], v[44:47]
  ds_read_b64_tr_b16 a[228:229], v6 offset:320
  v_mfma_f32_16x16x32_bf16 v[40:43], a[236:239], v[172:175], v[40:43]
  ds_read_b64_tr_b16 a[230:231], v6 offset:448
  v_mfma_f32_16x16x32_bf16 v[40:43], a[232:235], v[160:163], v[40:43]
  s_waitcnt lgkmcnt(8)
  v_mfma_f32_16x16x32_bf16 v[52:55], a[240:243], v[160:163], v[52:55]
  ds_read_b64_tr_b16 a[232:233], v6 offset:576
  v_mfma_f32_16x16x32_bf16 v[52:55], a[244:247], v[172:175], v[52:55]
  ds_read_b64_tr_b16 a[234:235], v6 offset:704
  v_mfma_f32_16x16x32_bf16 v[56:59], a[244:247], v[176:179], v[56:59]
  buffer_load_dword v24, v29, s[44:47], 0 offen sc1
  v_mfma_f32_16x16x32_bf16 v[56:59], a[240:243], v[164:167], v[56:59]
  ds_read_b64_tr_b16 a[236:237], v6 offset:832
  v_mfma_f32_16x16x32_bf16 v[60:63], a[240:243], v[168:171], v[60:63]
  ds_read_b64_tr_b16 a[238:239], v6 offset:960
  v_add_f32_dpp v20, v20, v20 row_ror:8 row_mask:0xc bank_mask:0xf
  v_mfma_f32_16x16x32_bf16 v[60:63], a[244:247], v[180:183], v[60:63]
  v_add_f32_dpp v21, v21, v21 row_ror:8 row_mask:0xc bank_mask:0xf
  s_waitcnt lgkmcnt(8)
  v_mfma_f32_16x16x32_bf16 v[60:63], a[252:255], v[156:159], v[60:63]
  ds_read_b64_tr_b16 a[240:241], v6 offset:608
  v_add_f32_dpp v22, v22, v22 row_ror:8 row_mask:0xc bank_mask:0xf
  v_mfma_f32_16x16x32_bf16 v[60:63], a[248:251], v[144:147], v[60:63]
  ds_read_b64_tr_b16 a[242:243], v6 offset:736
  v_add_f32_dpp v23, v23, v23 row_ror:8 row_mask:0xc bank_mask:0xf
  v_mfma_f32_16x16x32_bf16 v[56:59], a[248:251], v[140:143], v[56:59]
  v_cvt_pk_bf16_f32 v20, v20, v21
  v_cvt_pk_bf16_f32 v21, v22, v23
  v_mfma_f32_16x16x32_bf16 v[56:59], a[252:255], v[152:155], v[56:59]
  ds_read_b64_tr_b16 a[244:245], v6 offset:864
  buffer_store_dwordx2 v[20:21], v32, s[28:31], s57 offen offset:512
  v_mfma_f32_16x16x32_bf16 v[52:55], a[252:255], v[148:151], v[52:55]
  ds_read_b64_tr_b16 a[246:247], v6 offset:992
  v_mfma_f32_16x16x32_bf16 v[52:55], a[248:251], v[136:139], v[52:55]
  s_waitcnt lgkmcnt(8)
  v_mfma_f32_16x16x32_bf16 v[64:67], a[224:227], v[136:139], v[64:67]
  ds_read_b64_tr_b16 a[248:249], v6 offset:96
  v_mfma_f32_16x16x32_bf16 v[64:67], a[228:231], v[148:151], v[64:67]
  ds_read_b64_tr_b16 a[250:251], v6 offset:224
  v_mfma_f32_16x16x32_bf16 v[68:71], a[228:231], v[152:155], v[68:71]
  v_mfma_f32_16x16x32_bf16 v[68:71], a[224:227], v[140:143], v[68:71]
  ds_read_b64_tr_b16 a[252:253], v6 offset:352
  v_mfma_f32_16x16x32_bf16 v[72:75], a[224:227], v[144:147], v[72:75]
  ds_read_b64_tr_b16 a[254:255], v6 offset:480
  v_cvt_pk_bf16_f32 v232, v40, v41
  v_mfma_f32_16x16x32_bf16 v[72:75], a[228:231], v[156:159], v[72:75]
  v_cvt_pk_bf16_f32 v233, v42, v43
  s_waitcnt lgkmcnt(8)
  v_mfma_f32_16x16x32_bf16 v[72:75], a[236:239], v[180:183], v[72:75]
  v_cvt_pk_bf16_f32 v234, v52, v53
  v_cvt_pk_bf16_f32 v235, v54, v55
  v_mfma_f32_16x16x32_bf16 v[72:75], a[232:235], v[168:171], v[72:75]
  v_mfma_f32_16x16x32_bf16 v[68:71], a[232:235], v[164:167], v[68:71]
  s_waitcnt vmcnt(1)
  v_cmp_gt_u32 vcc, 6, v24
  s_cbranch_vccz L_go12
L_poll12:
  buffer_load_dword v24, v29, s[44:47], 0 offen sc1
  s_sub_u32 s39, s39, 1
  s_waitcnt vmcnt(0)
  v_cmp_gt_u32 vcc, 6, v24
  s_cbranch_scc1 L_giveup
  s_cbranch_vccnz L_poll12
L_go12:
  v_mfma_f32_16x16x32_bf16 v[68:71], a[236:239], v[176:179], v[68:71]
  v_cvt_pk_bf16_f32 v236, v44, v45
  v_cvt_pk_bf16_f32 v237, v46, v47
  v_mfma_f32_16x16x32_bf16 v[64:67], a[236:239], v[172:175], v[64:67]
  v_cvt_pk_bf16_f32 v238, v56, v57
  v_cvt_pk_bf16_f32 v239, v58, v59
  v_mfma_f32_16x16x32_bf16 v[64:67], a[232:235], v[160:163], v[64:67]
  buffer_load_dwordx4 a[32:35], v30, s[40:43], 0 offen sc1
  s_waitcnt lgkmcnt(4)
  v_mfma_f32_16x16x32_bf16 v[76:79], a[240:243], v[160:163], v[76:79]
  buffer_load_dwordx4 a[36:39], v30, s[40:43], s81 offen sc1
  buffer_store_dwordx4 v[232:235], v7, s[24:27], 0 offen sc1
  v_cvt_pk_bf16_f32 v240, v48, v49
  v_mfma_f32_16x16x32_bf16 v[76:79], a[244:247], v[172:175], v[76:79]
  v_cvt_pk_bf16_f32 v241, v50, v51
  buffer_load_dwordx4 a[40:43], v30, s[40:43], s82 offen sc1
  v_mfma_f32_16x16x32_bf16 v[80:83], a[244:247], v[176:179], v[80:83]
  buffer_load_dwordx4 a[44:47], v30, s[40:43], s83 offen sc1
  v_cvt_pk_bf16_f32 v242, v60, v61
  v_mfma_f32_16x16x32_bf16 v[80:83], a[240:243], v[164:167], v[80:83]
  v_cvt_pk_bf16_f32 v243, v62, v63
  buffer_load_dwordx4 a[48:51], v31, s[40:43], 0 offen sc1
  buffer_store_dwordx4 v[236:239], v7, s[24:27], s77 offen sc1
  v_mfma_f32_16x16x32_bf16 v[84:87], a[240:243], v[168:171], v[84:87]
  buffer_load_dwordx4 a[52:55], v31, s[40:43], s82 offen sc1
  v_add_u32 v30, 0x60000, v30
  v_mfma_f32_16x16x32_bf16 v[84:87], a[244:247], v[180:183], v[84:87]
  v_add_u32 v31, 0x60000, v31
  s_waitcnt lgkmcnt(0)
  v_mfma_f32_16x16x32_bf16 v[84:87], a[252:255], v[156:159], v[84:87]
  buffer_store_dwordx4 v[240:243], v7, s[24:27], s79 offen sc1
  v_mfma_f32_16x16x32_bf16 v[84:87], a[248:251], v[144:147], v[84:87]
  v_mfma_f32_16x16x32_bf16 v[80:83], a[248:251], v[140:143], v[80:83]
  v_mfma_f32_16x16x32_bf16 v[80:83], a[252:255], v[152:155], v[80:83]
  v_mfma_f32_16x16x32_bf16 v[76:79], a[252:255], v[148:151], v[76:79]
  v_mfma_f32_16x16x32_bf16 v[76:79], a[248:251], v[136:139], v[76:79]
  s_nop 7
  v_cvt_pk_bf16_f32 v244, v64, v65
  v_cvt_pk_bf16_f32 v245, v66, v67
  v_cvt_pk_bf16_f32 v246, v76, v77
  v_cvt_pk_bf16_f32 v247, v78, v79
  buffer_store_dwordx4 v[244:247], v7, s[24:27], s76 offen sc1
  v_cvt_pk_bf16_f32 v248, v68, v69
  v_cvt_pk_bf16_f32 v249, v70, v71
  v_cvt_pk_bf16_f32 v250, v80, v81
  v_cvt_pk_bf16_f32 v251, v82, v83
  buffer_store_dwordx4 v[248:251], v7, s[24:27], s78 offen sc1
  v_cvt_pk_bf16_f32 v252, v72, v73
  v_cvt_pk_bf16_f32 v253, v74, v75
  v_cvt_pk_bf16_f32 v254, v84, v85
  v_cvt_pk_bf16_f32 v255, v86, v87
  buffer_store_dwordx4 v[252:255], v7, s[24:27], s80 offen sc1
  s_waitcnt vmcnt(4)
  v_mfma_f32_16x16x32_bf16 v[20:23], a[172:175], a[32:35], 0
  v_mfma_f32_16x16x32_bf16 v[20:23], a[172:175], a[36:39], v[20:23]
  v_mfma_f32_16x16x32_bf16 v[20:23], a[172:175], a[40:43], v[20:23]
  v_mfma_f32_16x16x32_bf16 v[20:23], a[172:175], a[44:47], v[20:23]
  v_mfma_f32_16x16x32_bf16 v[20:23], a[176:179], a[48:51], v[20:23]
  v_mfma_f32_16x16x32_bf16 v[20:23], a[176:179], a[52:55], v[20:23]
  s_waitcnt vmcnt(0)
  v_mov_b32 v8, 7
  buffer_store_dword v8, v28, s[44:47], 0 offen sc1
  buffer_load_dword v24, v29, s[44:47], 0 offen sc1
  s_waitcnt vmcnt(0)
  v_cmp_gt_u32 vcc, 7, v24
  s_cbranch_vccz L_go13
L_poll13:
  buffer_load_dword v24, v29, s[44:47], 0 offen sc1
  s_sub_u32 s39, s39, 1
  s_waitcnt vmcnt(0)
  v_cmp_gt_u32 vcc, 7, v24
  s_cbranch_scc1 L_giveup
  s_cbranch_vccnz L_poll13
L_go13:
  buffer_load_dwordx4 a[0:3], v30, s[40:43], 0 offen sc1
  buffer_load_dwordx4 a[4:7], v30, s[40:43], s81 offen sc1
  buffer_load_dwordx4 a[8:11], v30, s[40:43], s82 offen sc1
  buffer_load_dwordx4 a[12:15], v30, s[40:43], s83 offen sc1
  buffer_load_dwordx4 a[16:19], v31, s[40:43], 0 offen sc1
  buffer_load_dwordx4 a[20:23], v31, s[40:43], s82 offen sc1
  v_add_f32_dpp v20, v20, v20 row_ror:8 row_mask:0xc bank_mask:0xf
  v_add_f32_dpp v21, v21, v21 row_ror:8 row_mask:0xc bank_mask:0xf
  v_add_f32_dpp v22, v22, v22 row_ror:8 row_mask:0xc bank_mask:0xf
  v_add_f32_dpp v23, v23, v23 row_ror:8 row_mask:0xc bank_mask:0xf
  v_cvt_pk_bf16_f32 v20, v20, v21
  v_cvt_pk_bf16_f32 v21, v22, v23
  buffer_store_dwordx2 v[20:21], v32, s[28:31], s57 offen offset:640
  s_waitcnt vmcnt(6)
  v_mfma_f32_16x16x32_bf16 v[20:23], a[172:175], a[0:3], 0
  s_waitcnt vmcnt(5)
  v_mfma_f32_16x16x32_bf16 v[20:23], a[172:175], a[4:7], v[20:23]
  s_waitcnt vmcnt(4)
  v_mfma_f32_16x16x32_bf16 v[20:23], a[172:175], a[8:11], v[20:23]
  s_waitcnt vmcnt(3)
  v_mfma_f32_16x16x32_bf16 v[20:23], a[172:175], a[12:15], v[20:23]
  s_waitcnt vmcnt(2)
  v_mfma_f32_16x16x32_bf16 v[20:23], a[176:179], a[16:19], v[20:23]
  s_waitcnt vmcnt(1)
  v_mfma_f32_16x16x32_bf16 v[20:23], a[176:179], a[20:23], v[20:23]
  s_nop 7
  v_add_f32_dpp v20, v20, v20 row_ror:8 row_mask:0xc bank_mask:0xf
  v_add_f32_dpp v21, v21, v21 row_ror:8 row_mask:0xc bank_mask:0xf
  v_add_f32_dpp v22, v22, v22 row_ror:8 row_mask:0xc bank_mask:0xf
  v_add_f32_dpp v23, v23, v23 row_ror:8 row_mask:0xc bank_mask:0xf
  v_cvt_pk_bf16_f32 v20, v20, v21
  v_cvt_pk_bf16_f32 v21, v22, v23
  buffer_store_dwordx2 v[20:21], v32, s[28:31], s57 offen offset:768
  s_branch L_fin
L_unsafe:
  v_mov_b32 v0, 152064
  v_mov_b32 v3, 1
  ds_write_b32 v0, v3
  s_waitcnt lgkmcnt(0)
  s_branch L_unsafe_back
L_fallback:
  s_waitcnt vmcnt(0) lgkmcnt(0)
  s_mov_b32 s53, 1
  s_mov_b32 s34, 0xfffff000
  s_mov_b32 s39, 32
  v_mbcnt_lo_u32_b32 v0, -1, 0
  v_mbcnt_hi_u32_b32 v0, -1, v0
  v_mov_b32 v14, 0x1000000
  v_and_b32 v3, 15, v0
  v_lshrrev_b32 v0, 4, v0
  v_mul_u32_u24 v3, 1056, v3
  v_lshl_add_u32 v3, v0, 4, v3
  v_mov_b32 v16, 0xff800000
  v_mov_b32 v18, 0xff800000
  v_mov_b32 v20, 0xff800000
L_fb_loop:
  s_barrier
  s_add_u32 m0, s33, 0
  s_add_u32 s34, s34, 0x1000
  buffer_load_dwordx4 v1, s[8:11], s34 offen nt lds
  s_add_u32 m0, s33, 1056
  s_add_u32 s34, s34, 0x1000
  buffer_load_dwordx4 v1, s[8:11], s34 offen nt lds
  s_add_u32 m0, s33, 2112
  s_add_u32 s34, s34, 0x1000
  buffer_load_dwordx4 v1, s[8:11], s34 offen nt lds
  s_add_u32 m0, s33, 3168
  s_add_u32 s34, s34, 0x1000
  buffer_load_dwordx4 v1, s[8:11], s34 offen nt lds
  s_waitcnt vmcnt(0)
  s_barrier
  ds_read_b128 a[224:227], v3 offset:0
  ds_read_b128 a[228:231], v3 offset:64
  s_waitcnt lgkmcnt(0)
  v_mfma_f32_16x16x32_bf16 v[40:43], a[224:227], a[0:3], 0
  v_mfma_f32_16x16x32_bf16 v[40:43], a[228:231], a[12:15], v[40:43]
  v_mfma_f32_16x16x32_bf16 v[44:47], a[228:231], a[16:19], 0
  v_mfma_f32_16x16x32_bf16 v[44:47], a[224:227], a[4:7], v[44:47]
  v_mfma_f32_16x16x32_bf16 v[48:51], a[224:227], a[8:11], 0
  v_mfma_f32_16x16x32_bf16 v[48:51], a[228:231], a[20:23], v[48:51]
  ds_read_b128 a[224:227], v3 offset:128
  ds_read_b128 a[228:231], v3 offset:192
  s_waitcnt lgkmcnt(0)
  v_mfma_f32_16x16x32_bf16 v[48:51], a[224:227], a[32:35], v[48:51]
  v_mfma_f32_16x16x32_bf16 v[48:51], a[228:231], a[44:47], v[48:51]
  v_mfma_f32_16x16x32_bf16 v[44:47], a[228:231], a[40:43], v[44:47]
  v_mfma_f32_16x16x32_bf16 v[44:47], a[224:227], a[28:31], v[44:47]
  v_mfma_f32_16x16x32_bf16 v[40:43], a[224:227], a[24:27], v[40:43]
  v_mfma_f32_16x16x32_bf16 v[40:43], a[228:231], a[36:39], v[40:43]
  ds_read_b128 a[224:227], v3 offset:256
  ds_read_b128 a[228:231], v3 offset:320
  s_waitcnt lgkmcnt(0)
  v_mfma_f32_16x16x32_bf16 v[40:43], a[224:227], a[48:51], v[40:43]
  v_mfma_f32_16x16x32_bf16 v[40:43], a[228:231], a[60:63], v[40:43]
  v_mfma_f32_16x16x32_bf16 v[44:47], a[228:231], a[64:67], v[44:47]
  v_mfma_f32_16x16x32_bf16 v[44:47], a[224:227], a[52:55], v[44:47]
  v_mfma_f32_16x16x32_bf16 v[48:51], a[224:227], a[56:59], v[48:51]
  v_mfma_f32_16x16x32_bf16 v[48:51], a[228:231], a[68:71], v[48:51]
  ds_read_b128 a[224:227], v3 offset:384
  ds_read_b128 a[228:231], v3 offset:448
  s_waitcnt lgkmcnt(0)
  v_mfma_f32_16x16x32_bf16 v[48:51], a[224:227], a[80:83], v[48:51]
  v_mfma_f32_16x16x32_bf16 v[48:51], a[228:231], a[92:95], v[48:51]
  v_mfma_f32_16x16x32_bf16 v[44:47], a[228:231], a[88:91], v[44:47]
  v_mfma_f32_16x16x32_bf16 v[44:47], a[224:227], a[76:79], v[44:47]
  v_mfma_f32_16x16x32_bf16 v[40:43], a[224:227], a[72:75], v[40:43]
  v_mfma_f32_16x16x32_bf16 v[40:43], a[228:231], a[84:87], v[40:43]
  ds_read_b128 a[224:227], v3 offset:896
  ds_read_b128 a[228:231], v3 offset:960
  s_waitcnt lgkmcnt(0)
  v_mfma_f32_16x16x32_bf16 v[52:55], a[224:227], a[72:75], 0
  v_mfma_f32_16x16x32_bf16 v[52:55], a[228:231], a[84:87], v[52:55]
  v_mfma_f32_16x16x32_bf16 v[56:59], a[228:231], a[88:91], 0
  v_mfma_f32_16x16x32_bf16 v[56:59], a[224:227], a[76:79], v[56:59]
  v_mfma_f32_16x16x32_bf16 v[60:63], a[224:227], a[80:83], 0
  v_mfma_f32_16x16x32_bf16 v[60:63], a[228:231], a[92:95], v[60:63]
  ds_read_b128 a[224:227], v3 offset:768
  ds_read_b128 a[228:231], v3 offset:832
  s_waitcnt lgkmcnt(0)
  v_mfma_f32_16x16x32_bf16 v[60:63], a[224:227], a[56:59], v[60:63]
  v_mfma_f32_16x16x32_bf16 v[60:63], a[228:231], a[68:71], v[60:63]
  v_mfma_f32_16x16x32_bf16 v[56:59], a[228:231], a[64:67], v[56:59]
  v_mfma_f32_16x16x32_bf16 v[56:59], a[224:227], a[52:55], v[56:59]
  v_mfma_f32_16x16x32_bf16 v[52:55], a[224:227], a[48:51], v[52:55]
  v_mfma_f32_16x16x32_bf16 v[52:55], a[228:231], a[60:63], v[52:55]
  ds_read_b128 a[224:227], v3 offset:640
  ds_read_b128 a[228:231], v3 offset:704
  s_waitcnt lgkmcnt(0)
  v_mfma_f32_16x16x32_bf16 v[52:55], a[224:227], a[24:27], v[52:55]
  v_mfma_f32_16x16x32_bf16 v[52:55], a[228:231], a[36:39], v[52:55]
  v_mfma_f32_16x16x32_bf16 v[56:59], a[228:231], a[40:43], v[56:59]
  v_mfma_f32_16x16x32_bf16 v[56:59], a[224:227], a[28:31], v[56:59]
  v_mfma_f32_16x16x32_bf16 v[60:63], a[224:227], a[32:35], v[60:63]
  v_mfma_f32_16x16x32_bf16 v[60:63], a[228:231], a[44:47], v[60:63]
  ds_read_b128 a[224:227], v3 offset:512
  ds_read_b128 a[228:231], v3 offset:576
  s_waitcnt lgkmcnt(0)
  v_mfma_f32_16x16x32_bf16 v[60:63], a[224:227], a[8:11], v[60:63]
  v_mfma_f32_16x16x32_bf16 v[60:63], a[228:231], a[20:23], v[60:63]
  v_mfma_f32_16x16x32_bf16 v[56:59], a[228:231], a[16:19], v[56:59]
  v_mfma_f32_16x16x32_bf16 v[56:59], a[224:227], a[4:7], v[56:59]
  v_mfma_f32_16x16x32_bf16 v[52:55], a[224:227], a[0:3], v[52:55]
  v_mfma_f32_16x16x32_bf16 v[52:55], a[228:231], a[12:15], v[52:55]
  s_nop 7
  v_max3_f32 v16, v16, v40, v41
  v_max3_f32 v16, v16, v42, v43
  v_max3_f32 v16, v16, v52, v53
  v_max3_f32 v16, v16, v54, v55
  v_max3_f32 v18, v18, v44, v45
  v_max3_f32 v18, v18, v46, v47
  v_max3_f32 v18, v18, v56, v57
  v_max3_f32 v18, v18, v58, v59
  v_max3_f32 v20, v20, v48, v49
  v_max3_f32 v20, v20, v50, v51
  v_max3_f32 v20, v20, v60, v61
  v_max3_f32 v20, v20, v62, v63
  s_sub_u32 s39, s39, 1
  s_cmp_lg_u32 s39, 0
  s_cbranch_scc1 L_fb_loop
  s_barrier
  s_mov_b32 s34, 0xfffff000
  s_mov_b32 s35, 0xffffb100
  v_mov_b32 v17, v16
  v_mov_b32 v19, v18
  v_mov_b32 v21, v20
  s_nop 0
  v_permlane32_swap_b32 v16, v17
  v_permlane32_swap_b32 v18, v19
  v_permlane32_swap_b32 v20, v21
  v_max_f32 v16, v16, v17
  v_max_f32 v18, v18, v19
  v_max_f32 v20, v20, v21
  v_mov_b32 v17, v16
  v_mov_b32 v19, v18
  v_mov_b32 v21, v20
  s_nop 0
  v_permlane16_swap_b32 v16, v17
  v_permlane16_swap_b32 v18, v19
  v_permlane16_swap_b32 v20, v21
  v_max_f32 v16, v16, v17
  v_max_f32 v18, v18, v19
  v_max_f32 v20, v20, v21
  v_sub_f32 v28, 0, v16
  v_sub_f32 v29, 0, v16
  v_sub_f32 v30, 0, v16
  v_sub_f32 v31, 0, v16
  v_sub_f32 v32, 0, v18
  v_sub_f32 v33, 0, v18
  v_sub_f32 v34, 0, v18
  v_sub_f32 v35, 0, v18
  v_sub_f32 v36, 0, v20
  v_sub_f32 v37, 0, v20
  v_sub_f32 v38, 0, v20
  v_sub_f32 v39, 0, v20
  s_add_u32 m0, s33, 0
  s_add_u32 s34, s34, 0x1000
  buffer_load_dwordx4 v1, s[8:11], s34 offen nt lds
  s_add_u32 m0, s33, 1056
  s_add_u32 s34, s34, 0x1000
  buffer_load_dwordx4 v1, s[8:11], s34 offen nt lds
  s_add_u32 m0, s33, 2112
  s_add_u32 s34, s34, 0x1000
  buffer_load_dwordx4 v1, s[8:11], s34 offen nt lds
  s_add_u32 m0, s33, 3168
  s_add_u32 s34, s34, 0x1000
  buffer_load_dwordx4 v1, s[8:11], s34 offen nt lds
  s_add_u32 m0, s33, 16896
  s_add_u32 s34, s34, 0x1000
  buffer_load_dwordx4 v1, s[8:11], s34 offen nt lds
  s_add_u32 m0, s33, 17952
  s_add_u32 s34, s34, 0x1000
  buffer_load_dwordx4 v1, s[8:11], s34 offen nt lds
  s_add_u32 m0, s33, 19008
  s_add_u32 s34, s34, 0x1000
  buffer_load_dwordx4 v1, s[8:11], s34 offen nt lds
  s_add_u32 m0, s33, 20064
  s_add_u32 s34, s34, 0x1000
  buffer_load_dwordx4 v1, s[8:11], s34 offen nt lds
  s_add_u32 m0, s33, 33792
  s_add_u32 s34, s34, 0x1000
  buffer_load_dwordx4 v1, s[8:11], s34 offen nt lds
  s_add_u32 m0, s33, 34848
  s_add_u32 s34, s34, 0x1000
  buffer_load_dwordx4 v1, s[8:11], s34 offen nt lds
  s_add_u32 m0, s33, 35904
  s_add_u32 s34, s34, 0x1000
  buffer_load_dwordx4 v1, s[8:11], s34 offen nt lds
  s_add_u32 m0, s33, 36960
  s_add_u32 s34, s34, 0x1000
  buffer_load_dwordx4 v1, s[8:11], s34 offen nt lds
  s_add_u32 m0, s33, 50688
  s_add_u32 s35, s35, 0x4f00
  buffer_load_dwordx4 v4, s[12:15], s35 offen nt lds
  s_add_u32 m0, s33, 51744
  s_add_u32 s35, s35, 0x1000
  buffer_load_dwordx4 v4, s[12:15], s35 offen nt lds
  s_add_u32 m0, s33, 52800
  s_add_u32 s35, s35, 0x1000
  buffer_load_dwordx4 v4, s[12:15], s35 offen nt lds
  s_add_u32 m0, s33, 53856
  s_add_u32 s35, s35, 0x1000
  buffer_load_dwordx4 v4, s[12:15], s35 offen nt lds
  s_waitcnt vmcnt(0)
  s_barrier
  ds_read_b128 a[224:227], v3 offset:0
  ds_read_b128 a[228:231], v3 offset:64
  s_waitcnt lgkmcnt(0)
  v_mfma_f32_16x16x32_bf16 v[40:43], a[224:227], a[0:3], v[28:31]
  v_mfma_f32_16x16x32_bf16 v[40:43], a[228:231], a[12:15], v[40:43]
  v_mfma_f32_16x16x32_bf16 v[44:47], a[228:231], a[16:19], v[32:35]
  v_mfma_f32_16x16x32_bf16 v[44:47], a[224:227], a[4:7], v[44:47]
  v_mfma_f32_16x16x32_bf16 v[48:51], a[224:227], a[8:11], v[36:39]
  v_mfma_f32_16x16x32_bf16 v[48:51], a[228:231], a[20:23], v[48:51]
  ds_read_b128 a[224:227], v3 offset:128
  ds_read_b128 a[228:231], v3 offset:192
  s_waitcnt lgkmcnt(0)
  v_mfma_f32_16x16x32_bf16 v[48:51], a[224:227], a[32:35], v[48:51]
  v_mfma_f32_16x16x32_bf16 v[48:51], a[228:231], a[44:47], v[48:51]
  v_mfma_f32_16x16x32_bf16 v[44:47], a[228:231], a[40:43], v[44:47]
  v_mfma_f32_16x16x32_bf16 v[44:47], a[224:227], a[28:31], v[44:47]
  v_mfma_f32_16x16x32_bf16 v[40:43], a[224:227], a[24:27], v[40:43]
  v_mfma_f32_16x16x32_bf16 v[40:43], a[228:231], a[36:39], v[40:43]
  ds_read_b128 a[224:227], v3 offset:256
  ds_read_b128 a[228:231], v3 offset:320
  s_waitcnt lgkmcnt(0)
  v_mfma_f32_16x16x32_bf16 v[40:43], a[224:227], a[48:51], v[40:43]
  v_mfma_f32_16x16x32_bf16 v[40:43], a[228:231], a[60:63], v[40:43]
  v_mfma_f32_16x16x32_bf16 v[44:47], a[228:231], a[64:67], v[44:47]
  v_mfma_f32_16x16x32_bf16 v[44:47], a[224:227], a[52:55], v[44:47]
  v_mfma_f32_16x16x32_bf16 v[48:51], a[224:227], a[56:59], v[48:51]
  v_mfma_f32_16x16x32_bf16 v[48:51], a[228:231], a[68:71], v[48:51]
  ds_read_b128 a[224:227], v3 offset:384
  ds_read_b128 a[228:231], v3 offset:448
  s_waitcnt lgkmcnt(0)
  v_mfma_f32_16x16x32_bf16 v[48:51], a[224:227], a[80:83], v[48:51]
  v_mfma_f32_16x16x32_bf16 v[48:51], a[228:231], a[92:95], v[48:51]
  v_mfma_f32_16x16x32_bf16 v[44:47], a[228:231], a[88:91], v[44:47]
  v_mfma_f32_16x16x32_bf16 v[44:47], a[224:227], a[76:79], v[44:47]
  v_mfma_f32_16x16x32_bf16 v[40:43], a[224:227], a[72:75], v[40:43]
  v_mfma_f32_16x16x32_bf16 v[40:43], a[228:231], a[84:87], v[40:43]
  ds_read_b128 a[224:227], v3 offset:896
  ds_read_b128 a[228:231], v3 offset:960
  s_waitcnt lgkmcnt(0)
  v_mfma_f32_16x16x32_bf16 v[52:55], a[224:227], a[72:75], v[28:31]
  v_mfma_f32_16x16x32_bf16 v[52:55], a[228:231], a[84:87], v[52:55]
  v_mfma_f32_16x16x32_bf16 v[56:59], a[228:231], a[88:91], v[32:35]
  v_mfma_f32_16x16x32_bf16 v[56:59], a[224:227], a[76:79], v[56:59]
  v_mfma_f32_16x16x32_bf16 v[60:63], a[224:227], a[80:83], v[36:39]
  v_mfma_f32_16x16x32_bf16 v[60:63], a[228:231], a[92:95], v[60:63]
  ds_read_b128 a[224:227], v3 offset:768
  ds_read_b128 a[228:231], v3 offset:832
  s_waitcnt lgkmcnt(0)
  v_mfma_f32_16x16x32_bf16 v[60:63], a[224:227], a[56:59], v[60:63]
  v_mfma_f32_16x16x32_bf16 v[60:63], a[228:231], a[68:71], v[60:63]
  v_mfma_f32_16x16x32_bf16 v[56:59], a[228:231], a[64:67], v[56:59]
  v_mfma_f32_16x16x32_bf16 v[56:59], a[224:227], a[52:55], v[56:59]
  v_mfma_f32_16x16x32_bf16 v[52:55], a[224:227], a[48:51], v[52:55]
  v_mfma_f32_16x16x32_bf16 v[52:55], a[228:231], a[60:63], v[52:55]
  ds_read_b128 a[224:227], v3 offset:640
  ds_read_b128 a[228:231], v3 offset:704
  s_waitcnt lgkmcnt(0)
  v_mfma_f32_16x16x32_bf16 v[52:55], a[224:227], a[24:27], v[52:55]
  v_mfma_f32_16x16x32_bf16 v[52:55], a[228:231], a[36:39], v[52:55]
  v_mfma_f32_16x16x32_bf16 v[56:59], a[228:231], a[40:43], v[56:59]
  v_mfma_f32_16x16x32_bf16 v[56:59], a[224:227], a[28:31], v[56:59]
  v_mfma_f32_16x16x32_bf16 v[60:63], a[224:227], a[32:35], v[60:63]
  v_mfma_f32_16x16x32_bf16 v[60:63], a[228:231], a[44:47], v[60:63]
  ds_read_b128 a[224:227], v3 offset:512
  ds_read_b128 a[228:231], v3 offset:576
  s_waitcnt lgkmcnt(0)
  v_mfma_f32_16x16x32_bf16 v[60:63], a[224:227], a[8:11], v[60:63]
  v_mfma_f32_16x16x32_bf16 v[60:63], a[228:231], a[20:23], v[60:63]
  v_mfma_f32_16x16x32_bf16 v[56:59], a[228:231], a[16:19], v[56:59]
  v_mfma_f32_16x16x32_bf16 v[56:59], a[224:227], a[4:7], v[56:59]
  v_mfma_f32_16x16x32_bf16 v[52:55], a[224:227], a[0:3], v[52:55]
  v_mfma_f32_16x16x32_bf16 v[52:55], a[228:231], a[12:15], v[52:55]
  s_nop 7
  v_accvgpr_read_b32 v160, a48
  v_accvgpr_read_b32 v161, a49
  v_accvgpr_read_b32 v162, a50
  v_accvgpr_read_b32 v163, a51
  v_accvgpr_read_b32 v168, a52
  v_accvgpr_read_b32 v169, a53
  v_accvgpr_read_b32 v170, a54
  v_accvgpr_read_b32 v171, a55
  v_accvgpr_read_b32 v176, a56
  v_accvgpr_read_b32 v177, a57
  v_accvgpr_read_b32 v178, a58
  v_accvgpr_read_b32 v179, a59
  v_accvgpr_read_b32 v184, a60
  v_accvgpr_read_b32 v185, a61
  v_accvgpr_read_b32 v186, a62
  v_accvgpr_read_b32 v187, a63
  v_accvgpr_read_b32 v192, a64
  v_accvgpr_read_b32 v193, a65
  v_accvgpr_read_b32 v194, a66
  v_accvgpr_read_b32 v195, a67
  v_accvgpr_read_b32 v200, a68
  v_accvgpr_read_b32 v201, a69
  v_accvgpr_read_b32 v202, a70
  v_accvgpr_read_b32 v203, a71
  v_accvgpr_read_b32 v208, a72
  v_accvgpr_read_b32 v209, a73
  v_accvgpr_read_b32 v210, a74
  v_accvgpr_read_b32 v211, a75
  v_accvgpr_read_b32 v216, a76
  v_accvgpr_read_b32 v217, a77
  v_accvgpr_read_b32 v218, a78
  v_accvgpr_read_b32 v219, a79
  v_accvgpr_read_b32 v224, a80
  v_accvgpr_read_b32 v225, a81
  v_accvgpr_read_b32 v226, a82
  v_accvgpr_read_b32 v227, a83
  v_accvgpr_read_b32 v188, a84
  v_accvgpr_read_b32 v189, a85
  v_accvgpr_read_b32 v190, a86
  v_accvgpr_read_b32 v191, a87
  v_accvgpr_read_b32 v196, a88
  v_accvgpr_read_b32 v197, a89
  v_accvgpr_read_b32 v198, a90
  v_accvgpr_read_b32 v199, a91
  v_accvgpr_read_b32 v204, a92
  v_accvgpr_read_b32 v205, a93
  v_accvgpr_read_b32 v206, a94
  v_accvgpr_read_b32 v207, a95
  ds_read_b128 a[224:227], v3 offset:16896
  ds_read_b128 a[228:231], v3 offset:16960
  ds_read_b128 a[232:235], v3 offset:17024
  ds_read_b128 a[236:239], v3 offset:17088
  ds_read_b128 a[240:243], v3 offset:17152
  ds_read_b128 a[244:247], v3 offset:17216
  s_branch L_attn
.section .rodata,"a"
.p2align 6
.amdhsa_kernel concat_heads__mha_block_cached__gqa_block_cached__near_ridge_kernel
  .amdhsa_next_free_vgpr 512
  .amdhsa_next_free_sgpr 102
  .amdhsa_accum_offset 256
  .amdhsa_group_segment_fixed_size 0
  .amdhsa_kernarg_size 104
  .amdhsa_user_sgpr_count 2
  .amdhsa_user_sgpr_kernarg_segment_ptr 1
  .amdhsa_system_sgpr_workgroup_id_x 1
  .amdhsa_float_denorm_mode_32 3
.end_amdhsa_kernel
```
